```python
import torch

def _softmax(x, axis=-1):
    return torch.softmax(x, dim=axis)
def _gelu(x):
    return torch.nn.functional.gelu(x, approximate="tanh")
def _silu(x):
    return torch.nn.functional.silu(x)
def _sigmoid(x):
    return torch.sigmoid(x)
def _layernorm(x, axis=-1, eps=1e-5):
    m = x.mean(dim=axis, keepdim=True)
    v = x.var(dim=axis, keepdim=True, unbiased=False)
    return (x - m) / torch.sqrt(v + eps)
def _scatter_add(tgt, idx, src, axis=0):
    return tgt.clone().index_add_(axis, idx, src)
def _segment_sum(src, seg, n):
    out = torch.zeros((n,) + src.shape[1:], dtype=src.dtype)
    return out.index_add_(0, seg, src)
def _pad(x, pw):
    flat = tuple(v for pair in reversed(pw) for v in pair)
    return torch.nn.functional.pad(x, flat)

kernel_name = 'parallel_sum__linear_attn_block__dense_activation_silu__prompt'

def setup_inputs():

    _w = (lambda a: (lambda t: t.to(torch.bfloat16) if t.is_floating_point() else t)(torch.as_tensor(a)))
    def _A_setup():
        B, S, D = 1, 2048, 640
        return {
            "x": _w((lambda *s: torch.randn(*s, dtype=torch.bfloat16) * 0.05)(B, S, D)),
            "wqkv": _w((lambda *s: torch.randn(*s, dtype=torch.bfloat16) * 0.1)(D, 3 * D)),
            "wo": _w((lambda *s: torch.randn(*s, dtype=torch.bfloat16) * 0.05)(D, D)),
        }
    _A_in = _A_setup()

    def _B_setup():
        B, S, D, F = 1, 2048, 640, 1728
        return {
            "x": _w((lambda *s: torch.randn(*s, dtype=torch.bfloat16) * 0.05)(B, S, D)),
            "w1": _w((lambda *s: torch.randn(*s, dtype=torch.bfloat16) * 0.8)(D, F) * (D ** -0.5)),
            "w2": _w((lambda *s: torch.randn(*s, dtype=torch.bfloat16) * 0.1)(F, D) * (F ** -0.5)),
        }
    _B_in = _B_setup()

    return {
        "A_x": _A_in["x"],
        "A_wqkv": _A_in["wqkv"],
        "A_wo": _A_in["wo"],
        "B_x": _B_in["x"],
        "B_w1": _B_in["w1"],
        "B_w2": _B_in["w2"],
    }

def reference(A_x, A_wqkv, A_wo, B_x, B_w1, B_w2):
    def _A_ref(x, wqkv, wo):
        B, S, D = x.shape
        H = 32; Dh = D // H
        qkv = (lambda x, *d: x.permute(*d))((x @ wqkv).reshape(B, S, 3, H, Dh), 2, 0, 3, 1, 4)
        q, k, v = qkv[0], qkv[1], qkv[2]
        phi = lambda t: torch.where(t > 0, t + 1, torch.exp(t)) + 1e-6
        pq, pk = phi(q), phi(k)
        kv = torch.einsum("bhsd,bhse->bhde", pk, v)
        z = torch.einsum("bhsd->bhd", pk)
        num = torch.einsum("bhqd,bhde->bhqe", pq, kv)
        den = torch.einsum("bhqd,bhd->bhq", pq, z)[..., None] + 1e-6
        o = num / den
        return (lambda x, *d: x.permute(*d))(o, 0, 2, 1, 3).reshape(B, S, D) @ wo

    def _B_ref(x, w1, w2):
        h = torch.einsum("bsd,df->bsf", x, w1)
        h = _silu(h)
        out = torch.einsum("bsf,fd->bsd", h, w2)
        return out

    x = A_x
    xn = _layernorm(x, axis=-1)
    return x + _A_ref(xn, A_wqkv, A_wo) + _B_ref(xn, B_w1, B_w2)
```

```asm
; @launch grid=(256,1,1) block=(256,1,1) lds=163840
.amdgcn_target "amdgcn-amd-amdhsa--gfx950"
.text
.globl parallel_sum__linear_attn_block__dense_activation_silu__prompt_kernel
.p2align 8
.type parallel_sum__linear_attn_block__dense_activation_silu__prompt_kernel,@function
parallel_sum__linear_attn_block__dense_activation_silu__prompt_kernel:
    s_cmp_ge_u32 s2, 256
    s_cbranch_scc1 L_exit
    s_load_dwordx8 s[64:71], s[0:1], 32
    s_load_dwordx2 s[62:63], s[0:1], 16
    s_load_dwordx4 s[4:7], s[0:1], 0
    s_load_dwordx2 s[16:17], s[0:1], 64
    v_lshrrev_b32 v1, 6, v0
    v_and_b32 v0, 63, v0
    v_readfirstlane_b32 s36, v1
    s_getpc_b64 s[54:55]
L_pc:
    s_lshr_b32 s3, s2, 3
    s_lshl_b32 s3, s3, 2
    s_add_u32 s3, s3, s36
    s_lshl_b32 s3, s3, 9
    v_lshl_add_u32 v6, v0, 7, s3
    v_min_u32 v6, L_code_end-L_pc, v6
    s_mov_b64 exec, 15
    global_load_dword v255, v6, s[54:55]
    s_mov_b64 exec, -1
    s_and_b32 s3, s2, 7
    s_lshl_b32 s3, s3, 5
    s_lshr_b32 s75, s2, 3
    s_add_u32 s3, s3, s75
    s_lshl2_add_u32 s75, s3, s36
    s_lshl_b32 s3, s75, 1
    v_lshrrev_b32 v7, 5, v0
    v_add_u32 v7, s3, v7
    v_mul_u32_u24 v7, 1280, v7
    v_and_b32 v205, 31, v0
    v_lshl_add_u32 v204, v205, 4, v7
    v_lshl_add_u32 v205, v205, 3, v7
    s_mul_i32 s3, s75, 2432
    v_lshl_add_u32 v7, v0, 7, s3
    v_min_u32 v254, 2457472, v7
    s_mul_i32 s3, s75, 2176
    v_lshl_add_u32 v7, v0, 7, s3
    v_min_u32 v253, 2211712, v7
    s_waitcnt lgkmcnt(0)
    s_cmp_lg_u32 s2, 255
    s_cbranch_scc1 L_noclr
    v_mov_b32 v128, 0
    v_mov_b32 v129, 0
    v_mov_b32 v130, 0
    v_mov_b32 v131, 0
    s_lshl_b32 s3, s36, 10
    s_add_u32 s3, s3, 294912
    v_lshl_add_u32 v7, v0, 4, s3
    global_store_dwordx4 v7, v[128:131], s[16:17] sc1
    s_waitcnt vmcnt(0)
    s_mov_b32 s72, 1
    s_atomic_add s72, s[70:71], 0x0
L_noclr:
    global_load_dwordx4 v[192:195], v204, s[4:5]
    global_load_dwordx4 v[196:199], v204, s[4:5] offset:512
    global_load_dwordx2 v[200:201], v205, s[4:5] offset:1024
    s_mov_b64 exec, 0x7ffff
    global_load_dword v254, v254, s[6:7]
    s_mov_b64 exec, 0x1ffff
    global_load_dword v253, v253, s[64:65]
    s_mov_b64 exec, -1
    v_and_b32 v1, 15, v0
    v_lshrrev_b32 v2, 4, v0
    v_lshlrev_b32 v3, 4, v0
    v_add_u32 v4, 4096, v3
    s_and_b32 s3, s2, 7
    s_lshr_b32 s49, s2, 3
    s_lshl_b32 s48, s3, 2
    s_lshr_b32 s37, s3, 2
    s_and_b32 s3, s3, 3
    s_lshl_b32 s3, s3, 1
    s_or_b32 s3, s3, s37
    s_lshl_b32 s3, s3, 5
    s_add_u32 s3, s3, s49
    s_mov_b32 s43, s3
    s_lshr_b32 s37, s49, 3
    s_add_u32 s48, s48, s37
    s_and_b32 s49, s49, 7
    s_mul_i32 s39, s3, 993
    s_lshr_b32 s39, s39, 16
    s_mul_i32 s37, s39, 66
    s_sub_u32 s3, s3, s37
    s_cmp_lt_u32 s39, 3
    s_cselect_b32 s37, 43, 52
    s_cselect_b32 s38, 6, 5
    s_mul_i32 s37, s37, s3
    s_lshr_b32 s37, s37, 8
    s_mul_i32 s38, s38, s37
    s_sub_u32 s3, s3, s38
    s_cmp_eq_u32 s37, 11
    s_cselect_b32 s44, 3, s3
    s_cselect_b32 s3, 0, 2
    s_mul_i32 s73, s39, 11
    s_add_u32 s73, s73, s37
    s_lshl_b32 s73, s73, 1
    s_sub_u32 s43, s43, s73
    s_sub_u32 s43, s43, s3
    s_lshl_b32 s43, s43, 2
    s_add_u32 s43, s43, s36
    s_add_u32 s73, s73, s44
    s_add_u32 s73, s73, 672
    s_cmp_eq_u32 s36, 0
    s_cselect_b32 s73, s73, 1000
    s_cmp_lt_u32 s44, 2
    s_cselect_b32 s73, s73, s43
    s_mul_i32 s54, s73, 6554
    s_lshr_b32 s54, s54, 16
    s_mul_i32 s3, s54, 10
    s_sub_u32 s55, s73, s3
    s_max_u32 s3, s54, 54
    s_sub_u32 s3, s3, 54
    s_mul_i32 s52, s3, 52
    s_lshr_b32 s52, s52, 8
    s_mul_i32 s52, s52, 5
    s_sub_u32 s3, s3, s52
    s_cmp_eq_u32 s3, 4
    s_cselect_b32 s51, 5, 1
    s_lshl_b32 s3, s3, 2
    s_lshr_b32 s3, 0x47520, s3
    s_and_b32 s3, s3, 15
    s_lshl1_add_u32 s3, s52, s3
    s_lshl_b32 s50, s54, 1
    s_cmp_lt_u32 s54, 54
    s_cselect_b32 s50, s50, s3
    s_cselect_b32 s34, 27, 10
    s_add_u32 s51, s51, s50
    s_mul_i32 s34, s34, 81920
    s_mov_b32 s35, 0x20000
    s_mul_i32 s50, s50, 20480
    s_mul_i32 s51, s51, 20480
    s_lshl_b32 s3, s55, 7
    s_cmp_lt_u32 s73, 740
    s_cselect_b32 s53, 0, 0x40000000
    s_or_b32 s3, s3, s53
    v_lshrrev_b32 v5, 3, v0
    v_and_b32 v6, 6, v5
    v_xor_b32 v6, v6, v0
    v_and_b32 v6, 7, v6
    v_mul_u32_u24 v5, 1280, v5
    v_lshl_add_u32 v5, v6, 4, v5
    v_add_u32 v5, s3, v5
    v_add_u32 v6, 9216, v5
    s_lshl_b32 s52, s36, 12
    s_add_u32 m0, s52, 61440
    s_cmp_lt_u32 s54, 54
    s_cselect_b32 s32, s66, s62
    s_cselect_b32 s33, s67, s63
    buffer_load_dwordx4 v5, s[32:35], s50 offen nt lds
    buffer_load_dwordx4 v6, s[32:35], s50 offen offset:1024 nt lds
    s_add_u32 m0, s52, 63488
    s_nop 0
    buffer_load_dwordx4 v5, s[32:35], s51 offen nt lds
    buffer_load_dwordx4 v6, s[32:35], s51 offen offset:1024 nt lds
    s_mov_b64 s[24:25], s[70:71]
    v_or_b32 v203, s53, v3
    s_mov_b32 s18, 138412032
    s_mov_b32 s19, 0x20000
    s_mov_b32 s26, 256
    s_mov_b32 s27, 0x20000
    s_mov_b32 s20, s16
    s_mov_b32 s21, s17
    s_mov_b32 s22, 65536
    s_mov_b32 s23, 0x20000
    s_mov_b32 s28, s68
    s_mov_b32 s29, s69
    s_mov_b32 s30, 2621440
    s_mov_b32 s31, 0x20000
    v_lshrrev_b32 v5, 2, v0
    v_lshlrev_b32 v6, 7, v5
    v_and_b32 v5, 6, v5
    v_lshl_add_u32 v6, v5, 4, v6
    v_and_b32 v5, 3, v0
    v_lshl_add_u32 v6, v5, 3, v6
    v_add_u32 v252, s52, v6
    v_xor_b32 v246, 32, v252
    v_xor_b32 v247, 64, v252
    v_xor_b32 v148, 96, v252
    v_add_u32 v202, 8192, v203
    s_min_u32 s54, s54, 73
    s_mul_i32 s50, s54, 52
    s_lshr_b32 s50, s50, 8
    s_lshl_b32 s51, s50, 1
    s_sub_u32 s51, s54, s51
    s_cmp_eq_u32 s51, 32
    s_cselect_b32 s52, 53, s51
    s_sub_u32 s51, s51, s50
    s_lshl_b32 s50, s50, 1
    s_sub_u32 s50, s51, s50
    s_add_u32 s51, s51, 29
    s_cmp_lt_u32 s50, 3
    s_cselect_b32 s52, s52, s51
    s_bfe_u32 s51, s52, 0x10002
    s_mul_i32 s51, s51, 27
    s_lshr_b32 s50, s52, 3
    s_lshl2_add_u32 s51, s50, s51
    s_and_b32 s50, s52, 3
    s_add_u32 s51, s51, s50
    s_sub_u32 s50, s52, 24
    s_cmp_ge_u32 s52, 51
    s_cselect_b32 s50, s52, s50
    s_cmp_lt_u32 s52, 48
    s_cselect_b32 s50, s51, s50
    s_cmp_lt_u32 s54, 54
    s_cselect_b32 s54, s50, s54
    s_bfe_u32 s3, s54, 0x10001
    s_mul_i32 s3, s3, 3072
    s_lshl_b32 s54, s54, 14
    s_add_u32 s54, s54, s3
    s_add_u32 s54, s54, 4194304
    s_lshl_b32 s3, s55, 2
    s_add_u32 s3, s3, 0
    s_mul_i32 s52, s3, 52
    s_lshr_b32 s52, s52, 8
    s_mul_i32 s52, s52, 4091
    s_add_u32 s3, s3, s52
    s_lshl_b32 s3, s3, 10
    s_add_u32 s66, s3, s54
    s_lshl_b32 s3, s55, 2
    s_add_u32 s3, s3, 1
    s_mul_i32 s52, s3, 52
    s_lshr_b32 s52, s52, 8
    s_mul_i32 s52, s52, 4091
    s_add_u32 s3, s3, s52
    s_lshl_b32 s3, s3, 10
    s_add_u32 s67, s3, s54
    s_lshl_b32 s3, s55, 2
    s_add_u32 s3, s3, 2
    s_mul_i32 s52, s3, 52
    s_lshr_b32 s52, s52, 8
    s_mul_i32 s52, s52, 4091
    s_add_u32 s3, s3, s52
    s_lshl_b32 s3, s3, 10
    s_add_u32 s68, s3, s54
    s_lshl_b32 s3, s55, 2
    s_add_u32 s3, s3, 3
    s_mul_i32 s52, s3, 52
    s_lshr_b32 s52, s52, 8
    s_mul_i32 s52, s52, 4091
    s_add_u32 s3, s3, s52
    s_lshl_b32 s3, s3, 10
    s_add_u32 s69, s3, s54
    s_mov_b32 s3, s44
    s_mul_i32 s59, s37, 188
    s_cmp_lt_u32 s3, 2
    s_cbranch_scc1 L_dec_kv
    s_cmp_eq_u32 s3, 2
    s_cbranch_scc1 L_dec_q
    s_mul_i32 s39, s39, 3
    s_add_u32 s39, s39, s3
    s_sub_u32 s39, s39, 3
    s_mov_b32 s38, 2
    s_mul_i32 s41, s39, 320
    s_mov_b32 s42, 0
    s_mov_b32 s40, 3456
    s_branch L_dec_done
L_dec_q:
    s_mov_b32 s38, 1
    s_mul_i32 s41, s39, 320
    s_mov_b32 s42, 0
    s_mov_b32 s40, 3840
    s_branch L_dec_done
L_dec_kv:
    s_lshl_b32 s39, s39, 1
    s_add_u32 s39, s39, s3
    s_mov_b32 s38, 0
    s_mul_i32 s41, s39, 160
    s_add_u32 s41, s41, 1280
    s_mov_b32 s42, 1120
    s_mov_b32 s40, 3840
L_dec_done:
    s_lshl_b32 s45, s40, 6
    s_mul_i32 s46, s36, 18432
    s_add_u32 s46, s46, 81920
    s_mul_i32 s47, s36, 5120
    s_mul_i32 s3, s36, 48
    s_add_u32 s3, s3, s59
    v_lshrrev_b32 v5, 3, v0
    v_and_b32 v6, 7, v0
    v_lshrrev_b32 v7, 1, v5
    v_xor_b32 v6, v6, v7
    v_lshlrev_b32 v6, 4, v6
    v_add_u32 v7, s3, v5
    v_mul_u32_u24 v7, 1280, v7
    v_add_u32 v177, v7, v6
    v_xor_b32 v178, 64, v177
    v_add_u32 v178, 10240, v178
    v_add_u32 v179, 20480, v177
    v_add_u32 v180, 20480, v178
    v_add_u32 v181, 40960, v177
    v_add_u32 v182, 40960, v178
    s_cmp_eq_u32 s36, 3
    s_cselect_b32 vcc_hi, -1, 0
    s_mov_b32 vcc_lo, 0
    v_or_b32 v7, 0x40000000, v182
    v_cndmask_b32 v182, v182, v7, vcc
    s_lshl_b32 s3, s36, 4
    v_add_u32 v5, 0, v0
    v_mul_u32_u24 v6, 3277, v5
    v_lshrrev_b32 v6, 16, v6
    v_mul_u32_u24 v7, 20, v6
    v_sub_u32 v5, v5, v7
    v_lshrrev_b32 v7, 2, v6
    v_and_b32 v7, 2, v7
    v_xor_b32 v5, v5, v7
    v_cmp_lt_u32 vcc, 9, v5
    v_mov_b32 v7, s42
    v_lshlrev_b32 v5, 4, v5
    v_cndmask_b32 v7, 0, v7, vcc
    v_add3_u32 v5, v5, v7, s41
    v_cmp_le_u32 vcc, s40, v5
    v_add_u32 v6, s3, v6
    v_mad_u32_u24 v5, v6, s40, v5
    v_or_b32 v6, 0x40000000, v5
    v_cndmask_b32 v172, v5, v6, vcc
    v_add_u32 v5, 64, v0
    v_mul_u32_u24 v6, 3277, v5
    v_lshrrev_b32 v6, 16, v6
    v_mul_u32_u24 v7, 20, v6
    v_sub_u32 v5, v5, v7
    v_lshrrev_b32 v7, 2, v6
    v_and_b32 v7, 2, v7
    v_xor_b32 v5, v5, v7
    v_cmp_lt_u32 vcc, 9, v5
    v_mov_b32 v7, s42
    v_lshlrev_b32 v5, 4, v5
    v_cndmask_b32 v7, 0, v7, vcc
    v_add3_u32 v5, v5, v7, s41
    v_cmp_le_u32 vcc, s40, v5
    v_add_u32 v6, s3, v6
    v_mad_u32_u24 v5, v6, s40, v5
    v_or_b32 v6, 0x40000000, v5
    v_cndmask_b32 v173, v5, v6, vcc
    v_add_u32 v5, 128, v0
    v_mul_u32_u24 v6, 3277, v5
    v_lshrrev_b32 v6, 16, v6
    v_mul_u32_u24 v7, 20, v6
    v_sub_u32 v5, v5, v7
    v_lshrrev_b32 v7, 2, v6
    v_and_b32 v7, 2, v7
    v_xor_b32 v5, v5, v7
    v_cmp_lt_u32 vcc, 9, v5
    v_mov_b32 v7, s42
    v_lshlrev_b32 v5, 4, v5
    v_cndmask_b32 v7, 0, v7, vcc
    v_add3_u32 v5, v5, v7, s41
    v_cmp_le_u32 vcc, s40, v5
    v_add_u32 v6, s3, v6
    v_mad_u32_u24 v5, v6, s40, v5
    v_or_b32 v6, 0x40000000, v5
    v_cndmask_b32 v174, v5, v6, vcc
    v_add_u32 v5, 192, v0
    v_mul_u32_u24 v6, 3277, v5
    v_lshrrev_b32 v6, 16, v6
    v_mul_u32_u24 v7, 20, v6
    v_sub_u32 v5, v5, v7
    v_lshrrev_b32 v7, 2, v6
    v_and_b32 v7, 2, v7
    v_xor_b32 v5, v5, v7
    v_cmp_lt_u32 vcc, 9, v5
    v_mov_b32 v7, s42
    v_lshlrev_b32 v5, 4, v5
    v_cndmask_b32 v7, 0, v7, vcc
    v_add3_u32 v5, v5, v7, s41
    v_cmp_le_u32 vcc, s40, v5
    v_add_u32 v6, s3, v6
    v_mad_u32_u24 v5, v6, s40, v5
    v_or_b32 v6, 0x40000000, v5
    v_cndmask_b32 v175, v5, v6, vcc
    v_add_u32 v5, 256, v0
    v_mul_u32_u24 v6, 3277, v5
    v_lshrrev_b32 v6, 16, v6
    v_mul_u32_u24 v7, 20, v6
    v_sub_u32 v5, v5, v7
    v_lshrrev_b32 v7, 2, v6
    v_and_b32 v7, 2, v7
    v_xor_b32 v5, v5, v7
    v_cmp_lt_u32 vcc, 9, v5
    v_mov_b32 v7, s42
    v_lshlrev_b32 v5, 4, v5
    v_cndmask_b32 v7, 0, v7, vcc
    v_add3_u32 v5, v5, v7, s41
    v_cmp_le_u32 vcc, s40, v5
    v_add_u32 v6, s3, v6
    v_mad_u32_u24 v5, v6, s40, v5
    v_or_b32 v6, 0x40000000, v5
    v_cndmask_b32 v176, v5, v6, vcc
    s_mov_b32 s8, s4
    s_mov_b32 s9, s5
    s_mov_b32 s10, 2621440
    s_mov_b32 s11, 0x20000
    s_cmp_eq_u32 s38, 2
    s_cselect_b32 s12, s64, s6
    s_cselect_b32 s13, s65, s7
    s_mul_i32 s14, s40, 640
    s_mov_b32 s15, 0x20000
    s_mov_b32 s43, 0
    s_mov_b32 s44, 0
    v_lshrrev_b32 v5, 2, v1
    v_lshl_add_u32 v5, v2, 3, v5
    v_mul_u32_u24 v5, 320, v5
    v_and_b32 v6, 3, v1
    v_lshl_add_u32 v5, v6, 3, v5
    v_and_b32 v6, 1, v2
    v_lshlrev_b32 v6, 5, v6
    v_add_u32 v183, v5, v6
    v_sub_u32 v184, v5, v6
    v_add_u32 v185, 40960, v183
    v_add_u32 v186, 40960, v184
    v_lshrrev_b32 v5, 1, v1
    v_xor_b32 v5, v5, v2
    v_lshlrev_b32 v5, 4, v5
    v_lshl_add_u32 v5, v1, 7, v5
    v_add_u32 v187, s46, v5
    v_xor_b32 v188, 64, v187
    v_mov_b32 v5, 159744
    v_mov_b32 v128, 0x3f803f80
    v_mov_b32 v129, 0x3f803f80
    v_mov_b32 v130, 0x3f803f80
    v_mov_b32 v131, 0x3f803f80
    s_mov_b64 exec, 1
    ds_write_b128 v5, v[128:131]
    s_mov_b64 exec, -1
    s_cmp_eq_u32 s36, 3
    s_cselect_b32 vcc_lo, 0xf000f000, 0
    s_mov_b32 vcc_hi, vcc_lo
    v_add_u32 v6, 4096, v187
    v_cndmask_b32 v240, v6, v5, vcc
    v_add_u32 v6, 4096, v188
    v_cndmask_b32 v241, v6, v5, vcc
    v_add_u32 v6, 10240, v187
    v_cndmask_b32 v242, v6, v5, vcc
    v_add_u32 v6, 10240, v188
    v_cndmask_b32 v243, v6, v5, vcc
    v_add_u32 v6, 16384, v187
    v_cndmask_b32 v244, v6, v5, vcc
    v_add_u32 v6, 16384, v188
    v_cndmask_b32 v245, v6, v5, vcc
    v_lshlrev_b32 v5, 2, v2
    s_cmp_eq_u32 s38, 0
    s_cselect_b64 vcc, -1, 0
    s_mul_i32 s3, s36, 48
    v_cndmask_b32 v5, v1, v5, vcc
    v_add_u32 v5, s3, v5
    v_add_u32 v189, s59, v5
    v_add_u32 v190, 16, v189
    v_add_u32 v191, 32, v189
    v_mov_b32 v6, 4096
    v_cmp_lt_u32 vcc, 155, v5
    s_nop 1
    v_cndmask_b32 v191, v191, v6, vcc
    s_waitcnt lgkmcnt(0)
    s_cmp_eq_u32 s37, 11
    s_cbranch_scc1 L_idle
    s_mov_b64 exec, 0
    s_cmp_eq_u32 s36, 0
    s_cbranch_scc1 L_st0
    s_cmp_eq_u32 s36, 1
    s_cbranch_scc1 L_st1
    s_cmp_eq_u32 s36, 2
    s_cbranch_scc1 L_st2
    s_branch L_st3
L_iwback:
    s_mov_b64 exec, -1
    s_add_u32 m0, s46, 0
    s_nop 0
    buffer_load_dwordx4 v177, s[8:11], s43 offen lds
    s_add_u32 m0, s47, 0
    s_nop 0
    buffer_load_dwordx4 v172, s[12:15], s44 offen lds
    s_add_u32 m0, s46, 1024
    s_nop 0
    buffer_load_dwordx4 v178, s[8:11], s43 offen lds
    s_add_u32 m0, s47, 1024
    s_nop 0
    buffer_load_dwordx4 v173, s[12:15], s44 offen lds
    s_add_u32 m0, s46, 2048
    s_nop 0
    buffer_load_dwordx4 v179, s[8:11], s43 offen lds
    s_add_u32 m0, s47, 2048
    s_nop 0
    buffer_load_dwordx4 v174, s[12:15], s44 offen lds
    s_add_u32 m0, s46, 3072
    s_nop 0
    buffer_load_dwordx4 v180, s[8:11], s43 offen lds
    s_add_u32 m0, s47, 3072
    s_nop 0
    buffer_load_dwordx4 v175, s[12:15], s44 offen lds
    s_add_u32 m0, s46, 4096
    s_nop 0
    buffer_load_dwordx4 v181, s[8:11], s43 offen lds
    s_add_u32 m0, s47, 4096
    s_nop 0
    buffer_load_dwordx4 v176, s[12:15], s44 offen lds
    s_add_u32 s44, s44, s45
    s_add_u32 m0, s46, 5120
    s_nop 0
    buffer_load_dwordx4 v182, s[8:11], s43 offen lds
    s_add_u32 s43, s43, 128
    s_waitcnt vmcnt(11)
    ds_read_b64_tr_b16 v[224:225], v252 offset:61440
    ds_read_b64_tr_b16 v[226:227], v252 offset:63488
    ds_read_b64_tr_b16 v[228:229], v246 offset:61440
    ds_read_b64_tr_b16 v[230:231], v246 offset:63488
    ds_read_b64_tr_b16 v[232:233], v247 offset:61440
    ds_read_b64_tr_b16 v[234:235], v247 offset:63488
    ds_read_b64_tr_b16 v[236:237], v148 offset:61440
    ds_read_b64_tr_b16 v[238:239], v148 offset:63488
    s_add_u32 m0, s46, 6144
    s_nop 0
    buffer_load_dwordx4 v177, s[8:11], s43 offen lds
    s_add_u32 m0, s47, 20480
    s_nop 0
    buffer_load_dwordx4 v172, s[12:15], s44 offen lds
    s_add_u32 m0, s46, 7168
    s_nop 0
    buffer_load_dwordx4 v178, s[8:11], s43 offen lds
    s_add_u32 m0, s47, 21504
    s_nop 0
    buffer_load_dwordx4 v173, s[12:15], s44 offen lds
    s_add_u32 m0, s46, 8192
    s_nop 0
    buffer_load_dwordx4 v179, s[8:11], s43 offen lds
    s_add_u32 m0, s47, 22528
    s_nop 0
    buffer_load_dwordx4 v174, s[12:15], s44 offen lds
    s_add_u32 m0, s46, 9216
    s_nop 0
    buffer_load_dwordx4 v180, s[8:11], s43 offen lds
    s_add_u32 m0, s47, 23552
    s_nop 0
    buffer_load_dwordx4 v175, s[12:15], s44 offen lds
    s_add_u32 m0, s46, 10240
    s_nop 0
    buffer_load_dwordx4 v181, s[8:11], s43 offen lds
    s_add_u32 m0, s47, 24576
    s_nop 0
    buffer_load_dwordx4 v176, s[12:15], s44 offen lds
    s_add_u32 s44, s44, s45
    s_add_u32 m0, s46, 11264
    s_nop 0
    buffer_load_dwordx4 v182, s[8:11], s43 offen lds
    s_add_u32 s43, s43, 128
    s_cmp_eq_u32 s38, 0
    s_cbranch_scc1 L_kv
    s_branch L_main
    .p2align 12
L_main:
L_st0:
    s_cbranch_execz L_st4
    s_waitcnt vmcnt(11) lgkmcnt(0)
    s_barrier
    ds_read_b128 v[148:151], v187 offset:0
    ds_read_b128 v[152:155], v187 offset:2048
    ds_read_b128 v[156:159], v240
    ds_read_b64_tr_b16 v[128:129], v183 offset:0
    ds_read_b64_tr_b16 v[130:131], v183 offset:1280
    ds_read_b64_tr_b16 v[132:133], v184 offset:32
    ds_read_b64_tr_b16 v[134:135], v184 offset:1312
    ds_read_b64_tr_b16 v[136:137], v183 offset:64
    ds_read_b64_tr_b16 v[138:139], v183 offset:1344
    ds_read_b64_tr_b16 v[140:141], v184 offset:96
    ds_read_b64_tr_b16 v[142:143], v184 offset:1376
    s_waitcnt lgkmcnt(6)
    v_mfma_f32_16x16x32_bf16 v[8:11], v[128:131], v[148:151], 0
    ds_read_b64_tr_b16 v[144:145], v183 offset:128
    v_mfma_f32_16x16x32_bf16 v[12:15], v[128:131], v[152:155], 0
    s_add_u32 m0, s46, 12288
    ds_read_b64_tr_b16 v[146:147], v183 offset:1408
    s_mul_i32 s50, s75, 192
    v_mfma_f32_16x16x32_bf16 v[16:19], v[128:131], v[156:159], 0
    s_waitcnt lgkmcnt(6)
    buffer_load_dwordx4 v177, s[8:11], s43 offen lds
    s_add_u32 s50, s50, 65536
    v_mfma_f32_16x16x32_bf16 v[20:23], v[132:135], v[148:151], 0
    ds_read_b64_tr_b16 v[128:129], v184 offset:160
    s_lshl_b32 s51, s75, 6
    v_mfma_f32_16x16x32_bf16 v[24:27], v[132:135], v[152:155], 0
    s_add_u32 m0, s47, 40960
    ds_read_b64_tr_b16 v[130:131], v184 offset:1440
    v_mov_b32 v248, 0
    v_mfma_f32_16x16x32_bf16 v[28:31], v[132:135], v[156:159], 0
    s_waitcnt lgkmcnt(6)
    buffer_load_dwordx4 v172, s[12:15], s44 offen lds
    v_mov_b32 v249, 0
    v_mfma_f32_16x16x32_bf16 v[32:35], v[136:139], v[148:151], 0
    ds_read_b64_tr_b16 v[132:133], v183 offset:192
    v_mov_b32 v250, 0
    v_mfma_f32_16x16x32_bf16 v[36:39], v[136:139], v[152:155], 0
    ds_read_b64_tr_b16 v[134:135], v183 offset:1472
    v_mov_b32 v251, 0
    v_mfma_f32_16x16x32_bf16 v[40:43], v[136:139], v[156:159], 0
    s_waitcnt lgkmcnt(6)
    buffer_store_dwordx4 v[224:227], v203, s[16:19], s66 offen sc1
    v_mfma_f32_16x16x32_bf16 v[44:47], v[140:143], v[148:151], 0
    ds_read_b64_tr_b16 v[136:137], v184 offset:224
    s_mov_b64 exec, 0xfff
    buffer_store_dwordx4 v[248:251], v3, s[16:19], s50 offen sc1
    s_mov_b64 exec, -1
    v_mfma_f32_16x16x32_bf16 v[48:51], v[140:143], v[152:155], 0
    s_add_u32 m0, s46, 13312
    ds_read_b64_tr_b16 v[138:139], v184 offset:1504
    v_mfma_f32_16x16x32_bf16 v[52:55], v[140:143], v[156:159], 0
    s_waitcnt lgkmcnt(6)
    buffer_load_dwordx4 v178, s[8:11], s43 offen lds
    v_lshlrev_b32 v204, 16, v192
    v_mfma_f32_16x16x32_bf16 v[56:59], v[144:147], v[148:151], 0
    ds_read_b64_tr_b16 v[140:141], v183 offset:256
    v_and_b32 v205, 0xffff0000, v192
    v_mfma_f32_16x16x32_bf16 v[60:63], v[144:147], v[152:155], 0
    ds_read_b64_tr_b16 v[142:143], v183 offset:1536
    v_lshlrev_b32 v206, 16, v193
    v_mfma_f32_16x16x32_bf16 v[64:67], v[144:147], v[156:159], 0
    s_waitcnt lgkmcnt(6)
    v_and_b32 v207, 0xffff0000, v193
    v_lshlrev_b32 v208, 16, v194
    v_mfma_f32_16x16x32_bf16 v[68:71], v[128:131], v[148:151], 0
    ds_read_b64_tr_b16 v[144:145], v184 offset:288
    v_and_b32 v209, 0xffff0000, v194
    v_mfma_f32_16x16x32_bf16 v[72:75], v[128:131], v[152:155], 0
    s_add_u32 m0, s47, 41984
    ds_read_b64_tr_b16 v[146:147], v184 offset:1568
    v_lshlrev_b32 v210, 16, v195
    v_mfma_f32_16x16x32_bf16 v[76:79], v[128:131], v[156:159], 0
    s_waitcnt lgkmcnt(6)
    buffer_load_dwordx4 v173, s[12:15], s44 offen lds
    v_and_b32 v211, 0xffff0000, v195
    v_mfma_f32_16x16x32_bf16 v[80:83], v[132:135], v[148:151], 0
    ds_read_b64_tr_b16 v[128:129], v183 offset:10240
    v_lshlrev_b32 v212, 16, v196
    v_mfma_f32_16x16x32_bf16 v[84:87], v[132:135], v[152:155], 0
    ds_read_b64_tr_b16 v[130:131], v183 offset:11520
    ds_read_b128 v[160:163], v188 offset:0
    v_mfma_f32_16x16x32_bf16 v[88:91], v[132:135], v[156:159], 0
    s_waitcnt lgkmcnt(7)
    buffer_store_dwordx4 v[224:227], v202, s[16:19], s66 offen sc1
    v_and_b32 v213, 0xffff0000, v196
    v_mfma_f32_16x16x32_bf16 v[92:95], v[136:139], v[148:151], 0
    ds_read_b64_tr_b16 v[132:133], v184 offset:10272
    ds_read_b128 v[164:167], v188 offset:2048
    v_mfma_f32_16x16x32_bf16 v[96:99], v[136:139], v[152:155], 0
    s_add_u32 m0, s46, 14336
    ds_read_b64_tr_b16 v[134:135], v184 offset:11552
    v_lshlrev_b32 v214, 16, v197
    v_mfma_f32_16x16x32_bf16 v[100:103], v[136:139], v[156:159], 0
    s_waitcnt lgkmcnt(8)
    ds_read_b128 v[168:171], v241
    buffer_load_dwordx4 v179, s[8:11], s43 offen lds
    v_mfma_f32_16x16x32_bf16 v[104:107], v[140:143], v[148:151], 0
    ds_read_b64_tr_b16 v[136:137], v183 offset:10304
    v_and_b32 v215, 0xffff0000, v197
    v_mfma_f32_16x16x32_bf16 v[108:111], v[140:143], v[152:155], 0
    ds_read_b64_tr_b16 v[138:139], v183 offset:11584
    v_lshlrev_b32 v216, 16, v198
    v_mfma_f32_16x16x32_bf16 v[112:115], v[140:143], v[156:159], 0
    s_waitcnt lgkmcnt(9)
    v_and_b32 v217, 0xffff0000, v198
    v_lshlrev_b32 v218, 16, v199
    v_mfma_f32_16x16x32_bf16 v[116:119], v[144:147], v[148:151], 0
    ds_read_b64_tr_b16 v[140:141], v184 offset:10336
    v_and_b32 v219, 0xffff0000, v199
    v_mfma_f32_16x16x32_bf16 v[120:123], v[144:147], v[152:155], 0
    s_add_u32 m0, s47, 43008
    ds_read_b64_tr_b16 v[142:143], v184 offset:11616
    v_lshlrev_b32 v220, 16, v200
    v_mfma_f32_16x16x32_bf16 v[124:127], v[144:147], v[156:159], 0
    s_waitcnt lgkmcnt(4)
    buffer_load_dwordx4 v174, s[12:15], s44 offen lds
    v_and_b32 v221, 0xffff0000, v200
    v_mfma_f32_16x16x32_bf16 v[8:11], v[128:131], v[160:163], v[8:11]
    ds_read_b64_tr_b16 v[144:145], v183 offset:10368
    v_lshlrev_b32 v222, 16, v201
    v_mfma_f32_16x16x32_bf16 v[12:15], v[128:131], v[164:167], v[12:15]
    s_add_u32 m0, s46, 15360
    ds_read_b64_tr_b16 v[146:147], v183 offset:11648
    v_and_b32 v223, 0xffff0000, v201
    v_mfma_f32_16x16x32_bf16 v[16:19], v[128:131], v[168:171], v[16:19]
    buffer_load_dwordx4 v180, s[8:11], s43 offen lds
    v_add_f32 v192, v204, v205
    v_mfma_f32_16x16x32_bf16 v[20:23], v[132:135], v[160:163], v[20:23]
    ds_read_b64_tr_b16 v[128:129], v184 offset:10400
    v_add_f32 v193, v206, v207
    v_mfma_f32_16x16x32_bf16 v[24:27], v[132:135], v[164:167], v[24:27]
    ds_read_b64_tr_b16 v[130:131], v184 offset:11680
    v_add_f32 v192, v192, v208
    v_mfma_f32_16x16x32_bf16 v[28:31], v[132:135], v[168:171], v[28:31]
    s_waitcnt lgkmcnt(6)
    buffer_store_dwordx4 v[228:231], v203, s[16:19], s67 offen sc1
    v_add_f32 v193, v193, v209
    v_mfma_f32_16x16x32_bf16 v[32:35], v[136:139], v[160:163], v[32:35]
    ds_read_b64_tr_b16 v[132:133], v183 offset:10432
    v_add_f32 v192, v192, v210
    v_mfma_f32_16x16x32_bf16 v[36:39], v[136:139], v[164:167], v[36:39]
    s_add_u32 m0, s47, 44032
    ds_read_b64_tr_b16 v[134:135], v183 offset:11712
    v_add_f32 v193, v193, v211
    v_mfma_f32_16x16x32_bf16 v[40:43], v[136:139], v[168:171], v[40:43]
    s_waitcnt lgkmcnt(6)
    buffer_load_dwordx4 v175, s[12:15], s44 offen lds
    v_add_f32 v192, v192, v212
    v_mfma_f32_16x16x32_bf16 v[44:47], v[140:143], v[160:163], v[44:47]
    ds_read_b64_tr_b16 v[136:137], v184 offset:10464
    v_add_f32 v193, v193, v213
    v_mfma_f32_16x16x32_bf16 v[48:51], v[140:143], v[164:167], v[48:51]
    ds_read_b64_tr_b16 v[138:139], v184 offset:11744
    v_add_f32 v192, v192, v214
    v_mfma_f32_16x16x32_bf16 v[52:55], v[140:143], v[168:171], v[52:55]
    s_waitcnt lgkmcnt(6)
    v_add_f32 v193, v193, v215
    v_add_f32 v192, v192, v216
    v_mfma_f32_16x16x32_bf16 v[56:59], v[144:147], v[160:163], v[56:59]
    ds_read_b64_tr_b16 v[140:141], v183 offset:10496
    v_add_f32 v193, v193, v217
    v_mfma_f32_16x16x32_bf16 v[60:63], v[144:147], v[164:167], v[60:63]
    s_add_u32 m0, s46, 16384
    ds_read_b64_tr_b16 v[142:143], v183 offset:11776
    v_add_f32 v192, v192, v218
    v_mfma_f32_16x16x32_bf16 v[64:67], v[144:147], v[168:171], v[64:67]
    s_waitcnt lgkmcnt(6)
    buffer_load_dwordx4 v181, s[8:11], s43 offen lds
    v_add_f32 v193, v193, v219
    v_mfma_f32_16x16x32_bf16 v[68:71], v[128:131], v[160:163], v[68:71]
    ds_read_b64_tr_b16 v[144:145], v184 offset:10528
    v_add_f32 v192, v192, v220
    v_mfma_f32_16x16x32_bf16 v[72:75], v[128:131], v[164:167], v[72:75]
    ds_read_b64_tr_b16 v[146:147], v184 offset:11808
    v_add_f32 v193, v193, v221
    v_mfma_f32_16x16x32_bf16 v[76:79], v[128:131], v[168:171], v[76:79]
    s_waitcnt vmcnt(13) lgkmcnt(6)
    s_barrier
    v_mfma_f32_16x16x32_bf16 v[80:83], v[132:135], v[160:163], v[80:83]
    ds_read_b64_tr_b16 v[128:129], v183 offset:20480
    v_add_f32 v192, v192, v222
    v_mfma_f32_16x16x32_bf16 v[84:87], v[132:135], v[164:167], v[84:87]
    s_add_u32 m0, s47, 45056
    ds_read_b64_tr_b16 v[130:131], v183 offset:21760
    ds_read_b128 v[148:151], v187 offset:6144
    v_mfma_f32_16x16x32_bf16 v[88:91], v[132:135], v[168:171], v[88:91]
    s_waitcnt lgkmcnt(7)
    buffer_load_dwordx4 v176, s[12:15], s44 offen lds
    v_add_f32 v193, v193, v223
    v_mfma_f32_16x16x32_bf16 v[92:95], v[136:139], v[160:163], v[92:95]
    ds_read_b64_tr_b16 v[132:133], v184 offset:20512
    ds_read_b128 v[152:155], v187 offset:8192
    v_mfma_f32_16x16x32_bf16 v[96:99], v[136:139], v[164:167], v[96:99]
    s_add_u32 s44, s44, s45
    ds_read_b64_tr_b16 v[134:135], v184 offset:21792
    v_add_f32 v192, v192, v193
    v_mfma_f32_16x16x32_bf16 v[100:103], v[136:139], v[168:171], v[100:103]
    s_waitcnt lgkmcnt(8)
    ds_read_b128 v[156:159], v242
    v_add_f32_dpp v192, v192, v192 quad_perm:[1,0,3,2] row_mask:0xf bank_mask:0xf
    v_mfma_f32_16x16x32_bf16 v[104:107], v[140:143], v[160:163], v[104:107]
    ds_read_b64_tr_b16 v[136:137], v183 offset:20544
    v_add_f32_dpp v192, v192, v192 quad_perm:[2,3,0,1] row_mask:0xf bank_mask:0xf
    v_mfma_f32_16x16x32_bf16 v[108:111], v[140:143], v[164:167], v[108:111]
    s_add_u32 m0, s46, 17408
    ds_read_b64_tr_b16 v[138:139], v183 offset:21824
    v_add_f32_dpp v192, v192, v192 row_half_mirror row_mask:0xf bank_mask:0xf
    v_mfma_f32_16x16x32_bf16 v[112:115], v[140:143], v[168:171], v[112:115]
    s_waitcnt lgkmcnt(9)
    buffer_load_dwordx4 v182, s[8:11], s43 offen lds
    v_add_f32_dpp v192, v192, v192 row_mirror row_mask:0xf bank_mask:0xf
    v_mfma_f32_16x16x32_bf16 v[116:119], v[144:147], v[160:163], v[116:119]
    ds_read_b64_tr_b16 v[140:141], v184 offset:20576
    v_mov_b32 v193, v192
    v_mfma_f32_16x16x32_bf16 v[120:123], v[144:147], v[164:167], v[120:123]
    s_add_u32 s43, s43, 128
    ds_read_b64_tr_b16 v[142:143], v184 offset:21856
    v_permlane16_swap_b32 v192, v193
    v_mfma_f32_16x16x32_bf16 v[124:127], v[144:147], v[168:171], v[124:127]
    s_waitcnt lgkmcnt(4)
    v_add_f32 v192, v192, v193
    v_mul_f32 v192, 0x3acccccd, v192
    v_mfma_f32_16x16x32_bf16 v[8:11], v[128:131], v[148:151], v[8:11]
    ds_read_b64_tr_b16 v[144:145], v183 offset:20608
    v_sub_f32 v204, v204, v192
    v_mfma_f32_16x16x32_bf16 v[12:15], v[128:131], v[152:155], v[12:15]
    s_add_u32 m0, s46, 0
    ds_read_b64_tr_b16 v[146:147], v183 offset:21888
    v_sub_f32 v205, v205, v192
    v_mfma_f32_16x16x32_bf16 v[16:19], v[128:131], v[156:159], v[16:19]
    buffer_load_dwordx4 v177, s[8:11], s43 offen lds
    v_sub_f32 v206, v206, v192
    v_mfma_f32_16x16x32_bf16 v[20:23], v[132:135], v[148:151], v[20:23]
    ds_read_b64_tr_b16 v[128:129], v184 offset:20640
    v_sub_f32 v207, v207, v192
    v_mfma_f32_16x16x32_bf16 v[24:27], v[132:135], v[152:155], v[24:27]
    s_add_u32 m0, s47, 61440
    ds_read_b64_tr_b16 v[130:131], v184 offset:21920
    v_sub_f32 v208, v208, v192
    v_mfma_f32_16x16x32_bf16 v[28:31], v[132:135], v[156:159], v[28:31]
    s_waitcnt lgkmcnt(6)
    buffer_load_dwordx4 v172, s[12:15], s44 offen lds
    v_sub_f32 v209, v209, v192
    v_mfma_f32_16x16x32_bf16 v[32:35], v[136:139], v[148:151], v[32:35]
    ds_read_b64_tr_b16 v[132:133], v183 offset:20672
    v_sub_f32 v210, v210, v192
    v_mfma_f32_16x16x32_bf16 v[36:39], v[136:139], v[152:155], v[36:39]
    ds_read_b64_tr_b16 v[134:135], v183 offset:21952
    v_sub_f32 v211, v211, v192
    v_mfma_f32_16x16x32_bf16 v[40:43], v[136:139], v[156:159], v[40:43]
    s_waitcnt lgkmcnt(6)
    buffer_store_dwordx4 v[228:231], v202, s[16:19], s67 offen sc1
    v_sub_f32 v212, v212, v192
    v_mfma_f32_16x16x32_bf16 v[44:47], v[140:143], v[148:151], v[44:47]
    ds_read_b64_tr_b16 v[136:137], v184 offset:20704
    v_sub_f32 v213, v213, v192
    v_mfma_f32_16x16x32_bf16 v[48:51], v[140:143], v[152:155], v[48:51]
    s_add_u32 m0, s46, 1024
    ds_read_b64_tr_b16 v[138:139], v184 offset:21984
    v_sub_f32 v214, v214, v192
    v_mfma_f32_16x16x32_bf16 v[52:55], v[140:143], v[156:159], v[52:55]
    s_waitcnt lgkmcnt(6)
    buffer_load_dwordx4 v178, s[8:11], s43 offen lds
    v_sub_f32 v215, v215, v192
    v_mfma_f32_16x16x32_bf16 v[56:59], v[144:147], v[148:151], v[56:59]
    ds_read_b64_tr_b16 v[140:141], v183 offset:20736
    v_sub_f32 v216, v216, v192
    v_mfma_f32_16x16x32_bf16 v[60:63], v[144:147], v[152:155], v[60:63]
    ds_read_b64_tr_b16 v[142:143], v183 offset:22016
    v_sub_f32 v217, v217, v192
    v_mfma_f32_16x16x32_bf16 v[64:67], v[144:147], v[156:159], v[64:67]
    s_waitcnt lgkmcnt(6)
    v_sub_f32 v218, v218, v192
    v_sub_f32 v219, v219, v192
    v_mfma_f32_16x16x32_bf16 v[68:71], v[128:131], v[148:151], v[68:71]
    ds_read_b64_tr_b16 v[144:145], v184 offset:20768
    v_sub_f32 v220, v220, v192
    v_mfma_f32_16x16x32_bf16 v[72:75], v[128:131], v[152:155], v[72:75]
    s_add_u32 m0, s47, 62464
    ds_read_b64_tr_b16 v[146:147], v184 offset:22048
    v_sub_f32 v221, v221, v192
    v_mfma_f32_16x16x32_bf16 v[76:79], v[128:131], v[156:159], v[76:79]
    s_waitcnt lgkmcnt(6)
    buffer_load_dwordx4 v173, s[12:15], s44 offen lds
    v_sub_f32 v222, v222, v192
    v_mfma_f32_16x16x32_bf16 v[80:83], v[132:135], v[148:151], v[80:83]
    ds_read_b64_tr_b16 v[128:129], v183 offset:30720
    v_sub_f32 v223, v223, v192
    v_mfma_f32_16x16x32_bf16 v[84:87], v[132:135], v[152:155], v[84:87]
    ds_read_b64_tr_b16 v[130:131], v183 offset:32000
    ds_read_b128 v[160:163], v188 offset:6144
    v_mfma_f32_16x16x32_bf16 v[88:91], v[132:135], v[156:159], v[88:91]
    s_waitcnt lgkmcnt(7)
    buffer_store_dwordx4 v[232:235], v203, s[16:19], s68 offen sc1
    v_mul_f32 v193, v204, v204
    v_mfma_f32_16x16x32_bf16 v[92:95], v[136:139], v[148:151], v[92:95]
    ds_read_b64_tr_b16 v[132:133], v184 offset:30752
    ds_read_b128 v[164:167], v188 offset:8192
    v_mfma_f32_16x16x32_bf16 v[96:99], v[136:139], v[152:155], v[96:99]
    s_add_u32 m0, s46, 2048
    ds_read_b64_tr_b16 v[134:135], v184 offset:32032
    v_mul_f32 v194, v205, v205
    v_mfma_f32_16x16x32_bf16 v[100:103], v[136:139], v[156:159], v[100:103]
    s_waitcnt lgkmcnt(8)
    ds_read_b128 v[168:171], v243
    buffer_load_dwordx4 v179, s[8:11], s43 offen lds
    v_mfma_f32_16x16x32_bf16 v[104:107], v[140:143], v[148:151], v[104:107]
    ds_read_b64_tr_b16 v[136:137], v183 offset:30784
    v_fmac_f32 v193, v206, v206
    v_mfma_f32_16x16x32_bf16 v[108:111], v[140:143], v[152:155], v[108:111]
    ds_read_b64_tr_b16 v[138:139], v183 offset:32064
    v_fmac_f32 v194, v207, v207
    v_mfma_f32_16x16x32_bf16 v[112:115], v[140:143], v[156:159], v[112:115]
    s_waitcnt lgkmcnt(9)
    v_fmac_f32 v193, v208, v208
    v_fmac_f32 v194, v209, v209
    v_mfma_f32_16x16x32_bf16 v[116:119], v[144:147], v[148:151], v[116:119]
    ds_read_b64_tr_b16 v[140:141], v184 offset:30816
    v_fmac_f32 v193, v210, v210
    v_mfma_f32_16x16x32_bf16 v[120:123], v[144:147], v[152:155], v[120:123]
    s_add_u32 m0, s47, 63488
    ds_read_b64_tr_b16 v[142:143], v184 offset:32096
    v_fmac_f32 v194, v211, v211
    v_mfma_f32_16x16x32_bf16 v[124:127], v[144:147], v[156:159], v[124:127]
    s_waitcnt lgkmcnt(4)
    buffer_load_dwordx4 v174, s[12:15], s44 offen lds
    v_fmac_f32 v193, v212, v212
    v_mfma_f32_16x16x32_bf16 v[8:11], v[128:131], v[160:163], v[8:11]
    ds_read_b64_tr_b16 v[144:145], v183 offset:30848
    v_fmac_f32 v194, v213, v213
    v_mfma_f32_16x16x32_bf16 v[12:15], v[128:131], v[164:167], v[12:15]
    s_add_u32 m0, s46, 3072
    ds_read_b64_tr_b16 v[146:147], v183 offset:32128
    v_fmac_f32 v193, v214, v214
    v_mfma_f32_16x16x32_bf16 v[16:19], v[128:131], v[168:171], v[16:19]
    buffer_load_dwordx4 v180, s[8:11], s43 offen lds
    v_fmac_f32 v194, v215, v215
    v_mfma_f32_16x16x32_bf16 v[20:23], v[132:135], v[160:163], v[20:23]
    ds_read_b64_tr_b16 v[128:129], v184 offset:30880
    v_fmac_f32 v193, v216, v216
    v_mfma_f32_16x16x32_bf16 v[24:27], v[132:135], v[164:167], v[24:27]
    ds_read_b64_tr_b16 v[130:131], v184 offset:32160
    v_fmac_f32 v194, v217, v217
    v_mfma_f32_16x16x32_bf16 v[28:31], v[132:135], v[168:171], v[28:31]
    s_waitcnt lgkmcnt(6)
    buffer_store_dwordx4 v[232:235], v202, s[16:19], s68 offen sc1
    v_fmac_f32 v193, v218, v218
    v_mfma_f32_16x16x32_bf16 v[32:35], v[136:139], v[160:163], v[32:35]
    ds_read_b64_tr_b16 v[132:133], v183 offset:30912
    v_fmac_f32 v194, v219, v219
    v_mfma_f32_16x16x32_bf16 v[36:39], v[136:139], v[164:167], v[36:39]
    s_add_u32 m0, s47, 64512
    ds_read_b64_tr_b16 v[134:135], v183 offset:32192
    v_fmac_f32 v193, v220, v220
    v_mfma_f32_16x16x32_bf16 v[40:43], v[136:139], v[168:171], v[40:43]
    s_waitcnt lgkmcnt(6)
    buffer_load_dwordx4 v175, s[12:15], s44 offen lds
    v_fmac_f32 v194, v221, v221
    v_mfma_f32_16x16x32_bf16 v[44:47], v[140:143], v[160:163], v[44:47]
    ds_read_b64_tr_b16 v[136:137], v184 offset:30944
    v_fmac_f32 v193, v222, v222
    v_mfma_f32_16x16x32_bf16 v[48:51], v[140:143], v[164:167], v[48:51]
    ds_read_b64_tr_b16 v[138:139], v184 offset:32224
    v_fmac_f32 v194, v223, v223
    v_mfma_f32_16x16x32_bf16 v[52:55], v[140:143], v[168:171], v[52:55]
    s_waitcnt lgkmcnt(6)
    v_add_f32 v193, v193, v194
    s_nop 1
    v_add_f32_dpp v193, v193, v193 quad_perm:[1,0,3,2] row_mask:0xf bank_mask:0xf
    v_mfma_f32_16x16x32_bf16 v[56:59], v[144:147], v[160:163], v[56:59]
    ds_read_b64_tr_b16 v[140:141], v183 offset:30976
    v_add_f32_dpp v193, v193, v193 quad_perm:[2,3,0,1] row_mask:0xf bank_mask:0xf
    v_mfma_f32_16x16x32_bf16 v[60:63], v[144:147], v[164:167], v[60:63]
    s_add_u32 m0, s46, 4096
    ds_read_b64_tr_b16 v[142:143], v183 offset:32256
    v_add_f32_dpp v193, v193, v193 row_half_mirror row_mask:0xf bank_mask:0xf
    v_mfma_f32_16x16x32_bf16 v[64:67], v[144:147], v[168:171], v[64:67]
    s_waitcnt lgkmcnt(6)
    buffer_load_dwordx4 v181, s[8:11], s43 offen lds
    v_add_f32_dpp v193, v193, v193 row_mirror row_mask:0xf bank_mask:0xf
    v_mfma_f32_16x16x32_bf16 v[68:71], v[128:131], v[160:163], v[68:71]
    ds_read_b64_tr_b16 v[144:145], v184 offset:31008
    v_mov_b32 v194, v193
    v_mfma_f32_16x16x32_bf16 v[72:75], v[128:131], v[164:167], v[72:75]
    ds_read_b64_tr_b16 v[146:147], v184 offset:32288
    v_permlane16_swap_b32 v193, v194
    v_mfma_f32_16x16x32_bf16 v[76:79], v[128:131], v[168:171], v[76:79]
    s_waitcnt vmcnt(12) lgkmcnt(6)
    s_barrier
    v_mfma_f32_16x16x32_bf16 v[80:83], v[132:135], v[160:163], v[80:83]
    ds_read_b64_tr_b16 v[128:129], v185 offset:0
    v_add_f32 v193, v193, v194
    v_mfma_f32_16x16x32_bf16 v[84:87], v[132:135], v[164:167], v[84:87]
    s_add_u32 m0, s47, 65536
    ds_read_b64_tr_b16 v[130:131], v185 offset:1280
    ds_read_b128 v[148:151], v187 offset:12288
    v_mfma_f32_16x16x32_bf16 v[88:91], v[132:135], v[168:171], v[88:91]
    s_waitcnt lgkmcnt(7)
    buffer_load_dwordx4 v176, s[12:15], s44 offen lds
    v_mov_b32 v194, 0x3727c5ac
    v_mfma_f32_16x16x32_bf16 v[92:95], v[136:139], v[160:163], v[92:95]
    ds_read_b64_tr_b16 v[132:133], v186 offset:32
    ds_read_b128 v[152:155], v187 offset:14336
    v_mfma_f32_16x16x32_bf16 v[96:99], v[136:139], v[164:167], v[96:99]
    s_add_u32 s44, s44, s45
    ds_read_b64_tr_b16 v[134:135], v186 offset:1312
    v_fmac_f32 v194, 0x3acccccd, v193
    v_mfma_f32_16x16x32_bf16 v[100:103], v[136:139], v[168:171], v[100:103]
    s_waitcnt lgkmcnt(8)
    ds_read_b128 v[156:159], v244
    v_mfma_f32_16x16x32_bf16 v[104:107], v[140:143], v[160:163], v[104:107]
    ds_read_b64_tr_b16 v[136:137], v185 offset:64
    v_mfma_f32_16x16x32_bf16 v[108:111], v[140:143], v[164:167], v[108:111]
    s_add_u32 m0, s46, 5120
    ds_read_b64_tr_b16 v[138:139], v185 offset:1344
    v_mfma_f32_16x16x32_bf16 v[112:115], v[140:143], v[168:171], v[112:115]
    s_waitcnt lgkmcnt(9)
    buffer_load_dwordx4 v182, s[8:11], s43 offen lds
    v_mfma_f32_16x16x32_bf16 v[116:119], v[144:147], v[160:163], v[116:119]
    ds_read_b64_tr_b16 v[140:141], v186 offset:96
    v_mfma_f32_16x16x32_bf16 v[120:123], v[144:147], v[164:167], v[120:123]
    s_add_u32 s43, s43, 128
    ds_read_b64_tr_b16 v[142:143], v186 offset:1376
    v_mfma_f32_16x16x32_bf16 v[124:127], v[144:147], v[168:171], v[124:127]
    s_waitcnt lgkmcnt(4)
    v_rsq_f32 v193, v194
    v_mfma_f32_16x16x32_bf16 v[8:11], v[128:131], v[148:151], v[8:11]
    ds_read_b64_tr_b16 v[144:145], v185 offset:128
    v_mov_b32 v194, v192
    v_mfma_f32_16x16x32_bf16 v[12:15], v[128:131], v[152:155], v[12:15]
    s_add_u32 m0, s46, 6144
    ds_read_b64_tr_b16 v[146:147], v185 offset:1408
    v_mov_b32 v195, v193
    v_mfma_f32_16x16x32_bf16 v[16:19], v[128:131], v[156:159], v[16:19]
    buffer_load_dwordx4 v177, s[8:11], s43 offen lds
    v_permlane32_swap_b32 v192, v194
    v_mfma_f32_16x16x32_bf16 v[20:23], v[132:135], v[148:151], v[20:23]
    ds_read_b64_tr_b16 v[128:129], v186 offset:160
    v_permlane32_swap_b32 v193, v195
    v_mfma_f32_16x16x32_bf16 v[24:27], v[132:135], v[152:155], v[24:27]
    s_add_u32 m0, s47, 0
    ds_read_b64_tr_b16 v[130:131], v186 offset:1440
    v_mfma_f32_16x16x32_bf16 v[28:31], v[132:135], v[156:159], v[28:31]
    s_waitcnt lgkmcnt(6)
    buffer_load_dwordx4 v172, s[12:15], s44 offen lds
    v_mfma_f32_16x16x32_bf16 v[32:35], v[136:139], v[148:151], v[32:35]
    ds_read_b64_tr_b16 v[132:133], v185 offset:192
    s_mov_b64 exec, 15
    buffer_store_dwordx4 v[192:195], v3, s[20:23], s51 offen sc1
    s_mov_b64 exec, -1
    v_mfma_f32_16x16x32_bf16 v[36:39], v[136:139], v[152:155], v[36:39]
    ds_read_b64_tr_b16 v[134:135], v185 offset:1472
    v_mfma_f32_16x16x32_bf16 v[40:43], v[136:139], v[156:159], v[40:43]
    s_waitcnt lgkmcnt(6)
    buffer_store_dwordx4 v[236:239], v203, s[16:19], s69 offen sc1
    v_mfma_f32_16x16x32_bf16 v[44:47], v[140:143], v[148:151], v[44:47]
    ds_read_b64_tr_b16 v[136:137], v186 offset:224
    v_mfma_f32_16x16x32_bf16 v[48:51], v[140:143], v[152:155], v[48:51]
    s_add_u32 m0, s46, 7168
    ds_read_b64_tr_b16 v[138:139], v186 offset:1504
    v_mfma_f32_16x16x32_bf16 v[52:55], v[140:143], v[156:159], v[52:55]
    s_waitcnt lgkmcnt(6)
    buffer_load_dwordx4 v178, s[8:11], s43 offen lds
    v_mfma_f32_16x16x32_bf16 v[56:59], v[144:147], v[148:151], v[56:59]
    ds_read_b64_tr_b16 v[140:141], v185 offset:256
    v_mfma_f32_16x16x32_bf16 v[60:63], v[144:147], v[152:155], v[60:63]
    ds_read_b64_tr_b16 v[142:143], v185 offset:1536
    v_mfma_f32_16x16x32_bf16 v[64:67], v[144:147], v[156:159], v[64:67]
    s_waitcnt lgkmcnt(6)
    v_mfma_f32_16x16x32_bf16 v[68:71], v[128:131], v[148:151], v[68:71]
    ds_read_b64_tr_b16 v[144:145], v186 offset:288
    v_mfma_f32_16x16x32_bf16 v[72:75], v[128:131], v[152:155], v[72:75]
    s_add_u32 m0, s47, 1024
    ds_read_b64_tr_b16 v[146:147], v186 offset:1568
    v_mfma_f32_16x16x32_bf16 v[76:79], v[128:131], v[156:159], v[76:79]
    s_waitcnt lgkmcnt(6)
    buffer_load_dwordx4 v173, s[12:15], s44 offen lds
    v_mfma_f32_16x16x32_bf16 v[80:83], v[132:135], v[148:151], v[80:83]
    ds_read_b64_tr_b16 v[128:129], v185 offset:10240
    v_mfma_f32_16x16x32_bf16 v[84:87], v[132:135], v[152:155], v[84:87]
    ds_read_b64_tr_b16 v[130:131], v185 offset:11520
    ds_read_b128 v[160:163], v188 offset:12288
    v_mfma_f32_16x16x32_bf16 v[88:91], v[132:135], v[156:159], v[88:91]
    s_waitcnt lgkmcnt(7)
    buffer_store_dwordx4 v[236:239], v202, s[16:19], s69 offen sc1
    v_mfma_f32_16x16x32_bf16 v[92:95], v[136:139], v[148:151], v[92:95]
    ds_read_b64_tr_b16 v[132:133], v186 offset:10272
    ds_read_b128 v[164:167], v188 offset:14336
    v_mfma_f32_16x16x32_bf16 v[96:99], v[136:139], v[152:155], v[96:99]
    s_add_u32 m0, s46, 8192
    ds_read_b64_tr_b16 v[134:135], v186 offset:11552
    v_mfma_f32_16x16x32_bf16 v[100:103], v[136:139], v[156:159], v[100:103]
    s_waitcnt lgkmcnt(8)
    ds_read_b128 v[168:171], v245
    buffer_load_dwordx4 v179, s[8:11], s43 offen lds
    v_mfma_f32_16x16x32_bf16 v[104:107], v[140:143], v[148:151], v[104:107]
    ds_read_b64_tr_b16 v[136:137], v185 offset:10304
    v_mfma_f32_16x16x32_bf16 v[108:111], v[140:143], v[152:155], v[108:111]
    ds_read_b64_tr_b16 v[138:139], v185 offset:11584
    v_mfma_f32_16x16x32_bf16 v[112:115], v[140:143], v[156:159], v[112:115]
    s_waitcnt lgkmcnt(9)
    v_mfma_f32_16x16x32_bf16 v[116:119], v[144:147], v[148:151], v[116:119]
    ds_read_b64_tr_b16 v[140:141], v186 offset:10336
    v_mfma_f32_16x16x32_bf16 v[120:123], v[144:147], v[152:155], v[120:123]
    s_add_u32 m0, s47, 2048
    ds_read_b64_tr_b16 v[142:143], v186 offset:11616
    v_mfma_f32_16x16x32_bf16 v[124:127], v[144:147], v[156:159], v[124:127]
    s_waitcnt lgkmcnt(4)
    buffer_load_dwordx4 v174, s[12:15], s44 offen lds
    v_mfma_f32_16x16x32_bf16 v[8:11], v[128:131], v[160:163], v[8:11]
    ds_read_b64_tr_b16 v[144:145], v185 offset:10368
    v_mfma_f32_16x16x32_bf16 v[12:15], v[128:131], v[164:167], v[12:15]
    s_add_u32 m0, s46, 9216
    ds_read_b64_tr_b16 v[146:147], v185 offset:11648
    v_mfma_f32_16x16x32_bf16 v[16:19], v[128:131], v[168:171], v[16:19]
    buffer_load_dwordx4 v180, s[8:11], s43 offen lds
    v_mfma_f32_16x16x32_bf16 v[20:23], v[132:135], v[160:163], v[20:23]
    ds_read_b64_tr_b16 v[128:129], v186 offset:10400
    v_mfma_f32_16x16x32_bf16 v[24:27], v[132:135], v[164:167], v[24:27]
    ds_read_b64_tr_b16 v[130:131], v186 offset:11680
    v_mfma_f32_16x16x32_bf16 v[28:31], v[132:135], v[168:171], v[28:31]
    s_waitcnt lgkmcnt(6)
    v_mfma_f32_16x16x32_bf16 v[32:35], v[136:139], v[160:163], v[32:35]
    ds_read_b64_tr_b16 v[132:133], v185 offset:10432
    v_mfma_f32_16x16x32_bf16 v[36:39], v[136:139], v[164:167], v[36:39]
    s_add_u32 m0, s47, 3072
    ds_read_b64_tr_b16 v[134:135], v185 offset:11712
    v_mfma_f32_16x16x32_bf16 v[40:43], v[136:139], v[168:171], v[40:43]
    s_waitcnt lgkmcnt(6)
    buffer_load_dwordx4 v175, s[12:15], s44 offen lds
    v_mfma_f32_16x16x32_bf16 v[44:47], v[140:143], v[160:163], v[44:47]
    ds_read_b64_tr_b16 v[136:137], v186 offset:10464
    v_mfma_f32_16x16x32_bf16 v[48:51], v[140:143], v[164:167], v[48:51]
    ds_read_b64_tr_b16 v[138:139], v186 offset:11744
    v_mfma_f32_16x16x32_bf16 v[52:55], v[140:143], v[168:171], v[52:55]
    s_waitcnt lgkmcnt(6)
    v_mfma_f32_16x16x32_bf16 v[56:59], v[144:147], v[160:163], v[56:59]
    ds_read_b64_tr_b16 v[140:141], v185 offset:10496
    v_mfma_f32_16x16x32_bf16 v[60:63], v[144:147], v[164:167], v[60:63]
    s_add_u32 m0, s46, 10240
    ds_read_b64_tr_b16 v[142:143], v185 offset:11776
    v_mfma_f32_16x16x32_bf16 v[64:67], v[144:147], v[168:171], v[64:67]
    s_waitcnt lgkmcnt(6)
    buffer_load_dwordx4 v181, s[8:11], s43 offen lds
    v_mfma_f32_16x16x32_bf16 v[68:71], v[128:131], v[160:163], v[68:71]
    ds_read_b64_tr_b16 v[144:145], v186 offset:10528
    v_mfma_f32_16x16x32_bf16 v[72:75], v[128:131], v[164:167], v[72:75]
    ds_read_b64_tr_b16 v[146:147], v186 offset:11808
    v_mfma_f32_16x16x32_bf16 v[76:79], v[128:131], v[168:171], v[76:79]
    s_waitcnt vmcnt(12) lgkmcnt(6)
    s_barrier
    v_mfma_f32_16x16x32_bf16 v[80:83], v[132:135], v[160:163], v[80:83]
    ds_read_b64_tr_b16 v[128:129], v185 offset:20480
    v_mfma_f32_16x16x32_bf16 v[84:87], v[132:135], v[164:167], v[84:87]
    s_add_u32 m0, s47, 4096
    ds_read_b64_tr_b16 v[130:131], v185 offset:21760
    ds_read_b128 v[148:151], v187 offset:0
    v_mfma_f32_16x16x32_bf16 v[88:91], v[132:135], v[168:171], v[88:91]
    s_waitcnt lgkmcnt(7)
    buffer_load_dwordx4 v176, s[12:15], s44 offen lds
    v_mfma_f32_16x16x32_bf16 v[92:95], v[136:139], v[160:163], v[92:95]
    ds_read_b64_tr_b16 v[132:133], v186 offset:20512
    ds_read_b128 v[152:155], v187 offset:2048
    v_mfma_f32_16x16x32_bf16 v[96:99], v[136:139], v[164:167], v[96:99]
    s_add_u32 s44, s44, s45
    ds_read_b64_tr_b16 v[134:135], v186 offset:21792
    v_mfma_f32_16x16x32_bf16 v[100:103], v[136:139], v[168:171], v[100:103]
    s_waitcnt lgkmcnt(8)
    ds_read_b128 v[156:159], v240
    v_mfma_f32_16x16x32_bf16 v[104:107], v[140:143], v[160:163], v[104:107]
    ds_read_b64_tr_b16 v[136:137], v185 offset:20544
    v_mfma_f32_16x16x32_bf16 v[108:111], v[140:143], v[164:167], v[108:111]
    s_add_u32 m0, s46, 11264
    ds_read_b64_tr_b16 v[138:139], v185 offset:21824
    v_mfma_f32_16x16x32_bf16 v[112:115], v[140:143], v[168:171], v[112:115]
    s_waitcnt lgkmcnt(9)
    buffer_load_dwordx4 v182, s[8:11], s43 offen lds
    v_mfma_f32_16x16x32_bf16 v[116:119], v[144:147], v[160:163], v[116:119]
    ds_read_b64_tr_b16 v[140:141], v186 offset:20576
    v_mfma_f32_16x16x32_bf16 v[120:123], v[144:147], v[164:167], v[120:123]
    s_add_u32 s43, s43, 128
    ds_read_b64_tr_b16 v[142:143], v186 offset:21856
    v_mfma_f32_16x16x32_bf16 v[124:127], v[144:147], v[168:171], v[124:127]
    s_waitcnt lgkmcnt(4)
    v_mfma_f32_16x16x32_bf16 v[8:11], v[128:131], v[148:151], v[8:11]
    ds_read_b64_tr_b16 v[144:145], v185 offset:20608
    v_mov_b32 v6, 0
    v_mfma_f32_16x16x32_bf16 v[12:15], v[128:131], v[152:155], v[12:15]
L_st1:
    s_cbranch_execz L_st5
    s_add_u32 m0, s46, 12288
    ds_read_b64_tr_b16 v[146:147], v185 offset:21888
    v_mfma_f32_16x16x32_bf16 v[16:19], v[128:131], v[156:159], v[16:19]
    buffer_load_dwordx4 v177, s[8:11], s43 offen lds
    v_mfma_f32_16x16x32_bf16 v[20:23], v[132:135], v[148:151], v[20:23]
    ds_read_b64_tr_b16 v[128:129], v186 offset:20640
    buffer_load_dword v5, v6, s[24:27], 0 offen sc1
    v_mfma_f32_16x16x32_bf16 v[24:27], v[132:135], v[152:155], v[24:27]
    s_add_u32 m0, s47, 20480
    ds_read_b64_tr_b16 v[130:131], v186 offset:21920
    v_mfma_f32_16x16x32_bf16 v[28:31], v[132:135], v[156:159], v[28:31]
    s_waitcnt lgkmcnt(6)
    buffer_load_dwordx4 v172, s[12:15], s44 offen lds
    v_mfma_f32_16x16x32_bf16 v[32:35], v[136:139], v[148:151], v[32:35]
    ds_read_b64_tr_b16 v[132:133], v185 offset:20672
    v_mfma_f32_16x16x32_bf16 v[36:39], v[136:139], v[152:155], v[36:39]
    ds_read_b64_tr_b16 v[134:135], v185 offset:21952
    v_mfma_f32_16x16x32_bf16 v[40:43], v[136:139], v[156:159], v[40:43]
    s_waitcnt lgkmcnt(6)
    v_mfma_f32_16x16x32_bf16 v[44:47], v[140:143], v[148:151], v[44:47]
    ds_read_b64_tr_b16 v[136:137], v186 offset:20704
    v_mfma_f32_16x16x32_bf16 v[48:51], v[140:143], v[152:155], v[48:51]
    s_add_u32 m0, s46, 13312
    ds_read_b64_tr_b16 v[138:139], v186 offset:21984
    v_mfma_f32_16x16x32_bf16 v[52:55], v[140:143], v[156:159], v[52:55]
    s_waitcnt lgkmcnt(6)
    buffer_load_dwordx4 v178, s[8:11], s43 offen lds
    v_mfma_f32_16x16x32_bf16 v[56:59], v[144:147], v[148:151], v[56:59]
    ds_read_b64_tr_b16 v[140:141], v185 offset:20736
    v_mfma_f32_16x16x32_bf16 v[60:63], v[144:147], v[152:155], v[60:63]
    ds_read_b64_tr_b16 v[142:143], v185 offset:22016
    v_mfma_f32_16x16x32_bf16 v[64:67], v[144:147], v[156:159], v[64:67]
    s_waitcnt lgkmcnt(6)
    v_mfma_f32_16x16x32_bf16 v[68:71], v[128:131], v[148:151], v[68:71]
    ds_read_b64_tr_b16 v[144:145], v186 offset:20768
    v_mfma_f32_16x16x32_bf16 v[72:75], v[128:131], v[152:155], v[72:75]
    s_add_u32 m0, s47, 21504
    ds_read_b64_tr_b16 v[146:147], v186 offset:22048
    v_mfma_f32_16x16x32_bf16 v[76:79], v[128:131], v[156:159], v[76:79]
    s_waitcnt lgkmcnt(6)
    buffer_load_dwordx4 v173, s[12:15], s44 offen lds
    v_mfma_f32_16x16x32_bf16 v[80:83], v[132:135], v[148:151], v[80:83]
    ds_read_b64_tr_b16 v[128:129], v185 offset:30720
    v_mfma_f32_16x16x32_bf16 v[84:87], v[132:135], v[152:155], v[84:87]
    ds_read_b64_tr_b16 v[130:131], v185 offset:32000
    ds_read_b128 v[160:163], v188 offset:0
    v_mfma_f32_16x16x32_bf16 v[88:91], v[132:135], v[156:159], v[88:91]
    s_waitcnt lgkmcnt(7)
    v_mfma_f32_16x16x32_bf16 v[92:95], v[136:139], v[148:151], v[92:95]
    ds_read_b64_tr_b16 v[132:133], v186 offset:30752
    ds_read_b128 v[164:167], v188 offset:2048
    v_mfma_f32_16x16x32_bf16 v[96:99], v[136:139], v[152:155], v[96:99]
    s_add_u32 m0, s46, 14336
    ds_read_b64_tr_b16 v[134:135], v186 offset:32032
    v_mfma_f32_16x16x32_bf16 v[100:103], v[136:139], v[156:159], v[100:103]
    s_waitcnt lgkmcnt(8)
    ds_read_b128 v[168:171], v241
    buffer_load_dwordx4 v179, s[8:11], s43 offen lds
    v_mfma_f32_16x16x32_bf16 v[104:107], v[140:143], v[148:151], v[104:107]
    ds_read_b64_tr_b16 v[136:137], v185 offset:30784
    v_mfma_f32_16x16x32_bf16 v[108:111], v[140:143], v[152:155], v[108:111]
    ds_read_b64_tr_b16 v[138:139], v185 offset:32064
    v_mfma_f32_16x16x32_bf16 v[112:115], v[140:143], v[156:159], v[112:115]
    s_waitcnt lgkmcnt(9)
    v_mfma_f32_16x16x32_bf16 v[116:119], v[144:147], v[148:151], v[116:119]
    ds_read_b64_tr_b16 v[140:141], v186 offset:30816
    v_mfma_f32_16x16x32_bf16 v[120:123], v[144:147], v[152:155], v[120:123]
    s_add_u32 m0, s47, 22528
    ds_read_b64_tr_b16 v[142:143], v186 offset:32096
    v_mfma_f32_16x16x32_bf16 v[124:127], v[144:147], v[156:159], v[124:127]
    s_waitcnt lgkmcnt(4)
    buffer_load_dwordx4 v174, s[12:15], s44 offen lds
    v_mfma_f32_16x16x32_bf16 v[8:11], v[128:131], v[160:163], v[8:11]
    ds_read_b64_tr_b16 v[144:145], v185 offset:30848
    v_mfma_f32_16x16x32_bf16 v[12:15], v[128:131], v[164:167], v[12:15]
    s_add_u32 m0, s46, 15360
    ds_read_b64_tr_b16 v[146:147], v185 offset:32128
    v_mfma_f32_16x16x32_bf16 v[16:19], v[128:131], v[168:171], v[16:19]
    buffer_load_dwordx4 v180, s[8:11], s43 offen lds
    v_mfma_f32_16x16x32_bf16 v[20:23], v[132:135], v[160:163], v[20:23]
    ds_read_b64_tr_b16 v[128:129], v186 offset:30880
    v_mfma_f32_16x16x32_bf16 v[24:27], v[132:135], v[164:167], v[24:27]
    ds_read_b64_tr_b16 v[130:131], v186 offset:32160
    v_mfma_f32_16x16x32_bf16 v[28:31], v[132:135], v[168:171], v[28:31]
    s_waitcnt lgkmcnt(6)
    v_mfma_f32_16x16x32_bf16 v[32:35], v[136:139], v[160:163], v[32:35]
    ds_read_b64_tr_b16 v[132:133], v185 offset:30912
    v_mfma_f32_16x16x32_bf16 v[36:39], v[136:139], v[164:167], v[36:39]
    s_add_u32 m0, s47, 23552
    ds_read_b64_tr_b16 v[134:135], v185 offset:32192
    v_mfma_f32_16x16x32_bf16 v[40:43], v[136:139], v[168:171], v[40:43]
    s_waitcnt lgkmcnt(6)
    buffer_load_dwordx4 v175, s[12:15], s44 offen lds
    v_mfma_f32_16x16x32_bf16 v[44:47], v[140:143], v[160:163], v[44:47]
    ds_read_b64_tr_b16 v[136:137], v186 offset:30944
    v_mfma_f32_16x16x32_bf16 v[48:51], v[140:143], v[164:167], v[48:51]
    ds_read_b64_tr_b16 v[138:139], v186 offset:32224
    v_mfma_f32_16x16x32_bf16 v[52:55], v[140:143], v[168:171], v[52:55]
    s_waitcnt lgkmcnt(6)
    v_mfma_f32_16x16x32_bf16 v[56:59], v[144:147], v[160:163], v[56:59]
    ds_read_b64_tr_b16 v[140:141], v185 offset:30976
    v_mfma_f32_16x16x32_bf16 v[60:63], v[144:147], v[164:167], v[60:63]
    s_add_u32 m0, s46, 16384
    ds_read_b64_tr_b16 v[142:143], v185 offset:32256
    v_mfma_f32_16x16x32_bf16 v[64:67], v[144:147], v[168:171], v[64:67]
    s_waitcnt lgkmcnt(6)
    buffer_load_dwordx4 v181, s[8:11], s43 offen lds
    v_mfma_f32_16x16x32_bf16 v[68:71], v[128:131], v[160:163], v[68:71]
    ds_read_b64_tr_b16 v[144:145], v186 offset:31008
    v_mfma_f32_16x16x32_bf16 v[72:75], v[128:131], v[164:167], v[72:75]
    ds_read_b64_tr_b16 v[146:147], v186 offset:32288
    v_mfma_f32_16x16x32_bf16 v[76:79], v[128:131], v[168:171], v[76:79]
    s_waitcnt vmcnt(10) lgkmcnt(6)
    s_barrier
    v_mfma_f32_16x16x32_bf16 v[80:83], v[132:135], v[160:163], v[80:83]
    ds_read_b64_tr_b16 v[128:129], v183 offset:0
    v_mfma_f32_16x16x32_bf16 v[84:87], v[132:135], v[164:167], v[84:87]
    s_add_u32 m0, s47, 24576
    ds_read_b64_tr_b16 v[130:131], v183 offset:1280
    ds_read_b128 v[148:151], v187 offset:6144
    v_mfma_f32_16x16x32_bf16 v[88:91], v[132:135], v[168:171], v[88:91]
    s_waitcnt lgkmcnt(7)
    buffer_load_dwordx4 v176, s[12:15], s44 offen lds
    v_mfma_f32_16x16x32_bf16 v[92:95], v[136:139], v[160:163], v[92:95]
    ds_read_b64_tr_b16 v[132:133], v184 offset:32
    ds_read_b128 v[152:155], v187 offset:8192
    v_mfma_f32_16x16x32_bf16 v[96:99], v[136:139], v[164:167], v[96:99]
    s_add_u32 s44, s44, s45
    ds_read_b64_tr_b16 v[134:135], v184 offset:1312
    v_mfma_f32_16x16x32_bf16 v[100:103], v[136:139], v[168:171], v[100:103]
    s_waitcnt lgkmcnt(8)
    ds_read_b128 v[156:159], v242
    v_mfma_f32_16x16x32_bf16 v[104:107], v[140:143], v[160:163], v[104:107]
    ds_read_b64_tr_b16 v[136:137], v183 offset:64
    s_lshr_b32 s3, s2, 3
    v_mfma_f32_16x16x32_bf16 v[108:111], v[140:143], v[164:167], v[108:111]
    s_add_u32 m0, s46, 17408
    ds_read_b64_tr_b16 v[138:139], v183 offset:1344
    v_mfma_f32_16x16x32_bf16 v[112:115], v[140:143], v[168:171], v[112:115]
    s_waitcnt lgkmcnt(9)
    buffer_load_dwordx4 v182, s[8:11], s43 offen lds
    v_mfma_f32_16x16x32_bf16 v[116:119], v[144:147], v[160:163], v[116:119]
    ds_read_b64_tr_b16 v[140:141], v184 offset:96
    s_lshl_b32 s3, s3, 7
    v_mfma_f32_16x16x32_bf16 v[120:123], v[144:147], v[164:167], v[120:123]
    s_add_u32 s43, s43, 128
    ds_read_b64_tr_b16 v[142:143], v184 offset:1376
    v_mfma_f32_16x16x32_bf16 v[124:127], v[144:147], v[168:171], v[124:127]
    s_waitcnt lgkmcnt(4)
    v_mfma_f32_16x16x32_bf16 v[8:11], v[128:131], v[148:151], v[8:11]
    ds_read_b64_tr_b16 v[144:145], v183 offset:128
    s_add_u32 s3, s3, 294912
    v_mfma_f32_16x16x32_bf16 v[12:15], v[128:131], v[152:155], v[12:15]
    s_add_u32 m0, s46, 0
    ds_read_b64_tr_b16 v[146:147], v183 offset:1408
    v_mfma_f32_16x16x32_bf16 v[16:19], v[128:131], v[156:159], v[16:19]
    buffer_load_dwordx4 v177, s[8:11], s43 offen lds
    v_mfma_f32_16x16x32_bf16 v[20:23], v[132:135], v[148:151], v[20:23]
    ds_read_b64_tr_b16 v[128:129], v184 offset:160
    s_waitcnt vmcnt(11)
    s_cmp_lg_u32 s36, 0
    s_cbranch_scc1 L_noarr_hq
    v_cmp_gt_u32 vcc, 4, v5
    s_cbranch_vccz L_clr_hq_ok
    s_mov_b32 s56, 0
L_clr_hq_again:
    s_sleep 4
    buffer_load_dword v5, v6, s[24:27], 0 offen sc1
    s_waitcnt vmcnt(0)
    v_cmp_gt_u32 vcc, 4, v5
    s_add_u32 s56, s56, 1
    s_cmp_gt_u32 s56, 65536
    s_cbranch_scc1 L_clr_hq_ok
    s_cbranch_vccnz L_clr_hq_again
L_clr_hq_ok:
    v_mov_b32 v5, 1
    s_mov_b64 exec, 1
    buffer_atomic_add v5, v6, s[16:19], s3 offen sc1
    s_mov_b64 exec, -1
L_noarr_hq:
    v_mfma_f32_16x16x32_bf16 v[24:27], v[132:135], v[152:155], v[24:27]
    s_add_u32 m0, s47, 40960
    ds_read_b64_tr_b16 v[130:131], v184 offset:1440
    v_mfma_f32_16x16x32_bf16 v[28:31], v[132:135], v[156:159], v[28:31]
    s_waitcnt lgkmcnt(6)
    buffer_load_dwordx4 v172, s[12:15], s44 offen lds
    v_mfma_f32_16x16x32_bf16 v[32:35], v[136:139], v[148:151], v[32:35]
    ds_read_b64_tr_b16 v[132:133], v183 offset:192
    v_mfma_f32_16x16x32_bf16 v[36:39], v[136:139], v[152:155], v[36:39]
    ds_read_b64_tr_b16 v[134:135], v183 offset:1472
    v_mfma_f32_16x16x32_bf16 v[40:43], v[136:139], v[156:159], v[40:43]
    s_waitcnt lgkmcnt(6)
    v_mfma_f32_16x16x32_bf16 v[44:47], v[140:143], v[148:151], v[44:47]
    ds_read_b64_tr_b16 v[136:137], v184 offset:224
    v_mfma_f32_16x16x32_bf16 v[48:51], v[140:143], v[152:155], v[48:51]
    s_add_u32 m0, s46, 1024
    ds_read_b64_tr_b16 v[138:139], v184 offset:1504
    v_lshlrev_b32 v250, 5, v189
    v_mfma_f32_16x16x32_bf16 v[52:55], v[140:143], v[156:159], v[52:55]
    s_waitcnt lgkmcnt(6)
    buffer_load_dwordx4 v178, s[8:11], s43 offen lds
    v_and_b32 v198, 1, v189
    v_mfma_f32_16x16x32_bf16 v[56:59], v[144:147], v[148:151], v[56:59]
    ds_read_b64_tr_b16 v[140:141], v183 offset:256
    v_mul_u32_u24 v198, 24, v198
    v_mfma_f32_16x16x32_bf16 v[60:63], v[144:147], v[152:155], v[60:63]
    ds_read_b64_tr_b16 v[142:143], v183 offset:1536
    v_sub_u32 v250, v250, v198
    v_mfma_f32_16x16x32_bf16 v[64:67], v[144:147], v[156:159], v[64:67]
    s_waitcnt lgkmcnt(6)
    v_lshlrev_b32 v251, 5, v190
    v_and_b32 v198, 1, v190
    v_mfma_f32_16x16x32_bf16 v[68:71], v[128:131], v[148:151], v[68:71]
    ds_read_b64_tr_b16 v[144:145], v184 offset:288
    v_mul_u32_u24 v198, 24, v198
    v_mfma_f32_16x16x32_bf16 v[72:75], v[128:131], v[152:155], v[72:75]
    s_add_u32 m0, s47, 41984
    ds_read_b64_tr_b16 v[146:147], v184 offset:1568
    v_sub_u32 v251, v251, v198
    v_mfma_f32_16x16x32_bf16 v[76:79], v[128:131], v[156:159], v[76:79]
    s_waitcnt lgkmcnt(6)
    buffer_load_dwordx4 v173, s[12:15], s44 offen lds
    v_lshlrev_b32 v252, 5, v191
    v_mfma_f32_16x16x32_bf16 v[80:83], v[132:135], v[148:151], v[80:83]
    ds_read_b64_tr_b16 v[128:129], v183 offset:10240
    v_and_b32 v198, 1, v191
    v_mfma_f32_16x16x32_bf16 v[84:87], v[132:135], v[152:155], v[84:87]
    ds_read_b64_tr_b16 v[130:131], v183 offset:11520
    ds_read_b128 v[160:163], v188 offset:6144
    v_mfma_f32_16x16x32_bf16 v[88:91], v[132:135], v[156:159], v[88:91]
    s_waitcnt lgkmcnt(7)
    v_mul_u32_u24 v198, 24, v198
    v_sub_u32 v252, v252, v198
    v_mfma_f32_16x16x32_bf16 v[92:95], v[136:139], v[148:151], v[92:95]
    ds_read_b64_tr_b16 v[132:133], v184 offset:10272
    ds_read_b128 v[164:167], v188 offset:8192
    v_mfma_f32_16x16x32_bf16 v[96:99], v[136:139], v[152:155], v[96:99]
    s_add_u32 m0, s46, 2048
    ds_read_b64_tr_b16 v[134:135], v184 offset:11552
    s_mul_i32 s42, s36, 35840
    v_mfma_f32_16x16x32_bf16 v[100:103], v[136:139], v[156:159], v[100:103]
    s_waitcnt lgkmcnt(8)
    ds_read_b128 v[168:171], v243
    buffer_load_dwordx4 v179, s[8:11], s43 offen lds
    v_mfma_f32_16x16x32_bf16 v[104:107], v[140:143], v[148:151], v[104:107]
    ds_read_b64_tr_b16 v[136:137], v183 offset:10304
    s_lshl_b32 s65, s49, 22
    v_mfma_f32_16x16x32_bf16 v[108:111], v[140:143], v[152:155], v[108:111]
    ds_read_b64_tr_b16 v[138:139], v183 offset:11584
    s_add_u32 s65, s65, 4194304
    v_mfma_f32_16x16x32_bf16 v[112:115], v[140:143], v[156:159], v[112:115]
    s_waitcnt lgkmcnt(9)
    s_and_b32 s40, s2, 1
    s_mul_i32 s40, s40, 27
    v_mfma_f32_16x16x32_bf16 v[116:119], v[144:147], v[148:151], v[116:119]
    ds_read_b64_tr_b16 v[140:141], v184 offset:10336
    s_add_u32 s40, s40, s36
    v_mfma_f32_16x16x32_bf16 v[120:123], v[144:147], v[152:155], v[120:123]
    s_add_u32 m0, s47, 43008
    ds_read_b64_tr_b16 v[142:143], v184 offset:11616
    s_lshl_b32 s57, s40, 14
    v_mfma_f32_16x16x32_bf16 v[124:127], v[144:147], v[156:159], v[124:127]
    s_waitcnt lgkmcnt(4)
    buffer_load_dwordx4 v174, s[12:15], s44 offen lds
    s_add_u32 s57, s57, s65
    v_mfma_f32_16x16x32_bf16 v[8:11], v[128:131], v[160:163], v[8:11]
    ds_read_b64_tr_b16 v[144:145], v183 offset:10368
    s_and_b32 s50, s40, 2
    v_mfma_f32_16x16x32_bf16 v[12:15], v[128:131], v[164:167], v[12:15]
    s_add_u32 m0, s46, 3072
    ds_read_b64_tr_b16 v[146:147], v183 offset:11648
    s_mul_i32 s50, s50, 1536
    v_mfma_f32_16x16x32_bf16 v[16:19], v[128:131], v[168:171], v[16:19]
    buffer_load_dwordx4 v180, s[8:11], s43 offen lds
    s_add_u32 s57, s57, s50
    v_mfma_f32_16x16x32_bf16 v[20:23], v[132:135], v[160:163], v[20:23]
    ds_read_b64_tr_b16 v[128:129], v184 offset:10400
    s_mul_i32 s50, s36, 81920
    v_mfma_f32_16x16x32_bf16 v[24:27], v[132:135], v[164:167], v[24:27]
    ds_read_b64_tr_b16 v[130:131], v184 offset:11680
    s_add_u32 s65, s65, s50
    v_mfma_f32_16x16x32_bf16 v[28:31], v[132:135], v[168:171], v[28:31]
    s_waitcnt lgkmcnt(6)
    s_add_u32 s65, s65, 884736
    s_add_u32 s72, s36, 1
    v_mfma_f32_16x16x32_bf16 v[32:35], v[136:139], v[160:163], v[32:35]
    ds_read_b64_tr_b16 v[132:133], v183 offset:10432
    s_lshr_b32 s72, s72, 2
    v_mfma_f32_16x16x32_bf16 v[36:39], v[136:139], v[164:167], v[36:39]
    s_add_u32 m0, s47, 44032
    ds_read_b64_tr_b16 v[134:135], v183 offset:11712
    s_lshl_b32 s72, s72, 30
    v_mfma_f32_16x16x32_bf16 v[40:43], v[136:139], v[168:171], v[40:43]
    s_waitcnt lgkmcnt(6)
    buffer_load_dwordx4 v175, s[12:15], s44 offen lds
    s_mov_b32 s62, 0x3f317218
    v_mfma_f32_16x16x32_bf16 v[44:47], v[140:143], v[160:163], v[44:47]
    ds_read_b64_tr_b16 v[136:137], v184 offset:10464
    s_mov_b32 s63, 0x358637bd
    v_mfma_f32_16x16x32_bf16 v[48:51], v[140:143], v[164:167], v[48:51]
    ds_read_b64_tr_b16 v[138:139], v184 offset:11744
    s_cmp_eq_u32 s38, 1
    s_cselect_b32 s41, 0, 0x80000000
    s_xor_b32 s41, s41, 0x3fb8aa3b
    v_mfma_f32_16x16x32_bf16 v[52:55], v[140:143], v[168:171], v[52:55]
    s_waitcnt lgkmcnt(6)
    s_mul_i32 s52, s39, 3
    s_add_u32 s52, s52, 0
    v_mfma_f32_16x16x32_bf16 v[56:59], v[144:147], v[160:163], v[56:59]
    ds_read_b64_tr_b16 v[140:141], v183 offset:10496
    s_bfe_u32 s53, s52, 0x10002
    v_mfma_f32_16x16x32_bf16 v[60:63], v[144:147], v[164:167], v[60:63]
    s_add_u32 m0, s46, 4096
    ds_read_b64_tr_b16 v[142:143], v183 offset:11776
    s_mul_i32 s53, s53, 27
    v_mfma_f32_16x16x32_bf16 v[64:67], v[144:147], v[168:171], v[64:67]
    s_waitcnt lgkmcnt(6)
    buffer_load_dwordx4 v181, s[8:11], s43 offen lds
    s_lshr_b32 s51, s52, 3
    v_mfma_f32_16x16x32_bf16 v[68:71], v[128:131], v[160:163], v[68:71]
    ds_read_b64_tr_b16 v[144:145], v184 offset:10528
    s_lshl2_add_u32 s53, s51, s53
    v_mfma_f32_16x16x32_bf16 v[72:75], v[128:131], v[164:167], v[72:75]
    ds_read_b64_tr_b16 v[146:147], v184 offset:11808
    s_and_b32 s51, s52, 3
    v_mfma_f32_16x16x32_bf16 v[76:79], v[128:131], v[168:171], v[76:79]
    s_waitcnt vmcnt(9) lgkmcnt(6)
    s_barrier
    v_mfma_f32_16x16x32_bf16 v[80:83], v[132:135], v[160:163], v[80:83]
    ds_read_b64_tr_b16 v[128:129], v183 offset:20480
    s_add_u32 s53, s53, s51
    v_mfma_f32_16x16x32_bf16 v[84:87], v[132:135], v[164:167], v[84:87]
    s_add_u32 m0, s47, 45056
    ds_read_b64_tr_b16 v[130:131], v183 offset:21760
    ds_read_b128 v[148:151], v187 offset:12288
    v_mfma_f32_16x16x32_bf16 v[88:91], v[132:135], v[168:171], v[88:91]
    s_waitcnt lgkmcnt(7)
    buffer_load_dwordx4 v176, s[12:15], s44 offen lds
    s_sub_u32 s51, s52, 24
    v_mfma_f32_16x16x32_bf16 v[92:95], v[136:139], v[160:163], v[92:95]
    ds_read_b64_tr_b16 v[132:133], v184 offset:20512
    ds_read_b128 v[152:155], v187 offset:14336
    s_cmp_ge_u32 s52, 51
    s_cselect_b32 s51, s52, s51
    v_mfma_f32_16x16x32_bf16 v[96:99], v[136:139], v[164:167], v[96:99]
    s_add_u32 s44, s44, s45
    ds_read_b64_tr_b16 v[134:135], v184 offset:21792
    v_mfma_f32_16x16x32_bf16 v[100:103], v[136:139], v[168:171], v[100:103]
    s_waitcnt lgkmcnt(8)
    ds_read_b128 v[156:159], v244
    v_mfma_f32_16x16x32_bf16 v[104:107], v[140:143], v[160:163], v[104:107]
    ds_read_b64_tr_b16 v[136:137], v183 offset:20544
    s_cmp_lt_u32 s52, 48
    s_cselect_b32 s51, s53, s51
    v_mfma_f32_16x16x32_bf16 v[108:111], v[140:143], v[164:167], v[108:111]
    s_add_u32 m0, s46, 5120
    ds_read_b64_tr_b16 v[138:139], v183 offset:21824
    s_mul_i32 s52, s39, 5
    v_mfma_f32_16x16x32_bf16 v[112:115], v[140:143], v[168:171], v[112:115]
    s_waitcnt lgkmcnt(9)
    buffer_load_dwordx4 v182, s[8:11], s43 offen lds
    s_add_u32 s52, s52, 74
    v_mfma_f32_16x16x32_bf16 v[116:119], v[144:147], v[160:163], v[116:119]
    ds_read_b64_tr_b16 v[140:141], v184 offset:20576
    s_cmp_eq_u32 s38, 1
    s_cselect_b32 s51, s52, s51
    v_mfma_f32_16x16x32_bf16 v[120:123], v[144:147], v[164:167], v[120:123]
    s_add_u32 s43, s43, 128
    ds_read_b64_tr_b16 v[142:143], v184 offset:21856
    s_and_b32 s3, s51, 1
    v_mfma_f32_16x16x32_bf16 v[124:127], v[144:147], v[168:171], v[124:127]
    s_waitcnt lgkmcnt(4)
    s_lshl_b32 s3, s3, 12
    s_lshl_b32 s66, s51, 13
    v_mfma_f32_16x16x32_bf16 v[8:11], v[128:131], v[148:151], v[8:11]
    ds_read_b64_tr_b16 v[144:145], v183 offset:20608
    s_sub_u32 s66, s66, s3
    v_mfma_f32_16x16x32_bf16 v[12:15], v[128:131], v[152:155], v[12:15]
    s_add_u32 m0, s46, 6144
    ds_read_b64_tr_b16 v[146:147], v183 offset:21888
    s_add_u32 s66, s66, 37748736
    v_mfma_f32_16x16x32_bf16 v[16:19], v[128:131], v[156:159], v[16:19]
    buffer_load_dwordx4 v177, s[8:11], s43 offen lds
    s_mul_i32 s52, s39, 3
    v_mfma_f32_16x16x32_bf16 v[20:23], v[132:135], v[148:151], v[20:23]
    ds_read_b64_tr_b16 v[128:129], v184 offset:20640
    s_add_u32 s52, s52, 1
    v_mfma_f32_16x16x32_bf16 v[24:27], v[132:135], v[152:155], v[24:27]
    s_add_u32 m0, s47, 61440
    ds_read_b64_tr_b16 v[130:131], v184 offset:21920
    s_bfe_u32 s53, s52, 0x10002
    v_mfma_f32_16x16x32_bf16 v[28:31], v[132:135], v[156:159], v[28:31]
    s_waitcnt lgkmcnt(6)
    buffer_load_dwordx4 v172, s[12:15], s44 offen lds
    s_mul_i32 s53, s53, 27
    v_mfma_f32_16x16x32_bf16 v[32:35], v[136:139], v[148:151], v[32:35]
    ds_read_b64_tr_b16 v[132:133], v183 offset:20672
    s_lshr_b32 s51, s52, 3
    v_mfma_f32_16x16x32_bf16 v[36:39], v[136:139], v[152:155], v[36:39]
    ds_read_b64_tr_b16 v[134:135], v183 offset:21952
    s_lshl2_add_u32 s53, s51, s53
    v_mfma_f32_16x16x32_bf16 v[40:43], v[136:139], v[156:159], v[40:43]
    s_waitcnt lgkmcnt(6)
    s_and_b32 s51, s52, 3
    s_add_u32 s53, s53, s51
    v_mfma_f32_16x16x32_bf16 v[44:47], v[140:143], v[148:151], v[44:47]
    ds_read_b64_tr_b16 v[136:137], v184 offset:20704
    s_sub_u32 s51, s52, 24
    v_mfma_f32_16x16x32_bf16 v[48:51], v[140:143], v[152:155], v[48:51]
    s_add_u32 m0, s46, 7168
    ds_read_b64_tr_b16 v[138:139], v184 offset:21984
    v_mfma_f32_16x16x32_bf16 v[52:55], v[140:143], v[156:159], v[52:55]
    s_waitcnt lgkmcnt(6)
    buffer_load_dwordx4 v178, s[8:11], s43 offen lds
    v_mfma_f32_16x16x32_bf16 v[56:59], v[144:147], v[148:151], v[56:59]
    ds_read_b64_tr_b16 v[140:141], v183 offset:20736
    s_cmp_ge_u32 s52, 51
    s_cselect_b32 s51, s52, s51
    v_mfma_f32_16x16x32_bf16 v[60:63], v[144:147], v[152:155], v[60:63]
    ds_read_b64_tr_b16 v[142:143], v183 offset:22016
    s_cmp_lt_u32 s52, 48
    s_cselect_b32 s51, s53, s51
    v_mfma_f32_16x16x32_bf16 v[64:67], v[144:147], v[156:159], v[64:67]
    s_waitcnt lgkmcnt(6)
    s_mul_i32 s52, s39, 5
    s_add_u32 s52, s52, 75
    v_mfma_f32_16x16x32_bf16 v[68:71], v[128:131], v[148:151], v[68:71]
    ds_read_b64_tr_b16 v[144:145], v184 offset:20768
    s_cmp_eq_u32 s38, 1
    s_cselect_b32 s51, s52, s51
    v_mfma_f32_16x16x32_bf16 v[72:75], v[128:131], v[152:155], v[72:75]
    s_add_u32 m0, s47, 62464
    ds_read_b64_tr_b16 v[146:147], v184 offset:22048
    s_and_b32 s3, s51, 1
    v_mfma_f32_16x16x32_bf16 v[76:79], v[128:131], v[156:159], v[76:79]
    s_waitcnt lgkmcnt(6)
    buffer_load_dwordx4 v173, s[12:15], s44 offen lds
    s_lshl_b32 s3, s3, 12
    v_mfma_f32_16x16x32_bf16 v[80:83], v[132:135], v[148:151], v[80:83]
    ds_read_b64_tr_b16 v[128:129], v183 offset:30720
    s_lshl_b32 s67, s51, 13
    v_mfma_f32_16x16x32_bf16 v[84:87], v[132:135], v[152:155], v[84:87]
    ds_read_b64_tr_b16 v[130:131], v183 offset:32000
    ds_read_b128 v[160:163], v188 offset:12288
    v_mfma_f32_16x16x32_bf16 v[88:91], v[132:135], v[156:159], v[88:91]
    s_waitcnt lgkmcnt(7)
    s_sub_u32 s67, s67, s3
    s_add_u32 s67, s67, 37748736
    v_mfma_f32_16x16x32_bf16 v[92:95], v[136:139], v[148:151], v[92:95]
    ds_read_b64_tr_b16 v[132:133], v184 offset:30752
    ds_read_b128 v[164:167], v188 offset:14336
    v_mfma_f32_16x16x32_bf16 v[96:99], v[136:139], v[152:155], v[96:99]
    s_add_u32 m0, s46, 8192
    ds_read_b64_tr_b16 v[134:135], v184 offset:32032
    s_mul_i32 s52, s39, 3
    v_mfma_f32_16x16x32_bf16 v[100:103], v[136:139], v[156:159], v[100:103]
    s_waitcnt lgkmcnt(8)
    ds_read_b128 v[168:171], v245
    buffer_load_dwordx4 v179, s[8:11], s43 offen lds
    v_mfma_f32_16x16x32_bf16 v[104:107], v[140:143], v[148:151], v[104:107]
    ds_read_b64_tr_b16 v[136:137], v183 offset:30784
    s_add_u32 s52, s52, 2
    v_mfma_f32_16x16x32_bf16 v[108:111], v[140:143], v[152:155], v[108:111]
    ds_read_b64_tr_b16 v[138:139], v183 offset:32064
    s_cmp_eq_u32 s52, 32
    s_cselect_b32 s52, 53, s52
    v_mfma_f32_16x16x32_bf16 v[112:115], v[140:143], v[156:159], v[112:115]
    s_waitcnt lgkmcnt(9)
    s_bfe_u32 s53, s52, 0x10002
    s_mul_i32 s53, s53, 27
    v_mfma_f32_16x16x32_bf16 v[116:119], v[144:147], v[148:151], v[116:119]
    ds_read_b64_tr_b16 v[140:141], v184 offset:30816
    s_lshr_b32 s51, s52, 3
    v_mfma_f32_16x16x32_bf16 v[120:123], v[144:147], v[152:155], v[120:123]
    s_add_u32 m0, s47, 63488
    ds_read_b64_tr_b16 v[142:143], v184 offset:32096
    s_lshl2_add_u32 s53, s51, s53
    v_mfma_f32_16x16x32_bf16 v[124:127], v[144:147], v[156:159], v[124:127]
    s_waitcnt lgkmcnt(4)
    buffer_load_dwordx4 v174, s[12:15], s44 offen lds
    s_and_b32 s51, s52, 3
    v_mfma_f32_16x16x32_bf16 v[8:11], v[128:131], v[160:163], v[8:11]
    ds_read_b64_tr_b16 v[144:145], v183 offset:30848
    s_add_u32 s53, s53, s51
    v_mfma_f32_16x16x32_bf16 v[12:15], v[128:131], v[164:167], v[12:15]
    s_add_u32 m0, s46, 9216
    ds_read_b64_tr_b16 v[146:147], v183 offset:32128
    s_sub_u32 s51, s52, 24
    v_mfma_f32_16x16x32_bf16 v[16:19], v[128:131], v[168:171], v[16:19]
    buffer_load_dwordx4 v180, s[8:11], s43 offen lds
    v_mfma_f32_16x16x32_bf16 v[20:23], v[132:135], v[160:163], v[20:23]
    ds_read_b64_tr_b16 v[128:129], v184 offset:30880
    s_cmp_ge_u32 s52, 51
    s_cselect_b32 s51, s52, s51
    v_mfma_f32_16x16x32_bf16 v[24:27], v[132:135], v[164:167], v[24:27]
    ds_read_b64_tr_b16 v[130:131], v184 offset:32160
    s_cmp_lt_u32 s52, 48
    s_cselect_b32 s51, s53, s51
    v_mfma_f32_16x16x32_bf16 v[28:31], v[132:135], v[168:171], v[28:31]
    s_waitcnt lgkmcnt(6)
    s_mul_i32 s52, s39, 5
    s_add_u32 s52, s52, 76
    v_mfma_f32_16x16x32_bf16 v[32:35], v[136:139], v[160:163], v[32:35]
    ds_read_b64_tr_b16 v[132:133], v183 offset:30912
    s_cmp_eq_u32 s38, 1
    s_cselect_b32 s51, s52, s51
    v_mfma_f32_16x16x32_bf16 v[36:39], v[136:139], v[164:167], v[36:39]
    s_add_u32 m0, s47, 64512
    ds_read_b64_tr_b16 v[134:135], v183 offset:32192
    s_and_b32 s3, s51, 1
    v_mfma_f32_16x16x32_bf16 v[40:43], v[136:139], v[168:171], v[40:43]
    s_waitcnt lgkmcnt(6)
    buffer_load_dwordx4 v175, s[12:15], s44 offen lds
    s_lshl_b32 s3, s3, 12
    v_mfma_f32_16x16x32_bf16 v[44:47], v[140:143], v[160:163], v[44:47]
    ds_read_b64_tr_b16 v[136:137], v184 offset:30944
    s_lshl_b32 s68, s51, 13
    v_mfma_f32_16x16x32_bf16 v[48:51], v[140:143], v[164:167], v[48:51]
    ds_read_b64_tr_b16 v[138:139], v184 offset:32224
    s_sub_u32 s68, s68, s3
    v_mfma_f32_16x16x32_bf16 v[52:55], v[140:143], v[168:171], v[52:55]
    s_waitcnt lgkmcnt(6)
    s_add_u32 s68, s68, 37748736
    s_mul_i32 s52, s39, 2
    v_mfma_f32_16x16x32_bf16 v[56:59], v[144:147], v[160:163], v[56:59]
    ds_read_b64_tr_b16 v[140:141], v183 offset:30976
    s_add_u32 s52, s52, 32
    v_mfma_f32_16x16x32_bf16 v[60:63], v[144:147], v[164:167], v[60:63]
    s_add_u32 m0, s46, 10240
    ds_read_b64_tr_b16 v[142:143], v183 offset:32256
    s_bfe_u32 s53, s52, 0x10002
    v_mfma_f32_16x16x32_bf16 v[64:67], v[144:147], v[168:171], v[64:67]
    s_waitcnt lgkmcnt(6)
    buffer_load_dwordx4 v181, s[8:11], s43 offen lds
    s_mul_i32 s53, s53, 27
    v_mfma_f32_16x16x32_bf16 v[68:71], v[128:131], v[160:163], v[68:71]
    ds_read_b64_tr_b16 v[144:145], v184 offset:31008
    s_lshr_b32 s51, s52, 3
    v_mfma_f32_16x16x32_bf16 v[72:75], v[128:131], v[164:167], v[72:75]
    ds_read_b64_tr_b16 v[146:147], v184 offset:32288
    s_lshl2_add_u32 s53, s51, s53
    v_mfma_f32_16x16x32_bf16 v[76:79], v[128:131], v[168:171], v[76:79]
    s_waitcnt vmcnt(9) lgkmcnt(6)
    s_barrier
    v_mfma_f32_16x16x32_bf16 v[80:83], v[132:135], v[160:163], v[80:83]
    ds_read_b64_tr_b16 v[128:129], v185 offset:0
    s_and_b32 s51, s52, 3
    v_mfma_f32_16x16x32_bf16 v[84:87], v[132:135], v[164:167], v[84:87]
    s_add_u32 m0, s47, 65536
    ds_read_b64_tr_b16 v[130:131], v185 offset:1280
    ds_read_b128 v[148:151], v187 offset:0
    v_mfma_f32_16x16x32_bf16 v[88:91], v[132:135], v[168:171], v[88:91]
    s_waitcnt lgkmcnt(7)
    buffer_load_dwordx4 v176, s[12:15], s44 offen lds
    s_add_u32 s53, s53, s51
    v_mfma_f32_16x16x32_bf16 v[92:95], v[136:139], v[160:163], v[92:95]
    ds_read_b64_tr_b16 v[132:133], v186 offset:32
    ds_read_b128 v[152:155], v187 offset:2048
    v_mfma_f32_16x16x32_bf16 v[96:99], v[136:139], v[164:167], v[96:99]
    s_add_u32 s44, s44, s45
    ds_read_b64_tr_b16 v[134:135], v186 offset:1312
    s_sub_u32 s51, s52, 24
    v_mfma_f32_16x16x32_bf16 v[100:103], v[136:139], v[168:171], v[100:103]
    s_waitcnt lgkmcnt(8)
    ds_read_b128 v[156:159], v240
    v_mfma_f32_16x16x32_bf16 v[104:107], v[140:143], v[160:163], v[104:107]
    ds_read_b64_tr_b16 v[136:137], v185 offset:64
    s_cmp_ge_u32 s52, 51
    s_cselect_b32 s51, s52, s51
    v_mfma_f32_16x16x32_bf16 v[108:111], v[140:143], v[164:167], v[108:111]
    s_add_u32 m0, s46, 11264
    ds_read_b64_tr_b16 v[138:139], v185 offset:1344
    v_mfma_f32_16x16x32_bf16 v[112:115], v[140:143], v[168:171], v[112:115]
    s_waitcnt lgkmcnt(9)
    buffer_load_dwordx4 v182, s[8:11], s43 offen lds
    v_mfma_f32_16x16x32_bf16 v[116:119], v[144:147], v[160:163], v[116:119]
    ds_read_b64_tr_b16 v[140:141], v186 offset:96
    s_cmp_lt_u32 s52, 48
    s_cselect_b32 s51, s53, s51
    v_mfma_f32_16x16x32_bf16 v[120:123], v[144:147], v[164:167], v[120:123]
    s_add_u32 s43, s43, 128
    ds_read_b64_tr_b16 v[142:143], v186 offset:1376
    s_mul_i32 s52, s39, 5
    v_mfma_f32_16x16x32_bf16 v[124:127], v[144:147], v[168:171], v[124:127]
    s_waitcnt lgkmcnt(4)
    s_add_u32 s52, s52, 77
    v_mfma_f32_16x16x32_bf16 v[8:11], v[128:131], v[148:151], v[8:11]
    ds_read_b64_tr_b16 v[144:145], v185 offset:128
    s_cmp_eq_u32 s38, 1
    s_cselect_b32 s51, s52, s51
    v_mfma_f32_16x16x32_bf16 v[12:15], v[128:131], v[152:155], v[12:15]
    s_add_u32 m0, s46, 12288
    ds_read_b64_tr_b16 v[146:147], v185 offset:1408
    s_and_b32 s3, s51, 1
    v_mfma_f32_16x16x32_bf16 v[16:19], v[128:131], v[156:159], v[16:19]
    buffer_load_dwordx4 v177, s[8:11], s43 offen lds
    s_lshl_b32 s3, s3, 12
    v_mfma_f32_16x16x32_bf16 v[20:23], v[132:135], v[148:151], v[20:23]
    ds_read_b64_tr_b16 v[128:129], v186 offset:160
    s_lshl_b32 s69, s51, 13
    v_mfma_f32_16x16x32_bf16 v[24:27], v[132:135], v[152:155], v[24:27]
    s_add_u32 m0, s47, 0
    ds_read_b64_tr_b16 v[130:131], v186 offset:1440
    s_sub_u32 s69, s69, s3
    v_mfma_f32_16x16x32_bf16 v[28:31], v[132:135], v[156:159], v[28:31]
    s_waitcnt lgkmcnt(6)
    buffer_load_dwordx4 v172, s[12:15], s44 offen lds
    s_add_u32 s69, s69, 37748736
    v_mfma_f32_16x16x32_bf16 v[32:35], v[136:139], v[148:151], v[32:35]
L_st2:
    s_cbranch_execz L_st6
    ds_read_b64_tr_b16 v[132:133], v185 offset:192
    s_mul_i32 s52, s39, 2
    v_mfma_f32_16x16x32_bf16 v[36:39], v[136:139], v[152:155], v[36:39]
    ds_read_b64_tr_b16 v[134:135], v185 offset:1472
    s_add_u32 s52, s52, 33
    v_mfma_f32_16x16x32_bf16 v[40:43], v[136:139], v[156:159], v[40:43]
    s_waitcnt lgkmcnt(6)
    s_bfe_u32 s53, s52, 0x10002
    s_mul_i32 s53, s53, 27
    v_mfma_f32_16x16x32_bf16 v[44:47], v[140:143], v[148:151], v[44:47]
    ds_read_b64_tr_b16 v[136:137], v186 offset:224
    s_lshr_b32 s51, s52, 3
    v_mfma_f32_16x16x32_bf16 v[48:51], v[140:143], v[152:155], v[48:51]
    s_add_u32 m0, s46, 13312
    ds_read_b64_tr_b16 v[138:139], v186 offset:1504
    s_lshl2_add_u32 s53, s51, s53
    v_mfma_f32_16x16x32_bf16 v[52:55], v[140:143], v[156:159], v[52:55]
    s_waitcnt lgkmcnt(6)
    buffer_load_dwordx4 v178, s[8:11], s43 offen lds
    s_and_b32 s51, s52, 3
    v_mfma_f32_16x16x32_bf16 v[56:59], v[144:147], v[148:151], v[56:59]
    ds_read_b64_tr_b16 v[140:141], v185 offset:256
    s_add_u32 s53, s53, s51
    v_mfma_f32_16x16x32_bf16 v[60:63], v[144:147], v[152:155], v[60:63]
    ds_read_b64_tr_b16 v[142:143], v185 offset:1536
    s_sub_u32 s51, s52, 24
    v_mfma_f32_16x16x32_bf16 v[64:67], v[144:147], v[156:159], v[64:67]
    s_waitcnt lgkmcnt(6)
    s_cmp_ge_u32 s52, 51
    s_cselect_b32 s51, s52, s51
    v_mfma_f32_16x16x32_bf16 v[68:71], v[128:131], v[148:151], v[68:71]
    ds_read_b64_tr_b16 v[144:145], v186 offset:288
    s_cmp_lt_u32 s52, 48
    s_cselect_b32 s51, s53, s51
    v_mfma_f32_16x16x32_bf16 v[72:75], v[128:131], v[152:155], v[72:75]
    s_add_u32 m0, s47, 1024
    ds_read_b64_tr_b16 v[146:147], v186 offset:1568
    s_mul_i32 s52, s39, 5
    v_mfma_f32_16x16x32_bf16 v[76:79], v[128:131], v[156:159], v[76:79]
    s_waitcnt lgkmcnt(6)
    buffer_load_dwordx4 v173, s[12:15], s44 offen lds
    s_add_u32 s52, s52, 78
    v_mfma_f32_16x16x32_bf16 v[80:83], v[132:135], v[148:151], v[80:83]
    ds_read_b64_tr_b16 v[128:129], v185 offset:10240
    s_cmp_eq_u32 s38, 1
    s_cselect_b32 s51, s52, s51
    v_mfma_f32_16x16x32_bf16 v[84:87], v[132:135], v[152:155], v[84:87]
    ds_read_b64_tr_b16 v[130:131], v185 offset:11520
    ds_read_b128 v[160:163], v188 offset:0
    v_mfma_f32_16x16x32_bf16 v[88:91], v[132:135], v[156:159], v[88:91]
    s_waitcnt lgkmcnt(7)
    s_and_b32 s3, s51, 1
    s_lshl_b32 s3, s3, 12
    v_mfma_f32_16x16x32_bf16 v[92:95], v[136:139], v[148:151], v[92:95]
    ds_read_b64_tr_b16 v[132:133], v186 offset:10272
    ds_read_b128 v[164:167], v188 offset:2048
    v_mfma_f32_16x16x32_bf16 v[96:99], v[136:139], v[152:155], v[96:99]
    s_add_u32 m0, s46, 14336
    ds_read_b64_tr_b16 v[134:135], v186 offset:11552
    s_lshl_b32 s70, s51, 13
    v_mfma_f32_16x16x32_bf16 v[100:103], v[136:139], v[156:159], v[100:103]
    s_waitcnt lgkmcnt(8)
    ds_read_b128 v[168:171], v241
    buffer_load_dwordx4 v179, s[8:11], s43 offen lds
    v_mfma_f32_16x16x32_bf16 v[104:107], v[140:143], v[148:151], v[104:107]
    ds_read_b64_tr_b16 v[136:137], v185 offset:10304
    s_sub_u32 s70, s70, s3
    v_mfma_f32_16x16x32_bf16 v[108:111], v[140:143], v[152:155], v[108:111]
    ds_read_b64_tr_b16 v[138:139], v185 offset:11584
    s_add_u32 s70, s70, 37748736
    v_mfma_f32_16x16x32_bf16 v[112:115], v[140:143], v[156:159], v[112:115]
    s_waitcnt lgkmcnt(9)
    v_and_b32 v198, 15, v189
    v_lshlrev_b32 v200, 4, v198
    v_mfma_f32_16x16x32_bf16 v[116:119], v[144:147], v[148:151], v[116:119]
    ds_read_b64_tr_b16 v[140:141], v186 offset:10336
    v_and_b32 v6, 7, v0
    v_mfma_f32_16x16x32_bf16 v[120:123], v[144:147], v[152:155], v[120:123]
    s_add_u32 m0, s47, 2048
    ds_read_b64_tr_b16 v[142:143], v186 offset:11616
    v_add_u32 v249, 1, v6
    v_mfma_f32_16x16x32_bf16 v[124:127], v[144:147], v[156:159], v[124:127]
    s_waitcnt lgkmcnt(4)
    buffer_load_dwordx4 v174, s[12:15], s44 offen lds
    v_lshrrev_b32 v249, 3, v249
    v_mfma_f32_16x16x32_bf16 v[8:11], v[128:131], v[160:163], v[8:11]
    ds_read_b64_tr_b16 v[144:145], v185 offset:10368
    v_mad_u32_u24 v249, v249, 12, 8
    v_mfma_f32_16x16x32_bf16 v[12:15], v[128:131], v[164:167], v[12:15]
    s_add_u32 m0, s46, 15360
    ds_read_b64_tr_b16 v[146:147], v185 offset:11648
    s_lshl_b32 s71, s36, 10
    v_mfma_f32_16x16x32_bf16 v[16:19], v[128:131], v[168:171], v[16:19]
    buffer_load_dwordx4 v180, s[8:11], s43 offen lds
    s_add_u32 s71, s71, 294912
    v_mfma_f32_16x16x32_bf16 v[20:23], v[132:135], v[160:163], v[20:23]
    ds_read_b64_tr_b16 v[128:129], v186 offset:10400
    v_lshl_add_u32 v6, v6, 7, s71
    v_mfma_f32_16x16x32_bf16 v[24:27], v[132:135], v[164:167], v[24:27]
    ds_read_b64_tr_b16 v[130:131], v186 offset:11680
    v_lshl_add_u32 v200, v2, 8, v200
    v_mfma_f32_16x16x32_bf16 v[28:31], v[132:135], v[168:171], v[28:31]
    s_waitcnt lgkmcnt(6)
    v_bfe_u32 v198, v189, 4, 2
    v_lshl_add_u32 v200, v198, 10, v200
    v_mfma_f32_16x16x32_bf16 v[32:35], v[136:139], v[160:163], v[32:35]
    ds_read_b64_tr_b16 v[132:133], v185 offset:10432
    v_bfe_u32 v198, v189, 6, 4
    v_mfma_f32_16x16x32_bf16 v[36:39], v[136:139], v[164:167], v[36:39]
    s_add_u32 m0, s47, 3072
    ds_read_b64_tr_b16 v[134:135], v185 offset:11712
    v_lshl_add_u32 v200, v198, 14, v200
    v_mfma_f32_16x16x32_bf16 v[40:43], v[136:139], v[168:171], v[40:43]
    s_waitcnt lgkmcnt(6)
    buffer_load_dwordx4 v175, s[12:15], s44 offen lds
    v_bfe_u32 v198, v189, 6, 1
    v_mfma_f32_16x16x32_bf16 v[44:47], v[140:143], v[160:163], v[44:47]
    ds_read_b64_tr_b16 v[136:137], v186 offset:10464
    v_lshl_add_u32 v200, v198, 20, v200
    v_mfma_f32_16x16x32_bf16 v[48:51], v[140:143], v[164:167], v[48:51]
    ds_read_b64_tr_b16 v[138:139], v186 offset:11744
    v_bfe_u32 v198, v189, 7, 4
    v_mfma_f32_16x16x32_bf16 v[52:55], v[140:143], v[168:171], v[52:55]
    s_waitcnt lgkmcnt(6)
    v_lshl_add_u32 v200, v198, 22, v200
    v_bfe_u32 v198, v189, 11, 2
    v_mfma_f32_16x16x32_bf16 v[56:59], v[144:147], v[160:163], v[56:59]
    ds_read_b64_tr_b16 v[140:141], v185 offset:10496
    v_lshl_add_u32 v200, v198, 29, v200
    v_mfma_f32_16x16x32_bf16 v[60:63], v[144:147], v[164:167], v[60:63]
    s_add_u32 m0, s46, 16384
    ds_read_b64_tr_b16 v[142:143], v185 offset:11776
    v_and_b32 v198, 15, v190
    v_mfma_f32_16x16x32_bf16 v[64:67], v[144:147], v[168:171], v[64:67]
    s_waitcnt lgkmcnt(6)
    buffer_load_dwordx4 v181, s[8:11], s43 offen lds
    v_lshlrev_b32 v201, 4, v198
    v_mfma_f32_16x16x32_bf16 v[68:71], v[128:131], v[160:163], v[68:71]
    ds_read_b64_tr_b16 v[144:145], v186 offset:10528
    v_lshl_add_u32 v201, v2, 8, v201
    v_mfma_f32_16x16x32_bf16 v[72:75], v[128:131], v[164:167], v[72:75]
    ds_read_b64_tr_b16 v[146:147], v186 offset:11808
    v_bfe_u32 v198, v190, 4, 2
    v_mfma_f32_16x16x32_bf16 v[76:79], v[128:131], v[168:171], v[76:79]
    s_waitcnt vmcnt(9) lgkmcnt(6)
    s_barrier
    v_mfma_f32_16x16x32_bf16 v[80:83], v[132:135], v[160:163], v[80:83]
    ds_read_b64_tr_b16 v[128:129], v185 offset:20480
    v_lshl_add_u32 v201, v198, 10, v201
    v_mfma_f32_16x16x32_bf16 v[84:87], v[132:135], v[164:167], v[84:87]
    s_add_u32 m0, s47, 4096
    ds_read_b64_tr_b16 v[130:131], v185 offset:21760
    ds_read_b128 v[148:151], v187 offset:6144
    v_mfma_f32_16x16x32_bf16 v[88:91], v[132:135], v[168:171], v[88:91]
    s_waitcnt lgkmcnt(7)
    buffer_load_dwordx4 v176, s[12:15], s44 offen lds
    v_bfe_u32 v198, v190, 6, 4
    v_mfma_f32_16x16x32_bf16 v[92:95], v[136:139], v[160:163], v[92:95]
    ds_read_b64_tr_b16 v[132:133], v186 offset:20512
    ds_read_b128 v[152:155], v187 offset:8192
    buffer_load_dword v5, v6, s[16:19], 0 offen sc1
    v_mfma_f32_16x16x32_bf16 v[96:99], v[136:139], v[164:167], v[96:99]
    s_add_u32 s44, s44, s45
    ds_read_b64_tr_b16 v[134:135], v186 offset:21792
    v_lshl_add_u32 v201, v198, 14, v201
    v_mfma_f32_16x16x32_bf16 v[100:103], v[136:139], v[168:171], v[100:103]
    s_waitcnt lgkmcnt(8)
    ds_read_b128 v[156:159], v242
    v_bfe_u32 v198, v190, 6, 1
    v_mfma_f32_16x16x32_bf16 v[104:107], v[140:143], v[160:163], v[104:107]
    ds_read_b64_tr_b16 v[136:137], v185 offset:20544
    v_lshl_add_u32 v201, v198, 20, v201
    v_mfma_f32_16x16x32_bf16 v[108:111], v[140:143], v[164:167], v[108:111]
    s_add_u32 m0, s46, 17408
    ds_read_b64_tr_b16 v[138:139], v185 offset:21824
    v_bfe_u32 v198, v190, 7, 4
    v_mfma_f32_16x16x32_bf16 v[112:115], v[140:143], v[168:171], v[112:115]
    s_waitcnt lgkmcnt(9)
    buffer_load_dwordx4 v182, s[8:11], s43 offen lds
    v_lshl_add_u32 v201, v198, 22, v201
    v_mfma_f32_16x16x32_bf16 v[116:119], v[144:147], v[160:163], v[116:119]
    ds_read_b64_tr_b16 v[140:141], v186 offset:20576
    v_bfe_u32 v198, v190, 11, 2
    v_mfma_f32_16x16x32_bf16 v[120:123], v[144:147], v[164:167], v[120:123]
    s_add_u32 s43, s43, 128
    ds_read_b64_tr_b16 v[142:143], v186 offset:21856
    v_lshl_add_u32 v201, v198, 29, v201
    v_mfma_f32_16x16x32_bf16 v[124:127], v[144:147], v[168:171], v[124:127]
    s_waitcnt lgkmcnt(4)
    v_and_b32 v198, 15, v191
    v_lshlrev_b32 v202, 4, v198
    v_mfma_f32_16x16x32_bf16 v[8:11], v[128:131], v[148:151], v[8:11]
    ds_read_b64_tr_b16 v[144:145], v185 offset:20608
    v_lshl_add_u32 v202, v2, 8, v202
    v_mfma_f32_16x16x32_bf16 v[12:15], v[128:131], v[152:155], v[12:15]
    s_add_u32 m0, s46, 0
    ds_read_b64_tr_b16 v[146:147], v185 offset:21888
    v_bfe_u32 v198, v191, 4, 2
    v_mfma_f32_16x16x32_bf16 v[16:19], v[128:131], v[156:159], v[16:19]
    buffer_load_dwordx4 v177, s[8:11], s43 offen lds
    v_lshl_add_u32 v202, v198, 10, v202
    v_mfma_f32_16x16x32_bf16 v[20:23], v[132:135], v[148:151], v[20:23]
    ds_read_b64_tr_b16 v[128:129], v186 offset:20640
    v_bfe_u32 v198, v191, 6, 4
    v_mfma_f32_16x16x32_bf16 v[24:27], v[132:135], v[152:155], v[24:27]
    s_add_u32 m0, s47, 20480
    ds_read_b64_tr_b16 v[130:131], v186 offset:21920
    v_lshl_add_u32 v202, v198, 14, v202
    v_mfma_f32_16x16x32_bf16 v[28:31], v[132:135], v[156:159], v[28:31]
    s_waitcnt lgkmcnt(6)
    buffer_load_dwordx4 v172, s[12:15], s44 offen lds
    v_bfe_u32 v198, v191, 6, 1
    v_mfma_f32_16x16x32_bf16 v[32:35], v[136:139], v[148:151], v[32:35]
    ds_read_b64_tr_b16 v[132:133], v185 offset:20672
    v_lshl_add_u32 v202, v198, 20, v202
    v_mfma_f32_16x16x32_bf16 v[36:39], v[136:139], v[152:155], v[36:39]
    ds_read_b64_tr_b16 v[134:135], v185 offset:21952
    v_bfe_u32 v198, v191, 7, 4
    v_mfma_f32_16x16x32_bf16 v[40:43], v[136:139], v[156:159], v[40:43]
    s_waitcnt lgkmcnt(6)
    v_lshl_add_u32 v202, v198, 22, v202
    v_bfe_u32 v198, v191, 11, 2
    v_mfma_f32_16x16x32_bf16 v[44:47], v[140:143], v[148:151], v[44:47]
    ds_read_b64_tr_b16 v[136:137], v186 offset:20704
    v_lshl_add_u32 v202, v198, 29, v202
    v_mfma_f32_16x16x32_bf16 v[48:51], v[140:143], v[152:155], v[48:51]
    s_add_u32 m0, s46, 1024
    ds_read_b64_tr_b16 v[138:139], v186 offset:21984
    v_mfma_f32_16x16x32_bf16 v[52:55], v[140:143], v[156:159], v[52:55]
    s_waitcnt lgkmcnt(6)
    buffer_load_dwordx4 v178, s[8:11], s43 offen lds
    v_mfma_f32_16x16x32_bf16 v[56:59], v[144:147], v[148:151], v[56:59]
    ds_read_b64_tr_b16 v[140:141], v185 offset:20736
    v_mfma_f32_16x16x32_bf16 v[60:63], v[144:147], v[152:155], v[60:63]
    ds_read_b64_tr_b16 v[142:143], v185 offset:22016
    v_mfma_f32_16x16x32_bf16 v[64:67], v[144:147], v[156:159], v[64:67]
    s_waitcnt lgkmcnt(6)
    v_mfma_f32_16x16x32_bf16 v[68:71], v[128:131], v[148:151], v[68:71]
    ds_read_b64_tr_b16 v[144:145], v186 offset:20768
    v_mfma_f32_16x16x32_bf16 v[72:75], v[128:131], v[152:155], v[72:75]
    s_add_u32 m0, s47, 21504
    ds_read_b64_tr_b16 v[146:147], v186 offset:22048
    v_mfma_f32_16x16x32_bf16 v[76:79], v[128:131], v[156:159], v[76:79]
    s_waitcnt lgkmcnt(6)
    buffer_load_dwordx4 v173, s[12:15], s44 offen lds
    v_mfma_f32_16x16x32_bf16 v[80:83], v[132:135], v[148:151], v[80:83]
    ds_read_b64_tr_b16 v[128:129], v185 offset:30720
    v_mfma_f32_16x16x32_bf16 v[84:87], v[132:135], v[152:155], v[84:87]
    ds_read_b64_tr_b16 v[130:131], v185 offset:32000
    ds_read_b128 v[160:163], v188 offset:6144
    v_mfma_f32_16x16x32_bf16 v[88:91], v[132:135], v[156:159], v[88:91]
    s_waitcnt lgkmcnt(7)
    v_mfma_f32_16x16x32_bf16 v[92:95], v[136:139], v[148:151], v[92:95]
    ds_read_b64_tr_b16 v[132:133], v186 offset:30752
    ds_read_b128 v[164:167], v188 offset:8192
    v_mfma_f32_16x16x32_bf16 v[96:99], v[136:139], v[152:155], v[96:99]
    s_add_u32 m0, s46, 2048
    ds_read_b64_tr_b16 v[134:135], v186 offset:32032
    v_mfma_f32_16x16x32_bf16 v[100:103], v[136:139], v[156:159], v[100:103]
    s_waitcnt lgkmcnt(8)
    ds_read_b128 v[168:171], v243
    buffer_load_dwordx4 v179, s[8:11], s43 offen lds
    v_mfma_f32_16x16x32_bf16 v[104:107], v[140:143], v[148:151], v[104:107]
    ds_read_b64_tr_b16 v[136:137], v185 offset:30784
    v_mfma_f32_16x16x32_bf16 v[108:111], v[140:143], v[152:155], v[108:111]
    ds_read_b64_tr_b16 v[138:139], v185 offset:32064
    v_mfma_f32_16x16x32_bf16 v[112:115], v[140:143], v[156:159], v[112:115]
    s_waitcnt lgkmcnt(9)
    v_mfma_f32_16x16x32_bf16 v[116:119], v[144:147], v[148:151], v[116:119]
    ds_read_b64_tr_b16 v[140:141], v186 offset:30816
    v_mfma_f32_16x16x32_bf16 v[120:123], v[144:147], v[152:155], v[120:123]
    s_add_u32 m0, s47, 22528
    ds_read_b64_tr_b16 v[142:143], v186 offset:32096
    v_mfma_f32_16x16x32_bf16 v[124:127], v[144:147], v[156:159], v[124:127]
    s_waitcnt lgkmcnt(4)
    buffer_load_dwordx4 v174, s[12:15], s44 offen lds
    v_mfma_f32_16x16x32_bf16 v[8:11], v[128:131], v[160:163], v[8:11]
    ds_read_b64_tr_b16 v[144:145], v185 offset:30848
    v_mfma_f32_16x16x32_bf16 v[12:15], v[128:131], v[164:167], v[12:15]
    s_add_u32 m0, s46, 3072
    ds_read_b64_tr_b16 v[146:147], v185 offset:32128
    v_mfma_f32_16x16x32_bf16 v[16:19], v[128:131], v[168:171], v[16:19]
    buffer_load_dwordx4 v180, s[8:11], s43 offen lds
    v_mfma_f32_16x16x32_bf16 v[20:23], v[132:135], v[160:163], v[20:23]
    ds_read_b64_tr_b16 v[128:129], v186 offset:30880
    v_mfma_f32_16x16x32_bf16 v[24:27], v[132:135], v[164:167], v[24:27]
    ds_read_b64_tr_b16 v[130:131], v186 offset:32160
    v_mfma_f32_16x16x32_bf16 v[28:31], v[132:135], v[168:171], v[28:31]
    s_waitcnt lgkmcnt(6)
    v_mfma_f32_16x16x32_bf16 v[32:35], v[136:139], v[160:163], v[32:35]
    ds_read_b64_tr_b16 v[132:133], v185 offset:30912
    v_mfma_f32_16x16x32_bf16 v[36:39], v[136:139], v[164:167], v[36:39]
    s_add_u32 m0, s47, 23552
    ds_read_b64_tr_b16 v[134:135], v185 offset:32192
    v_mfma_f32_16x16x32_bf16 v[40:43], v[136:139], v[168:171], v[40:43]
    s_waitcnt lgkmcnt(6)
    buffer_load_dwordx4 v175, s[12:15], s44 offen lds
    v_mfma_f32_16x16x32_bf16 v[44:47], v[140:143], v[160:163], v[44:47]
    ds_read_b64_tr_b16 v[136:137], v186 offset:30944
    v_mfma_f32_16x16x32_bf16 v[48:51], v[140:143], v[164:167], v[48:51]
    ds_read_b64_tr_b16 v[138:139], v186 offset:32224
    v_mfma_f32_16x16x32_bf16 v[52:55], v[140:143], v[168:171], v[52:55]
    s_waitcnt lgkmcnt(6)
    v_mfma_f32_16x16x32_bf16 v[56:59], v[144:147], v[160:163], v[56:59]
    ds_read_b64_tr_b16 v[140:141], v185 offset:30976
    v_mfma_f32_16x16x32_bf16 v[60:63], v[144:147], v[164:167], v[60:63]
    s_add_u32 m0, s46, 4096
    ds_read_b64_tr_b16 v[142:143], v185 offset:32256
    v_mfma_f32_16x16x32_bf16 v[64:67], v[144:147], v[168:171], v[64:67]
    s_waitcnt lgkmcnt(6)
    buffer_load_dwordx4 v181, s[8:11], s43 offen lds
    v_mfma_f32_16x16x32_bf16 v[68:71], v[128:131], v[160:163], v[68:71]
    ds_read_b64_tr_b16 v[144:145], v186 offset:31008
    s_waitcnt vmcnt(10)
    v_and_b32 v7, 0xff, v5
    v_cmp_ne_u32 vcc, v249, v7
    s_cbranch_vccz L_chk_hq_ok
    s_mov_b32 s56, 0
L_chk_hq_again:
    s_sleep 8
    buffer_load_dword v5, v6, s[16:19], 0 offen sc1
    s_waitcnt vmcnt(0)
    v_and_b32 v7, 0xff, v5
    v_cmp_ne_u32 vcc, v249, v7
    s_add_u32 s56, s56, 1
    s_cmp_gt_u32 s56, 65536
    s_cbranch_scc1 L_chk_hq_ok
    s_cbranch_vccnz L_chk_hq_again
L_chk_hq_ok:
    v_mfma_f32_16x16x32_bf16 v[72:75], v[128:131], v[164:167], v[72:75]
    ds_read_b64_tr_b16 v[146:147], v186 offset:32288
    v_readlane_b32 s50, v5, 7
    v_mfma_f32_16x16x32_bf16 v[76:79], v[128:131], v[168:171], v[76:79]
    s_waitcnt vmcnt(9) lgkmcnt(6)
    s_barrier
    v_mfma_f32_16x16x32_bf16 v[80:83], v[132:135], v[160:163], v[80:83]
    ds_read_b64_tr_b16 v[128:129], v183 offset:0
    s_getreg_b32 s51, hwreg(HW_REG_XCC_ID, 2, 1)
    v_mfma_f32_16x16x32_bf16 v[84:87], v[132:135], v[164:167], v[84:87]
    s_add_u32 m0, s47, 24576
    ds_read_b64_tr_b16 v[130:131], v183 offset:1280
    ds_read_b128 v[148:151], v187 offset:12288
    v_mfma_f32_16x16x32_bf16 v[88:91], v[132:135], v[168:171], v[88:91]
    s_waitcnt lgkmcnt(7)
    buffer_load_dwordx4 v176, s[12:15], s44 offen lds
    s_bfe_u32 s52, s50, 0x80008
    v_mfma_f32_16x16x32_bf16 v[92:95], v[136:139], v[160:163], v[92:95]
    ds_read_b64_tr_b16 v[132:133], v184 offset:32
    ds_read_b128 v[152:155], v187 offset:14336
    s_cmp_gt_u32 s52, 6
    s_cselect_b32 s64, 0xf0, 0x0f
    v_mfma_f32_16x16x32_bf16 v[96:99], v[136:139], v[164:167], v[96:99]
    s_add_u32 s44, s44, s45
    ds_read_b64_tr_b16 v[134:135], v184 offset:1312
    v_mfma_f32_16x16x32_bf16 v[100:103], v[136:139], v[168:171], v[100:103]
    s_waitcnt lgkmcnt(8)
    ds_read_b128 v[156:159], v244
    v_mfma_f32_16x16x32_bf16 v[104:107], v[140:143], v[160:163], v[104:107]
    ds_read_b64_tr_b16 v[136:137], v183 offset:64
    s_cmp_gt_u32 s50, 458751
    s_cselect_b32 s52, 1, 0
    v_mfma_f32_16x16x32_bf16 v[108:111], v[140:143], v[164:167], v[108:111]
    s_add_u32 m0, s46, 5120
    ds_read_b64_tr_b16 v[138:139], v183 offset:1344
    s_xor_b32 s52, s52, s51
    v_mfma_f32_16x16x32_bf16 v[112:115], v[140:143], v[168:171], v[112:115]
    s_waitcnt lgkmcnt(9)
    buffer_load_dwordx4 v182, s[8:11], s43 offen lds
    s_and_b32 s50, s2, 7
    v_mfma_f32_16x16x32_bf16 v[116:119], v[144:147], v[160:163], v[116:119]
    ds_read_b64_tr_b16 v[140:141], v184 offset:96
    s_lshr_b32 s50, s64, s50
    v_mfma_f32_16x16x32_bf16 v[120:123], v[144:147], v[164:167], v[120:123]
    s_add_u32 s43, s43, 128
    ds_read_b64_tr_b16 v[142:143], v184 offset:1376
    s_and_b32 s50, s50, 1
    v_mfma_f32_16x16x32_bf16 v[124:127], v[144:147], v[168:171], v[124:127]
    s_waitcnt lgkmcnt(4)
    s_lshl_b32 s61, s50, 13
    s_lshl_b32 s52, s52, 13
    v_mfma_f32_16x16x32_bf16 v[8:11], v[128:131], v[148:151], v[8:11]
    ds_read_b64_tr_b16 v[144:145], v183 offset:128
    s_add_u32 s57, s57, s52
    v_mfma_f32_16x16x32_bf16 v[12:15], v[128:131], v[152:155], v[12:15]
    ds_read_b64_tr_b16 v[146:147], v183 offset:1408
    s_add_u32 s65, s65, s52
    v_mfma_f32_16x16x32_bf16 v[16:19], v[128:131], v[156:159], v[16:19]
    buffer_load_dwordx2 v[192:193], v250, s[20:23], 0 offen sc1
    v_mfma_f32_16x16x32_bf16 v[20:23], v[132:135], v[148:151], v[20:23]
    ds_read_b64_tr_b16 v[128:129], v184 offset:160
    buffer_load_dwordx2 v[194:195], v251, s[20:23], 0 offen sc1
    v_mfma_f32_16x16x32_bf16 v[24:27], v[132:135], v[152:155], v[24:27]
    ds_read_b64_tr_b16 v[130:131], v184 offset:1440
    buffer_load_dwordx2 v[196:197], v252, s[20:23], 0 offen sc1
    v_mfma_f32_16x16x32_bf16 v[28:31], v[132:135], v[156:159], v[28:31]
    s_waitcnt lgkmcnt(6)
    v_lshlrev_b32 v199, 2, v0
    v_add_u32 v199, 156672, v199
    v_mfma_f32_16x16x32_bf16 v[32:35], v[136:139], v[148:151], v[32:35]
    ds_read_b64_tr_b16 v[132:133], v183 offset:192
    s_add_u32 s58, s57, 0
    v_mfma_f32_16x16x32_bf16 v[36:39], v[136:139], v[152:155], v[36:39]
    s_lshr_b32 s50, s59, 6
    ds_read_b64_tr_b16 v[134:135], v183 offset:1472
    buffer_load_dwordx4 a[0:3], v3, s[16:19], s58 offen offset:0 sc1
    v_mfma_f32_16x16x32_bf16 v[40:43], v[136:139], v[156:159], v[40:43]
    s_waitcnt lgkmcnt(6)
    v_lshlrev_b32 v7, 4, v2
    v_add_u32 v7, 155648, v7
    v_mfma_f32_16x16x32_bf16 v[44:47], v[140:143], v[148:151], v[44:47]
    s_add_u32 s50, s50, s36
    ds_read_b64_tr_b16 v[136:137], v184 offset:224
    v_and_b32 v5, 3, v0
    v_mfma_f32_16x16x32_bf16 v[48:51], v[140:143], v[152:155], v[48:51]
    s_add_u32 s51, s59, 187
    ds_read_b64_tr_b16 v[138:139], v184 offset:1504
    v_lshl_add_u32 v5, v5, 2, v7
    v_mfma_f32_16x16x32_bf16 v[52:55], v[140:143], v[156:159], v[52:55]
    s_waitcnt lgkmcnt(6)
    buffer_load_dwordx4 a[4:7], v3, s[16:19], s58 offen offset:1024 sc1
    s_lshr_b32 s51, s51, 6
    v_mfma_f32_16x16x32_bf16 v[56:59], v[144:147], v[148:151], v[56:59]
    ds_read_b64_tr_b16 v[140:141], v183 offset:256
    s_cmp_eq_u32 s36, 3
    s_cselect_b32 vcc_lo, 0xf000f000, 0
    s_mov_b32 vcc_hi, vcc_lo
    v_mfma_f32_16x16x32_bf16 v[60:63], v[144:147], v[152:155], v[60:63]
    s_min_u32 s51, s51, 31
    ds_read_b64_tr_b16 v[142:143], v183 offset:1536
    v_cndmask_b32 v199, v199, v5, vcc
    v_mfma_f32_16x16x32_bf16 v[64:67], v[144:147], v[156:159], v[64:67]
    s_waitcnt lgkmcnt(6)
    s_mov_b32 s34, 0xaaaaaaaa
    s_mov_b32 s35, 0xaaaaaaaa
    v_mfma_f32_16x16x32_bf16 v[68:71], v[128:131], v[148:151], v[68:71]
    ds_read_b64_tr_b16 v[144:145], v184 offset:288
    buffer_load_dwordx4 a[8:11], v3, s[16:19], s58 offen offset:2048 sc1
    s_cmp_le_u32 s50, s51
    s_cselect_b32 s5, 1, 0
    v_mfma_f32_16x16x32_bf16 v[72:75], v[128:131], v[152:155], v[72:75]
    ds_read_b64_tr_b16 v[146:147], v184 offset:1568
    s_mov_b32 s32, 0xcccccccc
    v_mfma_f32_16x16x32_bf16 v[76:79], v[128:131], v[156:159], v[76:79]
    s_waitcnt lgkmcnt(6)
    s_mov_b32 s33, 0xcccccccc
    v_lshrrev_b32 v5, 8, v189
    v_mfma_f32_16x16x32_bf16 v[80:83], v[132:135], v[148:151], v[80:83]
    s_min_u32 s50, s50, s51
    ds_read_b64_tr_b16 v[128:129], v183 offset:10240
    v_bfe_u32 v5, s64, v5, 1
    v_mfma_f32_16x16x32_bf16 v[84:87], v[132:135], v[152:155], v[84:87]
    s_lshl_b32 s4, s50, 7
    ds_read_b64_tr_b16 v[130:131], v183 offset:11520
    ds_read_b128 v[160:163], v188 offset:12288
    v_mfma_f32_16x16x32_bf16 v[88:91], v[132:135], v[156:159], v[88:91]
    s_waitcnt lgkmcnt(7)
    buffer_load_dwordx4 a[12:15], v3, s[16:19], s58 offen offset:3072 sc1
    v_lshl_add_u32 v200, v5, 13, v200
    v_mfma_f32_16x16x32_bf16 v[92:95], v[136:139], v[148:151], v[92:95]
    s_lshr_b32 s50, s50, 2
    ds_read_b64_tr_b16 v[132:133], v184 offset:10272
    ds_read_b128 v[164:167], v188 offset:14336
    v_mfma_f32_16x16x32_bf16 v[96:99], v[136:139], v[152:155], v[96:99]
    s_and_b32 s3, s38, 1
    ds_read_b64_tr_b16 v[134:135], v184 offset:11552
    v_lshrrev_b32 v5, 8, v190
    v_mfma_f32_16x16x32_bf16 v[100:103], v[136:139], v[156:159], v[100:103]
    s_waitcnt lgkmcnt(8)
    ds_read_b128 v[168:171], v245
    v_bfe_u32 v5, s64, v5, 1
    v_mfma_f32_16x16x32_bf16 v[104:107], v[140:143], v[148:151], v[104:107]
    s_lshl_b32 s3, s3, 14
    ds_read_b64_tr_b16 v[136:137], v183 offset:10304
    buffer_load_dwordx4 a[16:19], v4, s[16:19], s58 offen offset:0 sc1
    v_mfma_f32_16x16x32_bf16 v[108:111], v[140:143], v[152:155], v[108:111]
    s_add_u32 s4, s4, s3
    ds_read_b64_tr_b16 v[138:139], v183 offset:11584
    v_lshl_add_u32 v201, v5, 13, v201
    v_mfma_f32_16x16x32_bf16 v[112:115], v[140:143], v[156:159], v[112:115]
    s_waitcnt lgkmcnt(9)
    v_lshrrev_b32 v5, 8, v191
    v_bfe_u32 v5, s64, v5, 1
    v_mfma_f32_16x16x32_bf16 v[116:119], v[144:147], v[148:151], v[116:119]
    ds_read_b64_tr_b16 v[140:141], v184 offset:10336
    s_add_u32 s58, s57, 65536
    v_mfma_f32_16x16x32_bf16 v[120:123], v[144:147], v[152:155], v[120:123]
    s_add_u32 s4, s4, 65536
    ds_read_b64_tr_b16 v[142:143], v184 offset:11616
    buffer_load_dwordx4 a[20:23], v3, s[16:19], s58 offen offset:0 sc1
    v_mfma_f32_16x16x32_bf16 v[124:127], v[144:147], v[156:159], v[124:127]
    s_waitcnt lgkmcnt(4)
    v_lshl_add_u32 v202, v5, 13, v202
    s_lshr_b32 s3, s64, s50
    v_mfma_f32_16x16x32_bf16 v[8:11], v[128:131], v[160:163], v[8:11]
    s_and_b32 s3, s3, 1
    ds_read_b64_tr_b16 v[144:145], v183 offset:10368
    s_lshl_b32 s3, s3, 13
    v_mfma_f32_16x16x32_bf16 v[12:15], v[128:131], v[164:167], v[12:15]
    s_add_u32 s4, s4, s3
    ds_read_b64_tr_b16 v[146:147], v183 offset:11648
    s_and_b32 s3, s36, 1
    v_mfma_f32_16x16x32_bf16 v[16:19], v[128:131], v[168:171], v[16:19]
    buffer_load_dwordx4 a[24:27], v3, s[16:19], s58 offen offset:1024 sc1
    s_lshl_b32 s3, s3, 2
    v_mfma_f32_16x16x32_bf16 v[20:23], v[132:135], v[160:163], v[20:23]
    s_xor_b32 s50, s48, s3
    ds_read_b64_tr_b16 v[128:129], v184 offset:10400
    s_mul_i32 s3, s50, 22336
    v_mfma_f32_16x16x32_bf16 v[24:27], v[132:135], v[164:167], v[24:27]
    s_lshr_b32 s51, s3, 16
    ds_read_b64_tr_b16 v[130:131], v184 offset:11680
    s_add_u32 s3, s3, 21987
    v_mfma_f32_16x16x32_bf16 v[28:31], v[132:135], v[168:171], v[28:31]
    s_waitcnt lgkmcnt(6)
    s_lshr_b32 s3, s3, 16
    s_sub_u32 s51, s3, s51
    v_mfma_f32_16x16x32_bf16 v[32:35], v[136:139], v[160:163], v[32:35]
    s_lshr_b32 s3, s48, 3
    ds_read_b64_tr_b16 v[132:133], v183 offset:10432
    buffer_load_dwordx4 a[28:31], v3, s[16:19], s58 offen offset:2048 sc1
    v_mfma_f32_16x16x32_bf16 v[36:39], v[136:139], v[164:167], v[36:39]
    s_lshl2_add_u32 s3, s49, s3
    ds_read_b64_tr_b16 v[134:135], v183 offset:11712
    s_add_u32 s3, s3, 128
    v_mfma_f32_16x16x32_bf16 v[40:43], v[136:139], v[168:171], v[40:43]
    s_waitcnt lgkmcnt(6)
    s_cmp_eq_u32 s36, 3
    s_cselect_b32 s50, s3, s50
    s_cselect_b32 s51, 0, s51
    v_mfma_f32_16x16x32_bf16 v[44:47], v[140:143], v[160:163], v[44:47]
    ds_read_b64_tr_b16 v[136:137], v184 offset:10464
    s_cmp_eq_u32 s36, 2
    s_cselect_b32 s7, 4, 11
    v_mfma_f32_16x16x32_bf16 v[48:51], v[140:143], v[164:167], v[48:51]
    ds_read_b64_tr_b16 v[138:139], v184 offset:11744
    buffer_load_dwordx4 a[32:35], v3, s[16:19], s58 offen offset:3072 sc1
    v_mfma_f32_16x16x32_bf16 v[52:55], v[140:143], v[168:171], v[52:55]
    s_waitcnt lgkmcnt(6)
    s_cmp_lt_u32 s36, 2
    s_cselect_b32 s0, -1, 0
    s_cselect_b32 s3, 0, 128
    v_mfma_f32_16x16x32_bf16 v[56:59], v[144:147], v[160:163], v[56:59]
    s_lshl_b32 s7, s7, s51
    ds_read_b64_tr_b16 v[140:141], v183 offset:10496
    s_add_u32 s50, s50, s3
    v_mfma_f32_16x16x32_bf16 v[60:63], v[144:147], v[164:167], v[60:63]
    s_lshl_b32 s6, s50, 7
    ds_read_b64_tr_b16 v[142:143], v183 offset:11776
    s_add_u32 s6, s6, s61
    v_mfma_f32_16x16x32_bf16 v[64:67], v[144:147], v[168:171], v[64:67]
    s_waitcnt lgkmcnt(6)
    buffer_load_dwordx4 a[36:39], v4, s[16:19], s58 offen offset:0 sc1
    s_add_u32 s6, s6, 65536
    v_mfma_f32_16x16x32_bf16 v[68:71], v[128:131], v[160:163], v[68:71]
    s_mov_b32 s1, s61
    ds_read_b64_tr_b16 v[144:145], v184 offset:10528
    s_lshr_b32 s3, s48, 1
    v_mfma_f32_16x16x32_bf16 v[72:75], v[128:131], v[164:167], v[72:75]
    s_lshl_b32 s3, s3, 22
    ds_read_b64_tr_b16 v[146:147], v184 offset:11808
    s_add_u32 s61, s61, s3
    v_mfma_f32_16x16x32_bf16 v[76:79], v[128:131], v[168:171], v[76:79]
    s_waitcnt vmcnt(13) lgkmcnt(6)
    s_barrier
    s_add_u32 s58, s57, 131072
    v_mfma_f32_16x16x32_bf16 v[80:83], v[132:135], v[160:163], v[80:83]
    s_and_b32 s3, s48, 1
    ds_read_b64_tr_b16 v[128:129], v183 offset:20480
    buffer_load_dwordx4 a[40:43], v3, s[16:19], s58 offen offset:0 sc1
    v_mfma_f32_16x16x32_bf16 v[84:87], v[132:135], v[164:167], v[84:87]
    s_lshl_b32 s3, s3, 20
    ds_read_b64_tr_b16 v[130:131], v183 offset:21760
    ds_read_b128 v[148:151], v187 offset:0
    v_mfma_f32_16x16x32_bf16 v[88:91], v[132:135], v[168:171], v[88:91]
    s_waitcnt lgkmcnt(7)
    s_add_u32 s61, s61, s3
    s_and_b32 s3, s48, 15
    v_mfma_f32_16x16x32_bf16 v[92:95], v[136:139], v[160:163], v[92:95]
    s_lshl_b32 s3, s3, 14
    ds_read_b64_tr_b16 v[132:133], v184 offset:20512
    ds_read_b128 v[152:155], v187 offset:2048
    v_mfma_f32_16x16x32_bf16 v[96:99], v[136:139], v[164:167], v[96:99]
    s_add_u32 s61, s61, s3
    ds_read_b64_tr_b16 v[134:135], v184 offset:21792
    buffer_load_dwordx4 a[44:47], v3, s[16:19], s58 offen offset:1024 sc1
    v_mfma_f32_16x16x32_bf16 v[100:103], v[136:139], v[168:171], v[100:103]
    s_waitcnt lgkmcnt(8)
    ds_read_b128 v[156:159], v240
    s_xor_b32 s20, s61, 0x810000
    v_mfma_f32_16x16x32_bf16 v[104:107], v[140:143], v[160:163], v[104:107]
    s_add_u32 s61, s61, 37748736
    ds_read_b64_tr_b16 v[136:137], v183 offset:20544
    s_add_u32 s20, s20, 37748736
    v_mfma_f32_16x16x32_bf16 v[108:111], v[140:143], v[164:167], v[108:111]
L_st3:
    s_cbranch_execz L_st7
    s_and_b32 s3, s40, 1
    ds_read_b64_tr_b16 v[138:139], v183 offset:21824
    s_lshl_b32 s3, s3, 12
    v_mfma_f32_16x16x32_bf16 v[112:115], v[140:143], v[168:171], v[112:115]
    s_waitcnt lgkmcnt(9)
    buffer_load_dwordx4 a[48:51], v3, s[16:19], s58 offen offset:2048 sc1
    s_lshl_b32 s50, s40, 13
    v_mfma_f32_16x16x32_bf16 v[116:119], v[144:147], v[160:163], v[116:119]
    s_sub_u32 s50, s50, s3
    ds_read_b64_tr_b16 v[140:141], v184 offset:20576
    s_add_u32 s20, s20, s50
    v_mfma_f32_16x16x32_bf16 v[120:123], v[144:147], v[164:167], v[120:123]
    s_add_u32 s21, s61, s50
    ds_read_b64_tr_b16 v[142:143], v184 offset:21856
    s_add_u32 s3, s36, 1
    v_mfma_f32_16x16x32_bf16 v[124:127], v[144:147], v[168:171], v[124:127]
    s_waitcnt lgkmcnt(4)
    s_and_b32 s3, s3, 3
    s_lshl_b32 s12, s3, 10
    v_mfma_f32_16x16x32_bf16 v[8:11], v[128:131], v[148:151], v[8:11]
    s_add_u32 s3, s36, 2
    ds_read_b64_tr_b16 v[144:145], v183 offset:20608
    buffer_load_dwordx4 a[52:55], v3, s[16:19], s58 offen offset:3072 sc1
    v_mfma_f32_16x16x32_bf16 v[12:15], v[128:131], v[152:155], v[12:15]
    s_and_b32 s3, s3, 3
    ds_read_b64_tr_b16 v[146:147], v183 offset:21888
    s_lshl_b32 s13, s3, 10
    v_mfma_f32_16x16x32_bf16 v[16:19], v[128:131], v[156:159], v[16:19]
    s_add_u32 s3, s36, 3
    s_and_b32 s3, s3, 3
    v_mfma_f32_16x16x32_bf16 v[20:23], v[132:135], v[148:151], v[20:23]
    s_lshl_b32 s14, s3, 10
    ds_read_b64_tr_b16 v[128:129], v184 offset:20640
    s_add_u32 s3, s36, 4
    v_mfma_f32_16x16x32_bf16 v[24:27], v[132:135], v[152:155], v[24:27]
    s_and_b32 s3, s3, 3
    ds_read_b64_tr_b16 v[130:131], v184 offset:21920
    buffer_load_dwordx4 a[56:59], v4, s[16:19], s58 offen offset:0 sc1
    v_mfma_f32_16x16x32_bf16 v[28:31], v[132:135], v[156:159], v[28:31]
    s_waitcnt lgkmcnt(6)
    s_waitcnt vmcnt(15)
    v_mul_f32 v193, s41, v193
    v_mfma_f32_16x16x32_bf16 v[32:35], v[136:139], v[148:151], v[32:35]
    s_lshl_b32 s15, s3, 10
    ds_read_b64_tr_b16 v[132:133], v183 offset:20672
    v_mul_f32 v195, s41, v195
    v_mfma_f32_16x16x32_bf16 v[36:39], v[136:139], v[152:155], v[36:39]
    ds_read_b64_tr_b16 v[134:135], v183 offset:21952
    s_add_u32 s58, s57, 196608
    v_mfma_f32_16x16x32_bf16 v[40:43], v[136:139], v[156:159], v[40:43]
    s_waitcnt lgkmcnt(6)
    buffer_load_dwordx4 a[60:63], v3, s[16:19], s58 offen offset:0 sc1
    v_mul_f32 v197, s41, v197
    v_mfma_f32_16x16x32_bf16 v[44:47], v[140:143], v[148:151], v[44:47]
    ds_read_b64_tr_b16 v[136:137], v184 offset:20704
    v_mfma_f32_16x16x32_bf16 v[48:51], v[140:143], v[152:155], v[48:51]
    ds_read_b64_tr_b16 v[138:139], v184 offset:21984
    v_mfma_f32_16x16x32_bf16 v[52:55], v[140:143], v[156:159], v[52:55]
    s_waitcnt lgkmcnt(6)
    v_mfma_f32_16x16x32_bf16 v[56:59], v[144:147], v[148:151], v[56:59]
    ds_read_b64_tr_b16 v[140:141], v183 offset:20736
    buffer_load_dwordx4 a[64:67], v3, s[16:19], s58 offen offset:1024 sc1
    v_mfma_f32_16x16x32_bf16 v[60:63], v[144:147], v[152:155], v[60:63]
    ds_read_b64_tr_b16 v[142:143], v183 offset:22016
    v_mfma_f32_16x16x32_bf16 v[64:67], v[144:147], v[156:159], v[64:67]
    s_waitcnt lgkmcnt(6)
    v_mfma_f32_16x16x32_bf16 v[68:71], v[128:131], v[148:151], v[68:71]
    ds_read_b64_tr_b16 v[144:145], v184 offset:20768
    v_mfma_f32_16x16x32_bf16 v[72:75], v[128:131], v[152:155], v[72:75]
    ds_read_b64_tr_b16 v[146:147], v184 offset:22048
    buffer_load_dwordx4 a[68:71], v3, s[16:19], s58 offen offset:2048 sc1
    v_mfma_f32_16x16x32_bf16 v[76:79], v[128:131], v[156:159], v[76:79]
    s_waitcnt lgkmcnt(6)
    v_mfma_f32_16x16x32_bf16 v[80:83], v[132:135], v[148:151], v[80:83]
    ds_read_b64_tr_b16 v[128:129], v183 offset:30720
    v_mfma_f32_16x16x32_bf16 v[84:87], v[132:135], v[152:155], v[84:87]
    ds_read_b64_tr_b16 v[130:131], v183 offset:32000
    ds_read_b128 v[160:163], v188 offset:0
    v_mfma_f32_16x16x32_bf16 v[88:91], v[132:135], v[156:159], v[88:91]
    s_waitcnt lgkmcnt(7)
    buffer_load_dwordx4 a[72:75], v3, s[16:19], s58 offen offset:3072 sc1
    v_mfma_f32_16x16x32_bf16 v[92:95], v[136:139], v[148:151], v[92:95]
    ds_read_b64_tr_b16 v[132:133], v184 offset:30752
    ds_read_b128 v[164:167], v188 offset:2048
    v_mfma_f32_16x16x32_bf16 v[96:99], v[136:139], v[152:155], v[96:99]
    ds_read_b64_tr_b16 v[134:135], v184 offset:32032
    v_mfma_f32_16x16x32_bf16 v[100:103], v[136:139], v[156:159], v[100:103]
    s_waitcnt lgkmcnt(8)
    ds_read_b128 v[168:171], v241
    v_mfma_f32_16x16x32_bf16 v[104:107], v[140:143], v[148:151], v[104:107]
    ds_read_b64_tr_b16 v[136:137], v183 offset:30784
    buffer_load_dwordx4 a[76:79], v4, s[16:19], s58 offen offset:0 sc1
    v_mfma_f32_16x16x32_bf16 v[108:111], v[140:143], v[152:155], v[108:111]
    ds_read_b64_tr_b16 v[138:139], v183 offset:32064
    v_mfma_f32_16x16x32_bf16 v[112:115], v[140:143], v[156:159], v[112:115]
    s_waitcnt lgkmcnt(9)
    v_mfma_f32_16x16x32_bf16 v[116:119], v[144:147], v[148:151], v[116:119]
    ds_read_b64_tr_b16 v[140:141], v184 offset:30816
    s_add_u32 s58, s57, 262144
    v_mfma_f32_16x16x32_bf16 v[120:123], v[144:147], v[152:155], v[120:123]
    ds_read_b64_tr_b16 v[142:143], v184 offset:32096
    buffer_load_dwordx4 a[80:83], v3, s[16:19], s58 offen offset:0 sc1
    v_mfma_f32_16x16x32_bf16 v[124:127], v[144:147], v[156:159], v[124:127]
    s_waitcnt lgkmcnt(4)
    v_mfma_f32_16x16x32_bf16 v[8:11], v[128:131], v[160:163], v[8:11]
    ds_read_b64_tr_b16 v[144:145], v183 offset:30848
    v_mfma_f32_16x16x32_bf16 v[12:15], v[128:131], v[164:167], v[12:15]
    ds_read_b64_tr_b16 v[146:147], v183 offset:32128
    v_mfma_f32_16x16x32_bf16 v[16:19], v[128:131], v[168:171], v[16:19]
    buffer_load_dwordx4 a[84:87], v3, s[16:19], s58 offen offset:1024 sc1
    v_mfma_f32_16x16x32_bf16 v[20:23], v[132:135], v[160:163], v[20:23]
    ds_read_b64_tr_b16 v[128:129], v184 offset:30880
    v_mfma_f32_16x16x32_bf16 v[24:27], v[132:135], v[164:167], v[24:27]
    ds_read_b64_tr_b16 v[130:131], v184 offset:32160
    v_mfma_f32_16x16x32_bf16 v[28:31], v[132:135], v[168:171], v[28:31]
    s_waitcnt lgkmcnt(6)
    v_mfma_f32_16x16x32_bf16 v[32:35], v[136:139], v[160:163], v[32:35]
    ds_read_b64_tr_b16 v[132:133], v183 offset:30912
    v_cndmask_b32 v204, v16, v17, s[34:35]
    v_mfma_f32_16x16x32_bf16 v[36:39], v[136:139], v[164:167], v[36:39]
    ds_read_b64_tr_b16 v[134:135], v183 offset:32192
    v_cndmask_b32 v205, v18, v19, s[34:35]
    v_mfma_f32_16x16x32_bf16 v[40:43], v[136:139], v[168:171], v[40:43]
    s_waitcnt lgkmcnt(6)
    v_cndmask_b32 v204, v204, v205, s[32:33]
    ds_write_b32 v199, v204 offset:0
    v_mfma_f32_16x16x32_bf16 v[44:47], v[140:143], v[160:163], v[44:47]
    ds_read_b64_tr_b16 v[136:137], v184 offset:30944
    v_cndmask_b32 v206, v28, v29, s[34:35]
    v_mfma_f32_16x16x32_bf16 v[48:51], v[140:143], v[164:167], v[48:51]
    ds_read_b64_tr_b16 v[138:139], v184 offset:32224
    v_cndmask_b32 v207, v30, v31, s[34:35]
    v_mfma_f32_16x16x32_bf16 v[52:55], v[140:143], v[168:171], v[52:55]
    s_waitcnt lgkmcnt(7)
    v_cndmask_b32 v206, v206, v207, s[32:33]
    ds_write_b32 v199, v206 offset:64
    v_mfma_f32_16x16x32_bf16 v[56:59], v[144:147], v[160:163], v[56:59]
    ds_read_b64_tr_b16 v[140:141], v183 offset:30976
    v_cndmask_b32 v204, v40, v41, s[34:35]
    v_mfma_f32_16x16x32_bf16 v[60:63], v[144:147], v[164:167], v[60:63]
    ds_read_b64_tr_b16 v[142:143], v183 offset:32256
    v_cndmask_b32 v205, v42, v43, s[34:35]
    v_mfma_f32_16x16x32_bf16 v[64:67], v[144:147], v[168:171], v[64:67]
    s_waitcnt lgkmcnt(8)
    v_cndmask_b32 v204, v204, v205, s[32:33]
    ds_write_b32 v199, v204 offset:128
    v_mfma_f32_16x16x32_bf16 v[68:71], v[128:131], v[160:163], v[68:71]
    ds_read_b64_tr_b16 v[144:145], v184 offset:31008
    v_cndmask_b32 v206, v52, v53, s[34:35]
    v_mfma_f32_16x16x32_bf16 v[72:75], v[128:131], v[164:167], v[72:75]
    ds_read_b64_tr_b16 v[146:147], v184 offset:32288
    v_cndmask_b32 v207, v54, v55, s[34:35]
    v_mfma_f32_16x16x32_bf16 v[76:79], v[128:131], v[168:171], v[76:79]
    s_waitcnt lgkmcnt(9)
    v_cndmask_b32 v206, v206, v207, s[32:33]
    ds_write_b32 v199, v206 offset:192
    v_mfma_f32_16x16x32_bf16 v[80:83], v[132:135], v[160:163], v[80:83]
    v_cndmask_b32 v204, v64, v65, s[34:35]
    v_cndmask_b32 v205, v66, v67, s[34:35]
    v_mfma_f32_16x16x32_bf16 v[84:87], v[132:135], v[164:167], v[84:87]
    v_cndmask_b32 v204, v204, v205, s[32:33]
    ds_write_b32 v199, v204 offset:256
    v_mfma_f32_16x16x32_bf16 v[88:91], v[132:135], v[168:171], v[88:91]
    s_waitcnt lgkmcnt(8)
    v_mfma_f32_16x16x32_bf16 v[92:95], v[136:139], v[160:163], v[92:95]
    v_cndmask_b32 v206, v76, v77, s[34:35]
    v_cndmask_b32 v207, v78, v79, s[34:35]
    v_mfma_f32_16x16x32_bf16 v[96:99], v[136:139], v[164:167], v[96:99]
    v_cndmask_b32 v206, v206, v207, s[32:33]
    ds_write_b32 v199, v206 offset:320
    v_mfma_f32_16x16x32_bf16 v[100:103], v[136:139], v[168:171], v[100:103]
    s_waitcnt lgkmcnt(6)
    s_waitcnt lgkmcnt(2)
    s_barrier
    v_mfma_f32_16x16x32_bf16 v[104:107], v[140:143], v[160:163], v[104:107]
    ds_read_b128 v[208:211], v7 offset:0
    v_cndmask_b32 v204, v88, v89, s[34:35]
    v_mfma_f32_16x16x32_bf16 v[108:111], v[140:143], v[164:167], v[108:111]
    ds_read_b128 v[212:215], v7 offset:64
    v_cndmask_b32 v205, v90, v91, s[34:35]
    v_mfma_f32_16x16x32_bf16 v[112:115], v[140:143], v[168:171], v[112:115]
    ds_read_b128 v[216:219], v7 offset:128
    v_cndmask_b32 v204, v204, v205, s[32:33]
    v_mfma_f32_16x16x32_bf16 v[116:119], v[144:147], v[160:163], v[116:119]
    ds_read_b128 v[220:223], v7 offset:192
    ds_write_b32 v199, v204 offset:384
    v_mfma_f32_16x16x32_bf16 v[120:123], v[144:147], v[164:167], v[120:123]
    v_cndmask_b32 v206, v100, v101, s[34:35]
    v_cndmask_b32 v207, v102, v103, s[34:35]
    v_mfma_f32_16x16x32_bf16 v[124:127], v[144:147], v[168:171], v[124:127]
    v_cndmask_b32 v206, v206, v207, s[32:33]
    ds_write_b32 v199, v206 offset:448
    s_cmp_eq_u32 s38, 1
    s_cbranch_scc1 L_q
    s_waitcnt lgkmcnt(4)
    v_pk_fma_f32 v[128:129], v[208:209], v[192:193], v[8:9] op_sel_hi:[1,0,1] neg_lo:[0,1,0] neg_hi:[0,1,0]
    v_pk_fma_f32 v[130:131], v[210:211], v[192:193], v[10:11] op_sel_hi:[1,0,1] neg_lo:[0,1,0] neg_hi:[0,1,0]
    v_pk_fma_f32 v[132:133], v[212:213], v[192:193], v[20:21] op_sel_hi:[1,0,1] neg_lo:[0,1,0] neg_hi:[0,1,0]
    v_pk_fma_f32 v[134:135], v[214:215], v[192:193], v[22:23] op_sel_hi:[1,0,1] neg_lo:[0,1,0] neg_hi:[0,1,0]
    v_pk_mul_f32 v[128:129], v[128:129], v[192:193] op_sel:[0,1] op_sel_hi:[1,1]
    v_pk_mul_f32 v[130:131], v[130:131], v[192:193] op_sel:[0,1] op_sel_hi:[1,1]
    v_pk_mul_f32 v[132:133], v[132:133], v[192:193] op_sel:[0,1] op_sel_hi:[1,1]
    v_pk_mul_f32 v[134:135], v[134:135], v[192:193] op_sel:[0,1] op_sel_hi:[1,1]
    buffer_load_dwordx4 a[88:91], v3, s[16:19], s58 offen offset:2048 sc1
    v_exp_f32 v136, v128
    v_exp_f32 v137, v129
    v_exp_f32 v138, v130
    v_exp_f32 v139, v131
    v_exp_f32 v140, v132
    v_exp_f32 v141, v133
    v_exp_f32 v142, v134
    v_exp_f32 v143, v135
    v_pk_add_f32 v[136:137], v[136:137], 1.0 op_sel_hi:[1,0]
    v_pk_add_f32 v[138:139], v[138:139], 1.0 op_sel_hi:[1,0]
    v_pk_add_f32 v[140:141], v[140:141], 1.0 op_sel_hi:[1,0]
    v_pk_add_f32 v[142:143], v[142:143], 1.0 op_sel_hi:[1,0]
    buffer_load_dwordx4 a[92:95], v3, s[16:19], s58 offen offset:3072 sc1
    v_rcp_f32 v136, v136
    v_rcp_f32 v137, v137
    v_rcp_f32 v138, v138
    v_rcp_f32 v139, v139
    v_rcp_f32 v140, v140
    v_rcp_f32 v141, v141
    v_rcp_f32 v142, v142
    v_rcp_f32 v143, v143
    v_pk_mul_f32 v[128:129], v[128:129], v[136:137]
    v_pk_mul_f32 v[130:131], v[130:131], v[138:139]
    v_pk_mul_f32 v[132:133], v[132:133], v[140:141]
    v_pk_mul_f32 v[134:135], v[134:135], v[142:143]
    v_cvt_pk_bf16_f32 v144, v128, v129
    v_cvt_pk_bf16_f32 v145, v130, v131
    v_cvt_pk_bf16_f32 v146, v132, v133
    v_cvt_pk_bf16_f32 v147, v134, v135
    buffer_store_dwordx4 v[144:147], v200, s[16:19], s66 offen sc1
    v_cndmask_b32 v204, v112, v113, s[34:35]
    v_cndmask_b32 v205, v114, v115, s[34:35]
    v_cndmask_b32 v204, v204, v205, s[32:33]
    ds_write_b32 v199, v204 offset:512
    v_cndmask_b32 v206, v124, v125, s[34:35]
    v_cndmask_b32 v207, v126, v127, s[34:35]
    v_cndmask_b32 v206, v206, v207, s[32:33]
    ds_write_b32 v199, v206 offset:576
    v_pk_fma_f32 v[128:129], v[208:209], v[194:195], v[12:13] op_sel_hi:[1,0,1] neg_lo:[0,1,0] neg_hi:[0,1,0]
    v_pk_fma_f32 v[130:131], v[210:211], v[194:195], v[14:15] op_sel_hi:[1,0,1] neg_lo:[0,1,0] neg_hi:[0,1,0]
    v_pk_fma_f32 v[132:133], v[212:213], v[194:195], v[24:25] op_sel_hi:[1,0,1] neg_lo:[0,1,0] neg_hi:[0,1,0]
    v_pk_fma_f32 v[134:135], v[214:215], v[194:195], v[26:27] op_sel_hi:[1,0,1] neg_lo:[0,1,0] neg_hi:[0,1,0]
    v_pk_mul_f32 v[128:129], v[128:129], v[194:195] op_sel:[0,1] op_sel_hi:[1,1]
    v_pk_mul_f32 v[130:131], v[130:131], v[194:195] op_sel:[0,1] op_sel_hi:[1,1]
    v_pk_mul_f32 v[132:133], v[132:133], v[194:195] op_sel:[0,1] op_sel_hi:[1,1]
    v_pk_mul_f32 v[134:135], v[134:135], v[194:195] op_sel:[0,1] op_sel_hi:[1,1]
    buffer_load_dwordx4 a[96:99], v4, s[16:19], s58 offen offset:0 sc1
    v_exp_f32 v136, v128
    v_exp_f32 v137, v129
    v_exp_f32 v138, v130
    v_exp_f32 v139, v131
    v_exp_f32 v140, v132
    v_exp_f32 v141, v133
    v_exp_f32 v142, v134
    v_exp_f32 v143, v135
    v_pk_add_f32 v[136:137], v[136:137], 1.0 op_sel_hi:[1,0]
    v_pk_add_f32 v[138:139], v[138:139], 1.0 op_sel_hi:[1,0]
    v_pk_add_f32 v[140:141], v[140:141], 1.0 op_sel_hi:[1,0]
    v_pk_add_f32 v[142:143], v[142:143], 1.0 op_sel_hi:[1,0]
    s_add_u32 s58, s57, 327680
    buffer_load_dwordx4 a[100:103], v3, s[16:19], s58 offen offset:0 sc1
    v_rcp_f32 v136, v136
    v_rcp_f32 v137, v137
    v_rcp_f32 v138, v138
    v_rcp_f32 v139, v139
    v_rcp_f32 v140, v140
    v_rcp_f32 v141, v141
    v_rcp_f32 v142, v142
    v_rcp_f32 v143, v143
    v_pk_mul_f32 v[128:129], v[128:129], v[136:137]
    v_pk_mul_f32 v[130:131], v[130:131], v[138:139]
    v_pk_mul_f32 v[132:133], v[132:133], v[140:141]
    v_pk_mul_f32 v[134:135], v[134:135], v[142:143]
    v_cvt_pk_bf16_f32 v148, v128, v129
    v_cvt_pk_bf16_f32 v149, v130, v131
    v_cvt_pk_bf16_f32 v150, v132, v133
    v_cvt_pk_bf16_f32 v151, v134, v135
    buffer_store_dwordx4 v[148:151], v201, s[16:19], s66 offen sc1
    s_waitcnt lgkmcnt(0)
    s_barrier
    ds_read_b128 v[224:227], v7 offset:256
    ds_read_b128 v[228:231], v7 offset:320
    ds_read_b128 v[232:235], v7 offset:384
    ds_read_b128 v[236:239], v7 offset:448
    ds_read_b128 v[240:243], v7 offset:512
    ds_read_b128 v[244:247], v7 offset:576
    v_pk_fma_f32 v[128:129], v[208:209], v[196:197], v[16:17] op_sel_hi:[1,0,1] neg_lo:[0,1,0] neg_hi:[0,1,0]
    v_pk_fma_f32 v[130:131], v[210:211], v[196:197], v[18:19] op_sel_hi:[1,0,1] neg_lo:[0,1,0] neg_hi:[0,1,0]
    v_pk_fma_f32 v[132:133], v[212:213], v[196:197], v[28:29] op_sel_hi:[1,0,1] neg_lo:[0,1,0] neg_hi:[0,1,0]
    v_pk_fma_f32 v[134:135], v[214:215], v[196:197], v[30:31] op_sel_hi:[1,0,1] neg_lo:[0,1,0] neg_hi:[0,1,0]
    v_pk_mul_f32 v[128:129], v[128:129], v[196:197] op_sel:[0,1] op_sel_hi:[1,1]
    v_pk_mul_f32 v[130:131], v[130:131], v[196:197] op_sel:[0,1] op_sel_hi:[1,1]
    v_pk_mul_f32 v[132:133], v[132:133], v[196:197] op_sel:[0,1] op_sel_hi:[1,1]
    v_pk_mul_f32 v[134:135], v[134:135], v[196:197] op_sel:[0,1] op_sel_hi:[1,1]
    buffer_load_dwordx4 a[104:107], v3, s[16:19], s58 offen offset:1024 sc1
    v_exp_f32 v136, v128
    v_exp_f32 v137, v129
    v_exp_f32 v138, v130
    v_exp_f32 v139, v131
    v_exp_f32 v140, v132
    v_exp_f32 v141, v133
    v_exp_f32 v142, v134
    v_exp_f32 v143, v135
    v_pk_add_f32 v[136:137], v[136:137], 1.0 op_sel_hi:[1,0]
    v_pk_add_f32 v[138:139], v[138:139], 1.0 op_sel_hi:[1,0]
    v_pk_add_f32 v[140:141], v[140:141], 1.0 op_sel_hi:[1,0]
    v_pk_add_f32 v[142:143], v[142:143], 1.0 op_sel_hi:[1,0]
    v_rcp_f32 v136, v136
    v_rcp_f32 v137, v137
    v_rcp_f32 v138, v138
    v_rcp_f32 v139, v139
    v_rcp_f32 v140, v140
    v_rcp_f32 v141, v141
    v_rcp_f32 v142, v142
    v_rcp_f32 v143, v143
    v_pk_mul_f32 v[128:129], v[128:129], v[136:137]
    v_pk_mul_f32 v[130:131], v[130:131], v[138:139]
    v_pk_mul_f32 v[132:133], v[132:133], v[140:141]
    v_pk_mul_f32 v[134:135], v[134:135], v[142:143]
    v_cvt_pk_bf16_f32 v144, v128, v129
    v_cvt_pk_bf16_f32 v145, v130, v131
    v_cvt_pk_bf16_f32 v146, v132, v133
    v_cvt_pk_bf16_f32 v147, v134, v135
    buffer_store_dwordx4 v[144:147], v202, s[16:19], s66 offen sc1
    v_pk_fma_f32 v[128:129], v[216:217], v[192:193], v[32:33] op_sel_hi:[1,0,1] neg_lo:[0,1,0] neg_hi:[0,1,0]
    v_pk_fma_f32 v[130:131], v[218:219], v[192:193], v[34:35] op_sel_hi:[1,0,1] neg_lo:[0,1,0] neg_hi:[0,1,0]
    v_pk_fma_f32 v[132:133], v[220:221], v[192:193], v[44:45] op_sel_hi:[1,0,1] neg_lo:[0,1,0] neg_hi:[0,1,0]
    v_pk_fma_f32 v[134:135], v[222:223], v[192:193], v[46:47] op_sel_hi:[1,0,1] neg_lo:[0,1,0] neg_hi:[0,1,0]
    v_pk_mul_f32 v[128:129], v[128:129], v[192:193] op_sel:[0,1] op_sel_hi:[1,1]
    v_pk_mul_f32 v[130:131], v[130:131], v[192:193] op_sel:[0,1] op_sel_hi:[1,1]
    v_pk_mul_f32 v[132:133], v[132:133], v[192:193] op_sel:[0,1] op_sel_hi:[1,1]
    v_pk_mul_f32 v[134:135], v[134:135], v[192:193] op_sel:[0,1] op_sel_hi:[1,1]
    buffer_load_dwordx4 a[108:111], v3, s[16:19], s58 offen offset:2048 sc1
    v_exp_f32 v136, v128
    v_exp_f32 v137, v129
    v_exp_f32 v138, v130
    v_exp_f32 v139, v131
    v_exp_f32 v140, v132
    v_exp_f32 v141, v133
    v_exp_f32 v142, v134
    v_exp_f32 v143, v135
    v_pk_add_f32 v[136:137], v[136:137], 1.0 op_sel_hi:[1,0]
    v_pk_add_f32 v[138:139], v[138:139], 1.0 op_sel_hi:[1,0]
    v_pk_add_f32 v[140:141], v[140:141], 1.0 op_sel_hi:[1,0]
    v_pk_add_f32 v[142:143], v[142:143], 1.0 op_sel_hi:[1,0]
    buffer_load_dwordx4 a[112:115], v3, s[16:19], s58 offen offset:3072 sc1
    v_rcp_f32 v136, v136
    v_rcp_f32 v137, v137
    v_rcp_f32 v138, v138
    v_rcp_f32 v139, v139
    v_rcp_f32 v140, v140
    v_rcp_f32 v141, v141
    v_rcp_f32 v142, v142
    v_rcp_f32 v143, v143
    v_pk_mul_f32 v[128:129], v[128:129], v[136:137]
    v_pk_mul_f32 v[130:131], v[130:131], v[138:139]
    v_pk_mul_f32 v[132:133], v[132:133], v[140:141]
    v_pk_mul_f32 v[134:135], v[134:135], v[142:143]
    v_cvt_pk_bf16_f32 v148, v128, v129
    v_cvt_pk_bf16_f32 v149, v130, v131
    v_cvt_pk_bf16_f32 v150, v132, v133
    v_cvt_pk_bf16_f32 v151, v134, v135
    buffer_store_dwordx4 v[148:151], v200, s[16:19], s67 offen sc1
    v_pk_fma_f32 v[128:129], v[216:217], v[194:195], v[36:37] op_sel_hi:[1,0,1] neg_lo:[0,1,0] neg_hi:[0,1,0]
    v_pk_fma_f32 v[130:131], v[218:219], v[194:195], v[38:39] op_sel_hi:[1,0,1] neg_lo:[0,1,0] neg_hi:[0,1,0]
    v_pk_fma_f32 v[132:133], v[220:221], v[194:195], v[48:49] op_sel_hi:[1,0,1] neg_lo:[0,1,0] neg_hi:[0,1,0]
    v_pk_fma_f32 v[134:135], v[222:223], v[194:195], v[50:51] op_sel_hi:[1,0,1] neg_lo:[0,1,0] neg_hi:[0,1,0]
    v_pk_mul_f32 v[128:129], v[128:129], v[194:195] op_sel:[0,1] op_sel_hi:[1,1]
    v_pk_mul_f32 v[130:131], v[130:131], v[194:195] op_sel:[0,1] op_sel_hi:[1,1]
    v_pk_mul_f32 v[132:133], v[132:133], v[194:195] op_sel:[0,1] op_sel_hi:[1,1]
    v_pk_mul_f32 v[134:135], v[134:135], v[194:195] op_sel:[0,1] op_sel_hi:[1,1]
    buffer_load_dwordx4 a[116:119], v4, s[16:19], s58 offen offset:0 sc1
    v_exp_f32 v136, v128
    v_exp_f32 v137, v129
    v_exp_f32 v138, v130
    v_exp_f32 v139, v131
    v_exp_f32 v140, v132
    v_exp_f32 v141, v133
    v_exp_f32 v142, v134
    v_exp_f32 v143, v135
    v_pk_add_f32 v[136:137], v[136:137], 1.0 op_sel_hi:[1,0]
    v_pk_add_f32 v[138:139], v[138:139], 1.0 op_sel_hi:[1,0]
    v_pk_add_f32 v[140:141], v[140:141], 1.0 op_sel_hi:[1,0]
    v_pk_add_f32 v[142:143], v[142:143], 1.0 op_sel_hi:[1,0]
    s_add_u32 s58, s57, 393216
    v_or_b32 v188, s72, v3
    buffer_load_dwordx4 a[120:123], v188, s[16:19], s58 offen offset:0 sc1
    v_rcp_f32 v136, v136
    v_rcp_f32 v137, v137
    v_rcp_f32 v138, v138
    v_rcp_f32 v139, v139
    v_rcp_f32 v140, v140
    v_rcp_f32 v141, v141
    v_rcp_f32 v142, v142
    v_rcp_f32 v143, v143
    v_pk_mul_f32 v[128:129], v[128:129], v[136:137]
    v_pk_mul_f32 v[130:131], v[130:131], v[138:139]
    v_pk_mul_f32 v[132:133], v[132:133], v[140:141]
    v_pk_mul_f32 v[134:135], v[134:135], v[142:143]
    v_cvt_pk_bf16_f32 v144, v128, v129
    v_cvt_pk_bf16_f32 v145, v130, v131
    v_cvt_pk_bf16_f32 v146, v132, v133
    v_cvt_pk_bf16_f32 v147, v134, v135
    buffer_store_dwordx4 v[144:147], v201, s[16:19], s67 offen sc1
    v_pk_fma_f32 v[128:129], v[216:217], v[196:197], v[40:41] op_sel_hi:[1,0,1] neg_lo:[0,1,0] neg_hi:[0,1,0]
    v_pk_fma_f32 v[130:131], v[218:219], v[196:197], v[42:43] op_sel_hi:[1,0,1] neg_lo:[0,1,0] neg_hi:[0,1,0]
    v_pk_fma_f32 v[132:133], v[220:221], v[196:197], v[52:53] op_sel_hi:[1,0,1] neg_lo:[0,1,0] neg_hi:[0,1,0]
    v_pk_fma_f32 v[134:135], v[222:223], v[196:197], v[54:55] op_sel_hi:[1,0,1] neg_lo:[0,1,0] neg_hi:[0,1,0]
    v_pk_mul_f32 v[128:129], v[128:129], v[196:197] op_sel:[0,1] op_sel_hi:[1,1]
    v_pk_mul_f32 v[130:131], v[130:131], v[196:197] op_sel:[0,1] op_sel_hi:[1,1]
    v_pk_mul_f32 v[132:133], v[132:133], v[196:197] op_sel:[0,1] op_sel_hi:[1,1]
    v_pk_mul_f32 v[134:135], v[134:135], v[196:197] op_sel:[0,1] op_sel_hi:[1,1]
    buffer_load_dwordx4 a[124:127], v188, s[16:19], s58 offen offset:1024 sc1
    v_exp_f32 v136, v128
    v_exp_f32 v137, v129
    v_exp_f32 v138, v130
    v_exp_f32 v139, v131
    v_exp_f32 v140, v132
    v_exp_f32 v141, v133
    v_exp_f32 v142, v134
    v_exp_f32 v143, v135
    v_pk_add_f32 v[136:137], v[136:137], 1.0 op_sel_hi:[1,0]
    v_pk_add_f32 v[138:139], v[138:139], 1.0 op_sel_hi:[1,0]
    v_pk_add_f32 v[140:141], v[140:141], 1.0 op_sel_hi:[1,0]
    v_pk_add_f32 v[142:143], v[142:143], 1.0 op_sel_hi:[1,0]
    v_rcp_f32 v136, v136
    v_rcp_f32 v137, v137
    v_rcp_f32 v138, v138
    v_rcp_f32 v139, v139
    v_rcp_f32 v140, v140
    v_rcp_f32 v141, v141
    v_rcp_f32 v142, v142
    v_rcp_f32 v143, v143
    v_pk_mul_f32 v[128:129], v[128:129], v[136:137]
    v_pk_mul_f32 v[130:131], v[130:131], v[138:139]
    v_pk_mul_f32 v[132:133], v[132:133], v[140:141]
    v_pk_mul_f32 v[134:135], v[134:135], v[142:143]
    v_cvt_pk_bf16_f32 v148, v128, v129
    v_cvt_pk_bf16_f32 v149, v130, v131
    v_cvt_pk_bf16_f32 v150, v132, v133
    v_cvt_pk_bf16_f32 v151, v134, v135
    buffer_store_dwordx4 v[148:151], v202, s[16:19], s67 offen sc1
    s_waitcnt lgkmcnt(4)
    v_pk_fma_f32 v[128:129], v[224:225], v[192:193], v[56:57] op_sel_hi:[1,0,1] neg_lo:[0,1,0] neg_hi:[0,1,0]
    v_pk_fma_f32 v[130:131], v[226:227], v[192:193], v[58:59] op_sel_hi:[1,0,1] neg_lo:[0,1,0] neg_hi:[0,1,0]
    v_pk_fma_f32 v[132:133], v[228:229], v[192:193], v[68:69] op_sel_hi:[1,0,1] neg_lo:[0,1,0] neg_hi:[0,1,0]
    v_pk_fma_f32 v[134:135], v[230:231], v[192:193], v[70:71] op_sel_hi:[1,0,1] neg_lo:[0,1,0] neg_hi:[0,1,0]
    v_pk_mul_f32 v[128:129], v[128:129], v[192:193] op_sel:[0,1] op_sel_hi:[1,1]
    v_pk_mul_f32 v[130:131], v[130:131], v[192:193] op_sel:[0,1] op_sel_hi:[1,1]
    v_pk_mul_f32 v[132:133], v[132:133], v[192:193] op_sel:[0,1] op_sel_hi:[1,1]
    v_pk_mul_f32 v[134:135], v[134:135], v[192:193] op_sel:[0,1] op_sel_hi:[1,1]
    buffer_load_dwordx4 a[128:131], v188, s[16:19], s58 offen offset:2048 sc1
    v_exp_f32 v136, v128
    v_exp_f32 v137, v129
    v_exp_f32 v138, v130
    v_exp_f32 v139, v131
    v_exp_f32 v140, v132
    v_exp_f32 v141, v133
    v_exp_f32 v142, v134
    v_exp_f32 v143, v135
    v_pk_add_f32 v[136:137], v[136:137], 1.0 op_sel_hi:[1,0]
    v_pk_add_f32 v[138:139], v[138:139], 1.0 op_sel_hi:[1,0]
    v_pk_add_f32 v[140:141], v[140:141], 1.0 op_sel_hi:[1,0]
    v_pk_add_f32 v[142:143], v[142:143], 1.0 op_sel_hi:[1,0]
    buffer_load_dwordx4 a[132:135], v188, s[16:19], s58 offen offset:3072 sc1
    v_rcp_f32 v136, v136
    v_rcp_f32 v137, v137
    v_rcp_f32 v138, v138
    v_rcp_f32 v139, v139
    v_rcp_f32 v140, v140
    v_rcp_f32 v141, v141
    v_rcp_f32 v142, v142
    v_rcp_f32 v143, v143
    v_pk_mul_f32 v[128:129], v[128:129], v[136:137]
    v_pk_mul_f32 v[130:131], v[130:131], v[138:139]
    v_pk_mul_f32 v[132:133], v[132:133], v[140:141]
    v_pk_mul_f32 v[134:135], v[134:135], v[142:143]
    v_cvt_pk_bf16_f32 v144, v128, v129
    v_cvt_pk_bf16_f32 v145, v130, v131
    v_cvt_pk_bf16_f32 v146, v132, v133
    v_cvt_pk_bf16_f32 v147, v134, v135
    buffer_store_dwordx4 v[144:147], v200, s[16:19], s68 offen sc1
    v_pk_fma_f32 v[128:129], v[224:225], v[194:195], v[60:61] op_sel_hi:[1,0,1] neg_lo:[0,1,0] neg_hi:[0,1,0]
    v_pk_fma_f32 v[130:131], v[226:227], v[194:195], v[62:63] op_sel_hi:[1,0,1] neg_lo:[0,1,0] neg_hi:[0,1,0]
    v_pk_fma_f32 v[132:133], v[228:229], v[194:195], v[72:73] op_sel_hi:[1,0,1] neg_lo:[0,1,0] neg_hi:[0,1,0]
    v_pk_fma_f32 v[134:135], v[230:231], v[194:195], v[74:75] op_sel_hi:[1,0,1] neg_lo:[0,1,0] neg_hi:[0,1,0]
    v_pk_mul_f32 v[128:129], v[128:129], v[194:195] op_sel:[0,1] op_sel_hi:[1,1]
    v_pk_mul_f32 v[130:131], v[130:131], v[194:195] op_sel:[0,1] op_sel_hi:[1,1]
    v_pk_mul_f32 v[132:133], v[132:133], v[194:195] op_sel:[0,1] op_sel_hi:[1,1]
    v_pk_mul_f32 v[134:135], v[134:135], v[194:195] op_sel:[0,1] op_sel_hi:[1,1]
    v_or_b32 v188, s72, v4
    buffer_load_dwordx4 a[136:139], v188, s[16:19], s58 offen offset:0 sc1
    v_exp_f32 v136, v128
    v_exp_f32 v137, v129
    v_exp_f32 v138, v130
    v_exp_f32 v139, v131
    v_exp_f32 v140, v132
    v_exp_f32 v141, v133
    v_exp_f32 v142, v134
    v_exp_f32 v143, v135
    v_pk_add_f32 v[136:137], v[136:137], 1.0 op_sel_hi:[1,0]
    v_pk_add_f32 v[138:139], v[138:139], 1.0 op_sel_hi:[1,0]
    v_pk_add_f32 v[140:141], v[140:141], 1.0 op_sel_hi:[1,0]
    v_pk_add_f32 v[142:143], v[142:143], 1.0 op_sel_hi:[1,0]
    s_add_u32 s58, s36, 2
    s_and_b32 s58, s58, 2
    s_mul_i32 s58, s58, 1536
    s_add_u32 s58, s58, s65
    s_add_u32 s65, s65, 16384
    buffer_load_dwordx4 a[140:143], v3, s[16:19], s58 offen offset:0 sc1
    v_rcp_f32 v136, v136
    v_rcp_f32 v137, v137
    v_rcp_f32 v138, v138
    v_rcp_f32 v139, v139
    v_rcp_f32 v140, v140
    v_rcp_f32 v141, v141
    v_rcp_f32 v142, v142
    v_rcp_f32 v143, v143
    v_pk_mul_f32 v[128:129], v[128:129], v[136:137]
    v_pk_mul_f32 v[130:131], v[130:131], v[138:139]
    v_pk_mul_f32 v[132:133], v[132:133], v[140:141]
    v_pk_mul_f32 v[134:135], v[134:135], v[142:143]
    v_cvt_pk_bf16_f32 v148, v128, v129
    v_cvt_pk_bf16_f32 v149, v130, v131
    v_cvt_pk_bf16_f32 v150, v132, v133
    v_cvt_pk_bf16_f32 v151, v134, v135
    buffer_store_dwordx4 v[148:151], v201, s[16:19], s68 offen sc1
    v_pk_fma_f32 v[128:129], v[224:225], v[196:197], v[64:65] op_sel_hi:[1,0,1] neg_lo:[0,1,0] neg_hi:[0,1,0]
    v_pk_fma_f32 v[130:131], v[226:227], v[196:197], v[66:67] op_sel_hi:[1,0,1] neg_lo:[0,1,0] neg_hi:[0,1,0]
    v_pk_fma_f32 v[132:133], v[228:229], v[196:197], v[76:77] op_sel_hi:[1,0,1] neg_lo:[0,1,0] neg_hi:[0,1,0]
    v_pk_fma_f32 v[134:135], v[230:231], v[196:197], v[78:79] op_sel_hi:[1,0,1] neg_lo:[0,1,0] neg_hi:[0,1,0]
    v_pk_mul_f32 v[128:129], v[128:129], v[196:197] op_sel:[0,1] op_sel_hi:[1,1]
    v_pk_mul_f32 v[130:131], v[130:131], v[196:197] op_sel:[0,1] op_sel_hi:[1,1]
    v_pk_mul_f32 v[132:133], v[132:133], v[196:197] op_sel:[0,1] op_sel_hi:[1,1]
    v_pk_mul_f32 v[134:135], v[134:135], v[196:197] op_sel:[0,1] op_sel_hi:[1,1]
    buffer_load_dwordx4 a[144:147], v3, s[16:19], s58 offen offset:1024 sc1
    v_exp_f32 v136, v128
    v_exp_f32 v137, v129
    v_exp_f32 v138, v130
    v_exp_f32 v139, v131
    v_exp_f32 v140, v132
    v_exp_f32 v141, v133
    v_exp_f32 v142, v134
    v_exp_f32 v143, v135
    v_pk_add_f32 v[136:137], v[136:137], 1.0 op_sel_hi:[1,0]
    v_pk_add_f32 v[138:139], v[138:139], 1.0 op_sel_hi:[1,0]
    v_pk_add_f32 v[140:141], v[140:141], 1.0 op_sel_hi:[1,0]
    v_pk_add_f32 v[142:143], v[142:143], 1.0 op_sel_hi:[1,0]
    v_rcp_f32 v136, v136
    v_rcp_f32 v137, v137
    v_rcp_f32 v138, v138
    v_rcp_f32 v139, v139
    v_rcp_f32 v140, v140
    v_rcp_f32 v141, v141
    v_rcp_f32 v142, v142
    v_rcp_f32 v143, v143
    v_pk_mul_f32 v[128:129], v[128:129], v[136:137]
    v_pk_mul_f32 v[130:131], v[130:131], v[138:139]
    v_pk_mul_f32 v[132:133], v[132:133], v[140:141]
    v_pk_mul_f32 v[134:135], v[134:135], v[142:143]
    v_cvt_pk_bf16_f32 v144, v128, v129
    v_cvt_pk_bf16_f32 v145, v130, v131
    v_cvt_pk_bf16_f32 v146, v132, v133
    v_cvt_pk_bf16_f32 v147, v134, v135
    buffer_store_dwordx4 v[144:147], v202, s[16:19], s68 offen sc1
    s_waitcnt lgkmcnt(2)
    v_pk_fma_f32 v[128:129], v[232:233], v[192:193], v[80:81] op_sel_hi:[1,0,1] neg_lo:[0,1,0] neg_hi:[0,1,0]
    v_pk_fma_f32 v[130:131], v[234:235], v[192:193], v[82:83] op_sel_hi:[1,0,1] neg_lo:[0,1,0] neg_hi:[0,1,0]
    v_pk_fma_f32 v[132:133], v[236:237], v[192:193], v[92:93] op_sel_hi:[1,0,1] neg_lo:[0,1,0] neg_hi:[0,1,0]
    v_pk_fma_f32 v[134:135], v[238:239], v[192:193], v[94:95] op_sel_hi:[1,0,1] neg_lo:[0,1,0] neg_hi:[0,1,0]
    v_pk_mul_f32 v[128:129], v[128:129], v[192:193] op_sel:[0,1] op_sel_hi:[1,1]
    v_pk_mul_f32 v[130:131], v[130:131], v[192:193] op_sel:[0,1] op_sel_hi:[1,1]
    v_pk_mul_f32 v[132:133], v[132:133], v[192:193] op_sel:[0,1] op_sel_hi:[1,1]
    v_pk_mul_f32 v[134:135], v[134:135], v[192:193] op_sel:[0,1] op_sel_hi:[1,1]
    buffer_load_dwordx4 a[148:151], v3, s[16:19], s58 offen offset:2048 sc1
    v_exp_f32 v136, v128
    v_exp_f32 v137, v129
    v_exp_f32 v138, v130
    v_exp_f32 v139, v131
    v_exp_f32 v140, v132
    v_exp_f32 v141, v133
    v_exp_f32 v142, v134
    v_exp_f32 v143, v135
    v_pk_add_f32 v[136:137], v[136:137], 1.0 op_sel_hi:[1,0]
    v_pk_add_f32 v[138:139], v[138:139], 1.0 op_sel_hi:[1,0]
    v_pk_add_f32 v[140:141], v[140:141], 1.0 op_sel_hi:[1,0]
    v_pk_add_f32 v[142:143], v[142:143], 1.0 op_sel_hi:[1,0]
    buffer_load_dwordx4 a[152:155], v3, s[16:19], s58 offen offset:3072 sc1
    v_rcp_f32 v136, v136
    v_rcp_f32 v137, v137
    v_rcp_f32 v138, v138
    v_rcp_f32 v139, v139
    v_rcp_f32 v140, v140
    v_rcp_f32 v141, v141
    v_rcp_f32 v142, v142
    v_rcp_f32 v143, v143
    v_pk_mul_f32 v[128:129], v[128:129], v[136:137]
    v_pk_mul_f32 v[130:131], v[130:131], v[138:139]
    v_pk_mul_f32 v[132:133], v[132:133], v[140:141]
    v_pk_mul_f32 v[134:135], v[134:135], v[142:143]
    v_cvt_pk_bf16_f32 v148, v128, v129
    v_cvt_pk_bf16_f32 v149, v130, v131
    v_cvt_pk_bf16_f32 v150, v132, v133
    v_cvt_pk_bf16_f32 v151, v134, v135
    buffer_store_dwordx4 v[148:151], v200, s[16:19], s69 offen sc1
    v_pk_fma_f32 v[128:129], v[232:233], v[194:195], v[84:85] op_sel_hi:[1,0,1] neg_lo:[0,1,0] neg_hi:[0,1,0]
    v_pk_fma_f32 v[130:131], v[234:235], v[194:195], v[86:87] op_sel_hi:[1,0,1] neg_lo:[0,1,0] neg_hi:[0,1,0]
    v_pk_fma_f32 v[132:133], v[236:237], v[194:195], v[96:97] op_sel_hi:[1,0,1] neg_lo:[0,1,0] neg_hi:[0,1,0]
    v_pk_fma_f32 v[134:135], v[238:239], v[194:195], v[98:99] op_sel_hi:[1,0,1] neg_lo:[0,1,0] neg_hi:[0,1,0]
    v_pk_mul_f32 v[128:129], v[128:129], v[194:195] op_sel:[0,1] op_sel_hi:[1,1]
    v_pk_mul_f32 v[130:131], v[130:131], v[194:195] op_sel:[0,1] op_sel_hi:[1,1]
    v_pk_mul_f32 v[132:133], v[132:133], v[194:195] op_sel:[0,1] op_sel_hi:[1,1]
    v_pk_mul_f32 v[134:135], v[134:135], v[194:195] op_sel:[0,1] op_sel_hi:[1,1]
    buffer_load_dwordx4 a[156:159], v4, s[16:19], s58 offen offset:0 sc1
    v_exp_f32 v136, v128
    v_exp_f32 v137, v129
    v_exp_f32 v138, v130
    v_exp_f32 v139, v131
L_st4:
    s_cbranch_execz L_st8
    v_exp_f32 v140, v132
    v_exp_f32 v141, v133
    v_exp_f32 v142, v134
    v_exp_f32 v143, v135
    v_pk_add_f32 v[136:137], v[136:137], 1.0 op_sel_hi:[1,0]
    v_pk_add_f32 v[138:139], v[138:139], 1.0 op_sel_hi:[1,0]
    v_pk_add_f32 v[140:141], v[140:141], 1.0 op_sel_hi:[1,0]
    v_pk_add_f32 v[142:143], v[142:143], 1.0 op_sel_hi:[1,0]
    s_add_u32 s58, s36, 3
    s_and_b32 s58, s58, 2
    s_mul_i32 s58, s58, 1536
    s_add_u32 s58, s58, s65
    s_add_u32 s65, s65, 16384
    buffer_load_dwordx4 a[160:163], v3, s[16:19], s58 offen offset:0 sc1
    v_rcp_f32 v136, v136
    v_rcp_f32 v137, v137
    v_rcp_f32 v138, v138
    v_rcp_f32 v139, v139
    v_rcp_f32 v140, v140
    v_rcp_f32 v141, v141
    v_rcp_f32 v142, v142
    v_rcp_f32 v143, v143
    v_pk_mul_f32 v[128:129], v[128:129], v[136:137]
    v_pk_mul_f32 v[130:131], v[130:131], v[138:139]
    v_pk_mul_f32 v[132:133], v[132:133], v[140:141]
    v_pk_mul_f32 v[134:135], v[134:135], v[142:143]
    v_cvt_pk_bf16_f32 v144, v128, v129
    v_cvt_pk_bf16_f32 v145, v130, v131
    v_cvt_pk_bf16_f32 v146, v132, v133
    v_cvt_pk_bf16_f32 v147, v134, v135
    buffer_store_dwordx4 v[144:147], v201, s[16:19], s69 offen sc1
    v_pk_fma_f32 v[128:129], v[232:233], v[196:197], v[88:89] op_sel_hi:[1,0,1] neg_lo:[0,1,0] neg_hi:[0,1,0]
    v_pk_fma_f32 v[130:131], v[234:235], v[196:197], v[90:91] op_sel_hi:[1,0,1] neg_lo:[0,1,0] neg_hi:[0,1,0]
    v_pk_fma_f32 v[132:133], v[236:237], v[196:197], v[100:101] op_sel_hi:[1,0,1] neg_lo:[0,1,0] neg_hi:[0,1,0]
    v_pk_fma_f32 v[134:135], v[238:239], v[196:197], v[102:103] op_sel_hi:[1,0,1] neg_lo:[0,1,0] neg_hi:[0,1,0]
    v_pk_mul_f32 v[128:129], v[128:129], v[196:197] op_sel:[0,1] op_sel_hi:[1,1]
    v_pk_mul_f32 v[130:131], v[130:131], v[196:197] op_sel:[0,1] op_sel_hi:[1,1]
    v_pk_mul_f32 v[132:133], v[132:133], v[196:197] op_sel:[0,1] op_sel_hi:[1,1]
    v_pk_mul_f32 v[134:135], v[134:135], v[196:197] op_sel:[0,1] op_sel_hi:[1,1]
    buffer_load_dwordx4 a[164:167], v3, s[16:19], s58 offen offset:1024 sc1
    v_exp_f32 v136, v128
    v_exp_f32 v137, v129
    v_exp_f32 v138, v130
    v_exp_f32 v139, v131
    v_exp_f32 v140, v132
    v_exp_f32 v141, v133
    v_exp_f32 v142, v134
    v_exp_f32 v143, v135
    v_pk_add_f32 v[136:137], v[136:137], 1.0 op_sel_hi:[1,0]
    v_pk_add_f32 v[138:139], v[138:139], 1.0 op_sel_hi:[1,0]
    v_pk_add_f32 v[140:141], v[140:141], 1.0 op_sel_hi:[1,0]
    v_pk_add_f32 v[142:143], v[142:143], 1.0 op_sel_hi:[1,0]
    v_rcp_f32 v136, v136
    v_rcp_f32 v137, v137
    v_rcp_f32 v138, v138
    v_rcp_f32 v139, v139
    v_rcp_f32 v140, v140
    v_rcp_f32 v141, v141
    v_rcp_f32 v142, v142
    v_rcp_f32 v143, v143
    v_pk_mul_f32 v[128:129], v[128:129], v[136:137]
    v_pk_mul_f32 v[130:131], v[130:131], v[138:139]
    v_pk_mul_f32 v[132:133], v[132:133], v[140:141]
    v_pk_mul_f32 v[134:135], v[134:135], v[142:143]
    v_cvt_pk_bf16_f32 v148, v128, v129
    v_cvt_pk_bf16_f32 v149, v130, v131
    v_cvt_pk_bf16_f32 v150, v132, v133
    v_cvt_pk_bf16_f32 v151, v134, v135
    buffer_store_dwordx4 v[148:151], v202, s[16:19], s69 offen sc1
    s_waitcnt vmcnt(8) lgkmcnt(0)
    s_barrier
    s_atomic_add s5, s[16:17], s4 offset:0x1000
    s_cmp_eq_u32 s39, 10
    s_cbranch_scc1 L_h_skip
    v_pk_fma_f32 v[128:129], v[240:241], v[192:193], v[104:105] op_sel_hi:[1,0,1] neg_lo:[0,1,0] neg_hi:[0,1,0]
    v_pk_fma_f32 v[130:131], v[242:243], v[192:193], v[106:107] op_sel_hi:[1,0,1] neg_lo:[0,1,0] neg_hi:[0,1,0]
    v_pk_fma_f32 v[132:133], v[244:245], v[192:193], v[116:117] op_sel_hi:[1,0,1] neg_lo:[0,1,0] neg_hi:[0,1,0]
    v_pk_fma_f32 v[134:135], v[246:247], v[192:193], v[118:119] op_sel_hi:[1,0,1] neg_lo:[0,1,0] neg_hi:[0,1,0]
    v_pk_mul_f32 v[128:129], v[128:129], v[192:193] op_sel:[0,1] op_sel_hi:[1,1]
    v_pk_mul_f32 v[130:131], v[130:131], v[192:193] op_sel:[0,1] op_sel_hi:[1,1]
    v_pk_mul_f32 v[132:133], v[132:133], v[192:193] op_sel:[0,1] op_sel_hi:[1,1]
    v_pk_mul_f32 v[134:135], v[134:135], v[192:193] op_sel:[0,1] op_sel_hi:[1,1]
    v_exp_f32 v136, v128
    v_exp_f32 v137, v129
    v_exp_f32 v138, v130
    v_exp_f32 v139, v131
    v_exp_f32 v140, v132
    v_exp_f32 v141, v133
    v_exp_f32 v142, v134
    v_exp_f32 v143, v135
    v_pk_add_f32 v[136:137], v[136:137], 1.0 op_sel_hi:[1,0]
    v_pk_add_f32 v[138:139], v[138:139], 1.0 op_sel_hi:[1,0]
    v_pk_add_f32 v[140:141], v[140:141], 1.0 op_sel_hi:[1,0]
    v_pk_add_f32 v[142:143], v[142:143], 1.0 op_sel_hi:[1,0]
    v_rcp_f32 v136, v136
    v_rcp_f32 v137, v137
    v_rcp_f32 v138, v138
    v_rcp_f32 v139, v139
    v_rcp_f32 v140, v140
    v_rcp_f32 v141, v141
    v_rcp_f32 v142, v142
    v_rcp_f32 v143, v143
    v_pk_mul_f32 v[128:129], v[128:129], v[136:137]
    v_pk_mul_f32 v[130:131], v[130:131], v[138:139]
    v_pk_mul_f32 v[132:133], v[132:133], v[140:141]
    v_pk_mul_f32 v[134:135], v[134:135], v[142:143]
    v_cvt_pk_bf16_f32 v144, v128, v129
    v_cvt_pk_bf16_f32 v145, v130, v131
    v_cvt_pk_bf16_f32 v146, v132, v133
    v_cvt_pk_bf16_f32 v147, v134, v135
    buffer_store_dwordx4 v[144:147], v200, s[16:19], s70 offen sc1
    v_pk_fma_f32 v[128:129], v[240:241], v[194:195], v[108:109] op_sel_hi:[1,0,1] neg_lo:[0,1,0] neg_hi:[0,1,0]
    v_pk_fma_f32 v[130:131], v[242:243], v[194:195], v[110:111] op_sel_hi:[1,0,1] neg_lo:[0,1,0] neg_hi:[0,1,0]
    v_pk_fma_f32 v[132:133], v[244:245], v[194:195], v[120:121] op_sel_hi:[1,0,1] neg_lo:[0,1,0] neg_hi:[0,1,0]
    v_pk_fma_f32 v[134:135], v[246:247], v[194:195], v[122:123] op_sel_hi:[1,0,1] neg_lo:[0,1,0] neg_hi:[0,1,0]
    v_pk_mul_f32 v[128:129], v[128:129], v[194:195] op_sel:[0,1] op_sel_hi:[1,1]
    v_pk_mul_f32 v[130:131], v[130:131], v[194:195] op_sel:[0,1] op_sel_hi:[1,1]
    v_pk_mul_f32 v[132:133], v[132:133], v[194:195] op_sel:[0,1] op_sel_hi:[1,1]
    v_pk_mul_f32 v[134:135], v[134:135], v[194:195] op_sel:[0,1] op_sel_hi:[1,1]
    v_exp_f32 v136, v128
    v_exp_f32 v137, v129
    v_exp_f32 v138, v130
    v_exp_f32 v139, v131
    v_exp_f32 v140, v132
    v_exp_f32 v141, v133
    v_exp_f32 v142, v134
    v_exp_f32 v143, v135
    v_pk_add_f32 v[136:137], v[136:137], 1.0 op_sel_hi:[1,0]
    v_pk_add_f32 v[138:139], v[138:139], 1.0 op_sel_hi:[1,0]
    v_pk_add_f32 v[140:141], v[140:141], 1.0 op_sel_hi:[1,0]
    v_pk_add_f32 v[142:143], v[142:143], 1.0 op_sel_hi:[1,0]
    v_rcp_f32 v136, v136
    v_rcp_f32 v137, v137
    v_rcp_f32 v138, v138
    v_rcp_f32 v139, v139
    v_rcp_f32 v140, v140
    v_rcp_f32 v141, v141
    v_rcp_f32 v142, v142
    v_rcp_f32 v143, v143
    v_pk_mul_f32 v[128:129], v[128:129], v[136:137]
    v_pk_mul_f32 v[130:131], v[130:131], v[138:139]
    v_pk_mul_f32 v[132:133], v[132:133], v[140:141]
    v_pk_mul_f32 v[134:135], v[134:135], v[142:143]
    v_cvt_pk_bf16_f32 v148, v128, v129
    v_cvt_pk_bf16_f32 v149, v130, v131
    v_cvt_pk_bf16_f32 v150, v132, v133
    v_cvt_pk_bf16_f32 v151, v134, v135
    buffer_store_dwordx4 v[148:151], v201, s[16:19], s70 offen sc1
    v_pk_fma_f32 v[128:129], v[240:241], v[196:197], v[112:113] op_sel_hi:[1,0,1] neg_lo:[0,1,0] neg_hi:[0,1,0]
    v_pk_fma_f32 v[130:131], v[242:243], v[196:197], v[114:115] op_sel_hi:[1,0,1] neg_lo:[0,1,0] neg_hi:[0,1,0]
    v_pk_fma_f32 v[132:133], v[244:245], v[196:197], v[124:125] op_sel_hi:[1,0,1] neg_lo:[0,1,0] neg_hi:[0,1,0]
    v_pk_fma_f32 v[134:135], v[246:247], v[196:197], v[126:127] op_sel_hi:[1,0,1] neg_lo:[0,1,0] neg_hi:[0,1,0]
    v_pk_mul_f32 v[128:129], v[128:129], v[196:197] op_sel:[0,1] op_sel_hi:[1,1]
    v_pk_mul_f32 v[130:131], v[130:131], v[196:197] op_sel:[0,1] op_sel_hi:[1,1]
    v_pk_mul_f32 v[132:133], v[132:133], v[196:197] op_sel:[0,1] op_sel_hi:[1,1]
    v_pk_mul_f32 v[134:135], v[134:135], v[196:197] op_sel:[0,1] op_sel_hi:[1,1]
    v_exp_f32 v136, v128
    v_exp_f32 v137, v129
    v_exp_f32 v138, v130
    v_exp_f32 v139, v131
    v_exp_f32 v140, v132
    v_exp_f32 v141, v133
    v_exp_f32 v142, v134
    v_exp_f32 v143, v135
    v_pk_add_f32 v[136:137], v[136:137], 1.0 op_sel_hi:[1,0]
    v_pk_add_f32 v[138:139], v[138:139], 1.0 op_sel_hi:[1,0]
    v_pk_add_f32 v[140:141], v[140:141], 1.0 op_sel_hi:[1,0]
    v_pk_add_f32 v[142:143], v[142:143], 1.0 op_sel_hi:[1,0]
    v_rcp_f32 v136, v136
    v_rcp_f32 v137, v137
    v_rcp_f32 v138, v138
    v_rcp_f32 v139, v139
    v_rcp_f32 v140, v140
    v_rcp_f32 v141, v141
    v_rcp_f32 v142, v142
    v_rcp_f32 v143, v143
    v_pk_mul_f32 v[128:129], v[128:129], v[136:137]
    v_pk_mul_f32 v[130:131], v[130:131], v[138:139]
    v_pk_mul_f32 v[132:133], v[132:133], v[140:141]
    v_pk_mul_f32 v[134:135], v[134:135], v[142:143]
    v_cvt_pk_bf16_f32 v144, v128, v129
    v_cvt_pk_bf16_f32 v145, v130, v131
    v_cvt_pk_bf16_f32 v146, v132, v133
    v_cvt_pk_bf16_f32 v147, v134, v135
    buffer_store_dwordx4 v[144:147], v202, s[16:19], s70 offen sc1
L_h_skip:
L_join:
L_st5:
    s_cbranch_execz L_st9
    s_mov_b32 s44, 0
    s_atomic_add s44, s[16:17], s6 offset:0x1000 glc
    s_mov_b32 s56, 0
    s_mov_b32 s70, 1
    buffer_load_dwordx4 a[168:171], v3, s[16:19], s58 offen offset:2048 sc1
    buffer_load_dwordx4 a[172:175], v3, s[16:19], s58 offen offset:3072 sc1
    buffer_load_dwordx4 a[176:179], v4, s[16:19], s58 offen offset:0 sc1
    s_add_u32 s58, s36, 4
    s_and_b32 s58, s58, 2
    s_mul_i32 s58, s58, 1536
    s_add_u32 s58, s58, s65
    s_add_u32 s65, s65, 16384
    buffer_load_dwordx4 a[180:183], v3, s[16:19], s58 offen offset:0 sc1
L_s1e_again:
    s_waitcnt lgkmcnt(0)
    s_xor_b32 s44, s44, s7
    s_and_b32 s44, s44, s0
    s_cbranch_scc1 L_s1e_slow
L_s1e_ok:
    s_barrier
    s_add_u32 s60, s20, s12
    buffer_load_dwordx4 v[128:131], v3, s[16:19], s60 offen sc1
    s_add_u32 s60, s60, 32768
    buffer_load_dwordx4 v[132:135], v3, s[16:19], s60 offen sc1
    s_add_u32 s60, s60, 32768
    buffer_load_dwordx4 v[136:139], v3, s[16:19], s60 offen sc1
    s_add_u32 s60, s60, 32768
    buffer_load_dwordx4 v[140:143], v3, s[16:19], s60 offen sc1
    s_add_u32 s60, s20, s13
    buffer_load_dwordx4 v[144:147], v3, s[16:19], s60 offen sc1
    s_add_u32 s60, s60, 32768
    buffer_load_dwordx4 v[148:151], v3, s[16:19], s60 offen sc1
    s_add_u32 s60, s60, 32768
    buffer_load_dwordx4 v[152:155], v3, s[16:19], s60 offen sc1
    s_add_u32 s60, s60, 32768
    buffer_load_dwordx4 v[156:159], v3, s[16:19], s60 offen sc1
    s_waitcnt vmcnt(12)
    s_barrier
    s_atomic_add s5, s[16:17], s4
    s_waitcnt vmcnt(7)
    v_mfma_f32_16x16x32_bf16 v[8:11], a[0:3], v[128:131], 0
    s_add_u32 s60, s20, s14
    v_or_b32 v242, s72, v3
    v_lshlrev_b32 v243, 3, v0
    v_mfma_f32_16x16x32_bf16 v[12:15], a[4:7], v[128:131], 0
    buffer_load_dwordx4 v[160:163], v3, s[16:19], s60 offen sc1
    v_add_u32 v7, s42, v3
    v_mfma_f32_16x16x32_bf16 v[16:19], a[8:11], v[128:131], 0
    s_lshl2_add_u32 s43, s48, s36
    s_mul_i32 s43, s43, 20480
    v_mfma_f32_16x16x32_bf16 v[20:23], a[12:15], v[128:131], 0
    s_add_u32 s60, s60, 32768
    buffer_load_dwordx4 a[184:187], v3, s[16:19], s58 offen offset:1024 sc1
    s_mul_i32 s45, s49, 160
    v_mfma_f32_16x16x32_bf16 v[24:27], a[16:19], v[128:131], 0
    s_waitcnt vmcnt(8)
    buffer_load_dwordx4 v[164:167], v3, s[16:19], s60 offen sc1
    s_add_u32 s45, s43, s45
    v_mfma_f32_16x16x32_bf16 v[8:11], a[20:23], v[132:135], v[8:11]
    v_add_u32 v5, 0, v0
    v_mul_u32_u24 v6, 6554, v5
    v_mfma_f32_16x16x32_bf16 v[12:15], a[24:27], v[132:135], v[12:15]
    s_add_u32 s60, s60, 32768
    v_lshrrev_b32 v6, 16, v6
    v_mul_u32_u24 v6, 1120, v6
    v_mfma_f32_16x16x32_bf16 v[16:19], a[28:31], v[132:135], v[16:19]
    s_lshr_b32 s50, s49, 1
    buffer_load_dwordx4 v[168:171], v3, s[16:19], s60 offen sc1
    v_lshl_add_u32 v6, v5, 4, v6
    v_mfma_f32_16x16x32_bf16 v[20:23], a[32:35], v[132:135], v[20:23]
    s_mul_i32 s50, s50, 5
    v_add_u32 v248, s45, v6
    v_add_u32 v5, 64, v0
    v_mfma_f32_16x16x32_bf16 v[24:27], a[36:39], v[132:135], v[24:27]
    s_waitcnt vmcnt(9)
    buffer_load_dwordx4 a[188:191], v3, s[16:19], s58 offen offset:2048 sc1
    v_mul_u32_u24 v6, 6554, v5
    v_mfma_f32_16x16x32_bf16 v[8:11], a[40:43], v[136:139], v[8:11]
    s_add_u32 s60, s60, 32768
    v_lshrrev_b32 v6, 16, v6
    v_mul_u32_u24 v6, 1120, v6
    v_mfma_f32_16x16x32_bf16 v[12:15], a[44:47], v[136:139], v[12:15]
    s_and_b32 s51, s49, 1
    buffer_load_dwordx4 v[172:175], v3, s[16:19], s60 offen sc1
    v_lshl_add_u32 v6, v5, 4, v6
    v_mfma_f32_16x16x32_bf16 v[16:19], a[48:51], v[136:139], v[16:19]
    s_and_b32 s3, s50, 1
    v_add_u32 v249, s45, v6
    v_add_u32 v5, 128, v0
    v_mfma_f32_16x16x32_bf16 v[20:23], a[52:55], v[136:139], v[20:23]
    s_lshl_b32 s55, s3, 13
    v_mul_u32_u24 v6, 6554, v5
    v_lshrrev_b32 v6, 16, v6
    v_mfma_f32_16x16x32_bf16 v[24:27], a[56:59], v[136:139], v[24:27]
    s_waitcnt vmcnt(10)
    buffer_load_dwordx4 a[192:195], v3, s[16:19], s58 offen offset:3072 sc1
    v_mul_u32_u24 v6, 1120, v6
    v_mfma_f32_16x16x32_bf16 v[8:11], a[60:63], v[140:143], v[8:11]
    s_add_u32 s60, s20, s15
    v_lshl_add_u32 v6, v5, 4, v6
    v_add_u32 v250, s45, v6
    v_mfma_f32_16x16x32_bf16 v[12:15], a[64:67], v[140:143], v[12:15]
    s_add_u32 s55, s55, 4096
    buffer_load_dwordx4 v[128:131], v3, s[16:19], s60 offen sc1
    v_lshrrev_b32 v5, 5, v0
    v_mfma_f32_16x16x32_bf16 v[16:19], a[68:71], v[140:143], v[16:19]
    v_lshl_add_u32 v250, v5, 30, v250
    s_mul_i32 s46, s36, 3072
    v_mfma_f32_16x16x32_bf16 v[20:23], a[72:75], v[140:143], v[20:23]
    s_add_u32 s46, s46, 151552
    s_mul_i32 s45, s12, 35
    s_lshl_b32 s3, s3, 12
    v_mfma_f32_16x16x32_bf16 v[24:27], a[76:79], v[140:143], v[24:27]
    s_waitcnt vmcnt(11)
    v_add_u32 v244, s45, v3
    s_mul_i32 s45, s13, 35
    v_mfma_f32_16x16x32_bf16 v[28:31], a[0:3], v[144:147], 0
    s_add_u32 s60, s60, 32768
    buffer_load_dwordx4 a[196:199], v4, s[16:19], s58 offen offset:0 sc1
    v_add_u32 v245, s45, v3
    v_mfma_f32_16x16x32_bf16 v[32:35], a[4:7], v[144:147], 0
    buffer_load_dwordx4 v[132:135], v3, s[16:19], s60 offen sc1
    s_mul_i32 s45, s14, 35
    v_mfma_f32_16x16x32_bf16 v[36:39], a[8:11], v[144:147], 0
    s_lshl_b32 s50, s50, 13
    v_add_u32 v246, s45, v3
    v_mul_u32_u24 v5, 80, v1
    v_mfma_f32_16x16x32_bf16 v[40:43], a[12:15], v[144:147], 0
    s_sub_u32 s50, s50, s3
    v_lshl_add_u32 v5, v2, 4, v5
    v_add_u32 v236, 143360, v5
    v_mfma_f32_16x16x32_bf16 v[44:47], a[16:19], v[144:147], 0
    s_waitcnt vmcnt(12)
    v_add_u32 v237, 1280, v236
    v_subrev_u32 v5, 80, v237
    v_mfma_f32_16x16x32_bf16 v[28:31], a[20:23], v[148:151], v[28:31]
    s_add_u32 s60, s60, 32768
    v_cmp_le_u32 vcc, 4, v1
    s_nop 1
    v_cndmask_b32 v237, v237, v5, vcc
    v_mfma_f32_16x16x32_bf16 v[32:35], a[24:27], v[148:151], v[32:35]
    s_add_u32 s50, s50, s15
    buffer_load_dwordx4 v[136:139], v3, s[16:19], s60 offen sc1
    v_add_u32 v238, 2480, v236
    v_mfma_f32_16x16x32_bf16 v[36:39], a[28:31], v[148:151], v[36:39]
    s_add_u32 s58, s36, 5
    s_and_b32 s58, s58, 2
    s_mul_i32 s58, s58, 1536
    s_add_u32 s58, s58, s65
    s_add_u32 s65, s65, 16384
    v_mfma_f32_16x16x32_bf16 v[40:43], a[32:35], v[148:151], v[40:43]
    s_add_u32 s50, s50, s61
    buffer_load_dwordx4 a[200:203], v3, s[16:19], s58 offen offset:0 sc1
    v_subrev_u32 v5, 80, v238
    v_mfma_f32_16x16x32_bf16 v[44:47], a[36:39], v[148:151], v[44:47]
    s_waitcnt vmcnt(13)
    v_cmp_le_u32 vcc, 8, v1
    s_nop 1
    v_cndmask_b32 v238, v238, v5, vcc
    v_mfma_f32_16x16x32_bf16 v[28:31], a[40:43], v[152:155], v[28:31]
    s_add_u32 s60, s60, 32768
    v_add_u32 v239, 3680, v236
    v_subrev_u32 v5, 80, v239
    v_mfma_f32_16x16x32_bf16 v[32:35], a[44:47], v[152:155], v[32:35]
    s_add_u32 s50, s50, 442368
    buffer_load_dwordx4 v[140:143], v3, s[16:19], s60 offen sc1
    v_cmp_le_u32 vcc, 12, v1
    v_mfma_f32_16x16x32_bf16 v[36:39], a[48:51], v[152:155], v[36:39]
    s_lshl_b32 s3, s51, 14
    v_cndmask_b32 v239, v239, v5, vcc
    v_add_u32 v240, 4880, v236
    v_mfma_f32_16x16x32_bf16 v[40:43], a[52:55], v[152:155], v[40:43]
    s_add_u32 s52, s50, s3
    buffer_load_dwordx4 a[204:207], v3, s[16:19], s58 offen offset:1024 sc1
    v_lshlrev_b32 v241, 4, v2
    v_mfma_f32_16x16x32_bf16 v[44:47], a[56:59], v[152:155], v[44:47]
    s_waitcnt vmcnt(14)
    v_add_u32 v241, 149760, v241
    v_mul_u32_u24 v5, 160, v1
    v_mfma_f32_16x16x32_bf16 v[28:31], a[60:63], v[156:159], v[28:31]
    s_add_u32 s60, s21, s12
    v_lshl_add_u32 v5, v2, 3, v5
    v_add_u32 v247, s46, v5
    v_mfma_f32_16x16x32_bf16 v[32:35], a[64:67], v[156:159], v[32:35]
    s_add_u32 s53, s52, s55
    buffer_load_dwordx4 v[144:147], v3, s[16:19], s60 offen sc1
    v_add_u32 v251, s46, v3
    v_mfma_f32_16x16x32_bf16 v[36:39], a[68:71], v[156:159], v[36:39]
    s_add_u32 s54, s50, 32768
    v_mov_b32 v186, 0
    v_mov_b32 v187, 0
    v_mfma_f32_16x16x32_bf16 v[40:43], a[72:75], v[156:159], v[40:43]
    s_add_u32 s71, s52, 163840
    buffer_load_dwordx4 a[208:211], v3, s[16:19], s58 offen offset:2048 sc1
    s_add_u32 s73, s53, 163840
    v_mfma_f32_16x16x32_bf16 v[44:47], a[76:79], v[156:159], v[44:47]
    s_waitcnt vmcnt(15)
    s_lshl3_add_u32 s74, s51, s54
    s_add_u32 s74, s74, 163840
    v_mfma_f32_16x16x32_bf16 v[48:51], a[0:3], v[160:163], 0
    s_add_u32 s60, s60, 32768
    s_lshl_b32 s3, s51, 9
    s_add_u32 s54, s54, s3
    v_mfma_f32_16x16x32_bf16 v[52:55], a[4:7], v[160:163], 0
    s_mul_i32 s50, s49, 7168
    buffer_load_dwordx4 v[148:151], v3, s[16:19], s60 offen sc1
    s_add_u32 s50, s50, s15
    v_mfma_f32_16x16x32_bf16 v[56:59], a[8:11], v[160:163], 0
    s_add_u32 s50, s50, 163840
    s_mov_b32 s62, 0xbf317218
    s_lshl2_add_u32 s24, s49, s36
    v_mfma_f32_16x16x32_bf16 v[60:63], a[12:15], v[160:163], 0
    s_lshl_b32 s24, s24, 14
    s_add_u32 s24, s24, s1
    s_and_b32 s3, s36, 2
    v_mfma_f32_16x16x32_bf16 v[64:67], a[16:19], v[160:163], 0
    s_waitcnt vmcnt(14)
    buffer_load_dwordx4 a[212:215], v3, s[16:19], s58 offen offset:3072 sc1
    s_lshl_b32 s3, s3, 11
    v_mfma_f32_16x16x32_bf16 v[48:51], a[20:23], v[164:167], v[48:51]
    s_add_u32 s60, s60, 32768
    s_add_u32 s24, s24, s3
    s_and_b32 s3, s48, 3
    v_mfma_f32_16x16x32_bf16 v[52:55], a[24:27], v[164:167], v[52:55]
    s_lshl_b32 s3, s3, 19
    buffer_load_dwordx4 v[152:155], v3, s[16:19], s60 offen sc1
    s_add_u32 s24, s24, s3
    v_mfma_f32_16x16x32_bf16 v[56:59], a[28:31], v[164:167], v[56:59]
    s_lshr_b32 s3, s48, 2
    s_lshl_b32 s3, s3, 22
    s_add_u32 s24, s24, s3
    v_mfma_f32_16x16x32_bf16 v[60:63], a[32:35], v[164:167], v[60:63]
    s_xor_b32 s23, s24, 0x400000
    s_add_u32 s24, s24, 104857600
    s_add_u32 s23, s23, 104857600
    v_mfma_f32_16x16x32_bf16 v[64:67], a[36:39], v[164:167], v[64:67]
    s_waitcnt vmcnt(15)
    buffer_load_dwordx4 a[216:219], v4, s[16:19], s58 offen offset:0 sc1
    s_lshr_b32 s3, s2, 3
    v_mfma_f32_16x16x32_bf16 v[48:51], a[40:43], v[168:171], v[48:51]
    s_add_u32 s60, s60, 32768
    s_and_b32 s26, s2, 2
    s_lshl4_add_u32 s3, s26, s3
    v_mfma_f32_16x16x32_bf16 v[52:55], a[44:47], v[168:171], v[52:55]
    s_lshl_b32 s3, s3, 7
    buffer_load_dwordx4 v[156:159], v3, s[16:19], s60 offen sc1
    s_and_b32 s26, s2, 1
    v_mfma_f32_16x16x32_bf16 v[56:59], a[48:51], v[168:171], v[56:59]
    s_lshl_b32 s26, s26, 14
    s_add_u32 s26, s26, s3
    s_add_u32 s26, s26, s1
    v_mfma_f32_16x16x32_bf16 v[60:63], a[52:55], v[168:171], v[60:63]
    s_xor_b32 s25, s26, 0x4000
    s_add_u32 s26, s26, 131072
    s_add_u32 s25, s25, 131072
    v_mfma_f32_16x16x32_bf16 v[64:67], a[56:59], v[168:171], v[64:67]
    s_waitcnt vmcnt(15)
    s_add_u32 s58, s36, 6
    s_and_b32 s58, s58, 2
    s_mul_i32 s58, s58, 1536
    s_add_u32 s58, s58, s65
    s_add_u32 s65, s65, 16384
    v_mfma_f32_16x16x32_bf16 v[48:51], a[60:63], v[172:175], v[48:51]
    s_add_u32 s60, s21, s13
    buffer_load_dwordx4 a[220:223], v3, s[16:19], s58 offen offset:0 sc1
    s_and_b32 s3, s48, 15
    v_mfma_f32_16x16x32_bf16 v[52:55], a[64:67], v[172:175], v[52:55]
    s_lshl_b32 s3, s3, 9
    buffer_load_dwordx4 v[160:163], v3, s[16:19], s60 offen sc1
    s_add_u32 s3, s3, s1
    v_mfma_f32_16x16x32_bf16 v[56:59], a[68:71], v[172:175], v[56:59]
    s_add_u32 s3, s3, 114688
    s_lshr_b32 s27, s49, 1
    s_lshl_b32 s27, s27, 7
    v_mfma_f32_16x16x32_bf16 v[60:63], a[72:75], v[172:175], v[60:63]
    s_mov_b32 s44, 0
    s_atomic_add s44, s[16:17], s6 glc
    s_add_u32 s27, s27, s3
    v_mfma_f32_16x16x32_bf16 v[64:67], a[76:79], v[172:175], v[64:67]
    s_waitcnt vmcnt(15)
    s_lshl_b32 s39, s36, 7
    s_add_u32 s39, s39, s3
    v_mfma_f32_16x16x32_bf16 v[68:71], a[0:3], v[128:131], 0
    s_add_u32 s60, s60, 32768
    s_mul_i32 s55, s36, 5
    s_add_u32 s51, s55, 54
    v_mfma_f32_16x16x32_bf16 v[72:75], a[4:7], v[128:131], 0
    s_and_b32 s3, s51, 1
    buffer_load_dwordx4 v[164:167], v3, s[16:19], s60 offen sc1
    s_lshl_b32 s3, s3, 12
    v_mfma_f32_16x16x32_bf16 v[76:79], a[8:11], v[128:131], 0
    s_lshl_b32 s66, s51, 13
    s_sub_u32 s66, s66, s3
    s_add_u32 s66, s66, s61
    v_mfma_f32_16x16x32_bf16 v[80:83], a[12:15], v[128:131], 0
    s_add_u32 s51, s55, 55
    buffer_load_dwordx4 a[224:227], v3, s[16:19], s58 offen offset:1024 sc1
    s_and_b32 s3, s51, 1
    v_mfma_f32_16x16x32_bf16 v[84:87], a[16:19], v[128:131], 0
    s_waitcnt vmcnt(15)
    s_lshl_b32 s3, s3, 12
    s_lshl_b32 s67, s51, 13
    v_mfma_f32_16x16x32_bf16 v[68:71], a[20:23], v[132:135], v[68:71]
    s_add_u32 s60, s60, 32768
    s_sub_u32 s67, s67, s3
    s_add_u32 s67, s67, s61
    v_mfma_f32_16x16x32_bf16 v[72:75], a[24:27], v[132:135], v[72:75]
    s_add_u32 s51, s55, 56
    buffer_load_dwordx4 v[168:171], v3, s[16:19], s60 offen sc1
    s_and_b32 s3, s51, 1
    v_mfma_f32_16x16x32_bf16 v[76:79], a[28:31], v[132:135], v[76:79]
    s_lshl_b32 s3, s3, 12
    s_lshl_b32 s68, s51, 13
    s_sub_u32 s68, s68, s3
    v_mfma_f32_16x16x32_bf16 v[80:83], a[32:35], v[132:135], v[80:83]
    s_add_u32 s68, s68, s61
    buffer_load_dwordx4 a[228:231], v3, s[16:19], s58 offen offset:2048 sc1
    s_add_u32 s51, s55, 57
    v_mfma_f32_16x16x32_bf16 v[84:87], a[36:39], v[132:135], v[84:87]
    s_waitcnt vmcnt(16)
    s_and_b32 s3, s51, 1
    s_lshl_b32 s3, s3, 12
    v_mfma_f32_16x16x32_bf16 v[68:71], a[40:43], v[136:139], v[68:71]
    s_add_u32 s60, s60, 32768
    s_lshl_b32 s69, s51, 13
    s_sub_u32 s69, s69, s3
    v_mfma_f32_16x16x32_bf16 v[72:75], a[44:47], v[136:139], v[72:75]
    s_add_u32 s69, s69, s61
    buffer_load_dwordx4 v[172:175], v3, s[16:19], s60 offen sc1
    s_add_u32 s51, s55, 58
    v_mfma_f32_16x16x32_bf16 v[76:79], a[48:51], v[136:139], v[76:79]
    s_add_u32 m0, s46, 0
    s_and_b32 s3, s51, 1
    s_lshl_b32 s3, s3, 12
    v_mfma_f32_16x16x32_bf16 v[80:83], a[52:55], v[136:139], v[80:83]
    s_lshl_b32 s22, s51, 13
    buffer_load_dwordx4 a[232:235], v3, s[16:19], s58 offen offset:3072 sc1
    buffer_load_dwordx4 v248, s[8:11], 0 offen lds
    v_mfma_f32_16x16x32_bf16 v[84:87], a[56:59], v[136:139], v[84:87]
    s_waitcnt vmcnt(17)
    s_sub_u32 s22, s22, s3
    s_add_u32 s22, s22, s61
    v_mfma_f32_16x16x32_bf16 v[68:71], a[60:63], v[140:143], v[68:71]
    s_add_u32 m0, s46, 1024
    v_mfma_f32_16x16x32_bf16 v[72:75], a[64:67], v[140:143], v[72:75]
    buffer_load_dwordx4 v249, s[8:11], 0 offen lds
    v_mfma_f32_16x16x32_bf16 v[76:79], a[68:71], v[140:143], v[76:79]
    v_mfma_f32_16x16x32_bf16 v[80:83], a[72:75], v[140:143], v[80:83]
    s_add_u32 m0, s46, 2048
    v_mfma_f32_16x16x32_bf16 v[84:87], a[76:79], v[140:143], v[84:87]
    s_waitcnt vmcnt(16)
    buffer_load_dwordx4 a[236:239], v4, s[16:19], s58 offen offset:0 sc1
    buffer_load_dwordx4 v250, s[8:11], 0 offen lds
    v_mfma_f32_16x16x32_bf16 v[88:91], a[0:3], v[144:147], 0
    v_mfma_f32_16x16x32_bf16 v[92:95], a[4:7], v[144:147], 0
    v_mfma_f32_16x16x32_bf16 v[96:99], a[8:11], v[144:147], 0
    v_mfma_f32_16x16x32_bf16 v[100:103], a[12:15], v[144:147], 0
    v_mfma_f32_16x16x32_bf16 v[104:107], a[16:19], v[144:147], 0
    s_waitcnt vmcnt(16)
    v_mfma_f32_16x16x32_bf16 v[88:91], a[20:23], v[148:151], v[88:91]
    v_mfma_f32_16x16x32_bf16 v[92:95], a[24:27], v[148:151], v[92:95]
    v_mfma_f32_16x16x32_bf16 v[96:99], a[28:31], v[148:151], v[96:99]
    v_mfma_f32_16x16x32_bf16 v[100:103], a[32:35], v[148:151], v[100:103]
L_s1f_again:
    s_waitcnt lgkmcnt(0)
    s_xor_b32 s44, s44, s7
    s_and_b32 s44, s44, s0
    s_cbranch_scc1 L_s1f_slow
L_s1f_ok:
    s_barrier
    s_mov_b32 s44, 0
    s_atomic_add s44, s[16:17], s6 glc
    v_mfma_f32_16x16x32_bf16 v[104:107], a[36:39], v[148:151], v[104:107]
    s_waitcnt vmcnt(14)
    s_add_u32 s60, s20, s12
    s_add_u32 s60, s60, 131072
    v_mfma_f32_16x16x32_bf16 v[88:91], a[40:43], v[152:155], v[88:91]
    buffer_load_dwordx4 v[128:131], v3, s[16:19], s60 offen sc1
    v_mfma_f32_16x16x32_bf16 v[92:95], a[44:47], v[152:155], v[92:95]
    v_mfma_f32_16x16x32_bf16 v[96:99], a[48:51], v[152:155], v[96:99]
    s_add_u32 s60, s60, 32768
    v_mfma_f32_16x16x32_bf16 v[100:103], a[52:55], v[152:155], v[100:103]
    buffer_load_dwordx4 v[132:135], v3, s[16:19], s60 offen sc1
    v_mfma_f32_16x16x32_bf16 v[104:107], a[56:59], v[152:155], v[104:107]
    s_waitcnt vmcnt(14)
    v_mfma_f32_16x16x32_bf16 v[88:91], a[60:63], v[156:159], v[88:91]
    s_add_u32 s60, s60, 32768
    v_mfma_f32_16x16x32_bf16 v[92:95], a[64:67], v[156:159], v[92:95]
    buffer_load_dwordx4 v[136:139], v242, s[16:19], s60 offen sc1
    v_mfma_f32_16x16x32_bf16 v[96:99], a[68:71], v[156:159], v[96:99]
    v_mfma_f32_16x16x32_bf16 v[100:103], a[72:75], v[156:159], v[100:103]
    s_add_u32 s60, s20, s13
    s_add_u32 s60, s60, 131072
    v_mfma_f32_16x16x32_bf16 v[104:107], a[76:79], v[156:159], v[104:107]
    s_waitcnt vmcnt(13)
    buffer_load_dwordx4 v[140:143], v3, s[16:19], s60 offen sc1
    v_mfma_f32_16x16x32_bf16 v[108:111], a[0:3], v[160:163], 0
    v_mfma_f32_16x16x32_bf16 v[112:115], a[4:7], v[160:163], 0
    s_add_u32 s60, s60, 32768
    v_mfma_f32_16x16x32_bf16 v[116:119], a[8:11], v[160:163], 0
    buffer_load_dwordx4 v[144:147], v3, s[16:19], s60 offen sc1
    v_mfma_f32_16x16x32_bf16 v[120:123], a[12:15], v[160:163], 0
    v_mfma_f32_16x16x32_bf16 v[124:127], a[16:19], v[160:163], 0
    s_waitcnt vmcnt(14)
    s_add_u32 s60, s60, 32768
    v_mfma_f32_16x16x32_bf16 v[108:111], a[20:23], v[164:167], v[108:111]
    buffer_load_dwordx4 v[148:151], v242, s[16:19], s60 offen sc1
    v_mfma_f32_16x16x32_bf16 v[112:115], a[24:27], v[164:167], v[112:115]
    v_mfma_f32_16x16x32_bf16 v[116:119], a[28:31], v[164:167], v[116:119]
    s_add_u32 s60, s20, s14
    s_add_u32 s60, s60, 131072
    v_mfma_f32_16x16x32_bf16 v[120:123], a[32:35], v[164:167], v[120:123]
    buffer_load_dwordx4 v[152:155], v3, s[16:19], s60 offen sc1
    v_mfma_f32_16x16x32_bf16 v[124:127], a[36:39], v[164:167], v[124:127]
    s_waitcnt vmcnt(14)
    v_mfma_f32_16x16x32_bf16 v[108:111], a[40:43], v[168:171], v[108:111]
    s_add_u32 s60, s60, 32768
    v_mfma_f32_16x16x32_bf16 v[112:115], a[44:47], v[168:171], v[112:115]
    buffer_load_dwordx4 v[156:159], v3, s[16:19], s60 offen sc1
    v_mfma_f32_16x16x32_bf16 v[116:119], a[48:51], v[168:171], v[116:119]
    v_mfma_f32_16x16x32_bf16 v[120:123], a[52:55], v[168:171], v[120:123]
    v_mfma_f32_16x16x32_bf16 v[124:127], a[56:59], v[168:171], v[124:127]
    s_waitcnt vmcnt(13)
    v_mfma_f32_16x16x32_bf16 v[108:111], a[60:63], v[172:175], v[108:111]
    s_add_u32 s60, s60, 32768
    v_mfma_f32_16x16x32_bf16 v[112:115], a[64:67], v[172:175], v[112:115]
    buffer_load_dwordx4 v[160:163], v242, s[16:19], s60 offen sc1
    v_mfma_f32_16x16x32_bf16 v[116:119], a[68:71], v[172:175], v[116:119]
    v_mfma_f32_16x16x32_bf16 v[120:123], a[72:75], v[172:175], v[120:123]
L_s1b_again:
    s_waitcnt lgkmcnt(0)
    s_xor_b32 s44, s44, s7
    s_cbranch_scc1 L_s1b_slow
L_s1b_ok:
    s_barrier
    v_mfma_f32_16x16x32_bf16 v[124:127], a[76:79], v[172:175], v[124:127]
    s_waitcnt vmcnt(8)
    s_add_u32 m0, s15, 143360
    v_mfma_f32_16x16x32_bf16 v[8:11], a[80:83], v[128:131], v[8:11]
    s_add_u32 s60, s20, s15
    s_add_u32 s60, s60, 131072
    buffer_load_dwordx4 v3, s[16:19], s50 offen sc1 lds
    v_mfma_f32_16x16x32_bf16 v[12:15], a[84:87], v[128:131], v[12:15]
    buffer_load_dwordx4 v[164:167], v3, s[16:19], s60 offen sc1
    s_add_u32 m0, s15, 147456
    v_mfma_f32_16x16x32_bf16 v[16:19], a[88:91], v[128:131], v[16:19]
    buffer_load_dwordx4 v4, s[16:19], s50 offen sc1 lds
    v_mfma_f32_16x16x32_bf16 v[20:23], a[92:95], v[128:131], v[20:23]
    buffer_load_dwordx4 v[176:179], v3, s[16:19], s71 offen sc1
    v_mfma_f32_16x16x32_bf16 v[24:27], a[96:99], v[128:131], v[24:27]
    s_waitcnt vmcnt(11)
    buffer_load_dwordx4 v[180:183], v3, s[16:19], s73 offen sc1
    v_mfma_f32_16x16x32_bf16 v[8:11], a[100:103], v[132:135], v[8:11]
    s_add_u32 s60, s60, 32768
    buffer_load_dwordx2 v[184:185], v3, s[16:19], s74 offen sc1
    v_mfma_f32_16x16x32_bf16 v[12:15], a[104:107], v[132:135], v[12:15]
    buffer_load_dwordx4 v[168:171], v3, s[16:19], s60 offen sc1
    v_mfma_f32_16x16x32_bf16 v[16:19], a[108:111], v[132:135], v[16:19]
L_st6:
    s_cbranch_execz L_st10
    v_mfma_f32_16x16x32_bf16 v[20:23], a[112:115], v[132:135], v[20:23]
    v_mfma_f32_16x16x32_bf16 v[24:27], a[116:119], v[132:135], v[24:27]
    s_waitcnt vmcnt(13)
    v_mfma_f32_16x16x32_bf16 v[8:11], a[120:123], v[136:139], v[8:11]
    s_add_u32 s60, s60, 32768
    v_mfma_f32_16x16x32_bf16 v[12:15], a[124:127], v[136:139], v[12:15]
    buffer_load_dwordx4 v[172:175], v242, s[16:19], s60 offen sc1
    v_mfma_f32_16x16x32_bf16 v[16:19], a[128:131], v[136:139], v[16:19]
    v_mfma_f32_16x16x32_bf16 v[20:23], a[132:135], v[136:139], v[20:23]
    v_mfma_f32_16x16x32_bf16 v[24:27], a[136:139], v[136:139], v[24:27]
    s_waitcnt vmcnt(13)
    v_mfma_f32_16x16x32_bf16 v[28:31], a[80:83], v[140:143], v[28:31]
    s_add_u32 s60, s21, s12
    s_add_u32 s60, s60, 131072
    v_mfma_f32_16x16x32_bf16 v[32:35], a[84:87], v[140:143], v[32:35]
    buffer_load_dwordx4 v[128:131], v3, s[16:19], s60 offen sc1
    v_mfma_f32_16x16x32_bf16 v[36:39], a[88:91], v[140:143], v[36:39]
    v_mfma_f32_16x16x32_bf16 v[40:43], a[92:95], v[140:143], v[40:43]
    ds_write_b128 v7, v[8:11] offset:0
    v_mfma_f32_16x16x32_bf16 v[44:47], a[96:99], v[140:143], v[44:47]
    s_waitcnt vmcnt(13)
    v_mfma_f32_16x16x32_bf16 v[28:31], a[100:103], v[144:147], v[28:31]
    s_add_u32 s60, s60, 32768
    v_mfma_f32_16x16x32_bf16 v[32:35], a[104:107], v[144:147], v[32:35]
    buffer_load_dwordx4 v[132:135], v3, s[16:19], s60 offen sc1
    ds_write_b128 v7, v[12:15] offset:1024
    v_mfma_f32_16x16x32_bf16 v[36:39], a[108:111], v[144:147], v[36:39]
    v_mfma_f32_16x16x32_bf16 v[40:43], a[112:115], v[144:147], v[40:43]
    v_mfma_f32_16x16x32_bf16 v[44:47], a[116:119], v[144:147], v[44:47]
    s_waitcnt vmcnt(13)
    ds_write_b128 v7, v[16:19] offset:2048
    v_mfma_f32_16x16x32_bf16 v[28:31], a[120:123], v[148:151], v[28:31]
    s_add_u32 s60, s60, 32768
    v_mfma_f32_16x16x32_bf16 v[32:35], a[124:127], v[148:151], v[32:35]
    buffer_load_dwordx4 v[136:139], v242, s[16:19], s60 offen sc1
    v_mfma_f32_16x16x32_bf16 v[36:39], a[128:131], v[148:151], v[36:39]
    ds_write_b128 v7, v[20:23] offset:3072
    v_mfma_f32_16x16x32_bf16 v[40:43], a[132:135], v[148:151], v[40:43]
    v_mfma_f32_16x16x32_bf16 v[44:47], a[136:139], v[148:151], v[44:47]
    s_waitcnt vmcnt(13)
    v_mfma_f32_16x16x32_bf16 v[48:51], a[80:83], v[152:155], v[48:51]
    s_add_u32 s60, s21, s13
    s_add_u32 s60, s60, 131072
    ds_write_b128 v7, v[24:27] offset:4096
    v_mfma_f32_16x16x32_bf16 v[52:55], a[84:87], v[152:155], v[52:55]
    buffer_load_dwordx4 v[140:143], v3, s[16:19], s60 offen sc1
    v_mfma_f32_16x16x32_bf16 v[56:59], a[88:91], v[152:155], v[56:59]
    v_mfma_f32_16x16x32_bf16 v[60:63], a[92:95], v[152:155], v[60:63]
    ds_write_b128 v7, v[28:31] offset:5120
    v_mfma_f32_16x16x32_bf16 v[64:67], a[96:99], v[152:155], v[64:67]
    s_waitcnt vmcnt(13)
    s_waitcnt vmcnt(6) lgkmcnt(1)
    s_barrier
    v_mfma_f32_16x16x32_bf16 v[48:51], a[100:103], v[156:159], v[48:51]
    s_add_u32 s60, s60, 32768
    ds_read_b128 v[8:11], v246 offset:0
    ds_read_b128 v[188:191], v241 offset:0
    ds_read_b128 v[192:195], v241 offset:64
    ds_read_b128 v[196:199], v241 offset:128
    ds_read_b128 v[200:203], v241 offset:192
    v_mfma_f32_16x16x32_bf16 v[52:55], a[104:107], v[156:159], v[52:55]
    buffer_load_dwordx4 v[144:147], v3, s[16:19], s60 offen sc1
    ds_write_b128 v7, v[32:35] offset:6144
    ds_read_b128 v[12:15], v246 offset:1024
    v_mfma_f32_16x16x32_bf16 v[56:59], a[108:111], v[156:159], v[56:59]
    ds_read_b128 v[16:19], v246 offset:2048
    v_mfma_f32_16x16x32_bf16 v[60:63], a[112:115], v[156:159], v[60:63]
    ds_read_b128 v[20:23], v246 offset:3072
    v_mfma_f32_16x16x32_bf16 v[64:67], a[116:119], v[156:159], v[64:67]
    ds_write_b128 v7, v[36:39] offset:7168
    ds_read_b128 v[24:27], v246 offset:4096
    s_waitcnt lgkmcnt(9)
    v_cvt_pk_bf16_f32 v204, v188, v189
    v_cvt_pk_bf16_f32 v205, v190, v191
    s_mov_b32 vcc_lo, 0x11111111
    ds_read_b128 v[188:191], v236 offset:0
    s_mov_b32 vcc_hi, 0x11111111
    v_cndmask_b32 v204, 0, v204, vcc
    v_mfma_f32_16x16x32_bf16 v[48:51], a[120:123], v[160:163], v[48:51]
    s_add_u32 s60, s60, 32768
    v_cndmask_b32 v205, 0, v205, vcc
    s_waitcnt lgkmcnt(9)
    v_cvt_pk_bf16_f32 v206, v192, v193
    v_cvt_pk_bf16_f32 v207, v194, v195
    s_mov_b32 vcc_lo, 0x22221111
    ds_read_b128 v[192:195], v236 offset:64
    s_mov_b32 vcc_hi, 0x22222222
    v_cndmask_b32 v206, 0, v206, vcc
    v_cndmask_b32 v207, 0, v207, vcc
    v_mfma_f32_16x16x32_bf16 v[52:55], a[124:127], v[160:163], v[52:55]
    buffer_load_dwordx4 v[148:151], v242, s[16:19], s60 offen sc1
    s_waitcnt lgkmcnt(9)
    v_cvt_pk_bf16_f32 v208, v196, v197
    v_cvt_pk_bf16_f32 v209, v198, v199
    v_mfma_f32_16x16x32_bf16 v[232:235], v[204:207], v[176:179], 0
    s_mov_b32 vcc_lo, 0x22222222
    ds_read_b128 v[196:199], v237 offset:0
    s_mov_b32 vcc_hi, 0x44444444
    v_cndmask_b32 v208, 0, v208, vcc
    v_cndmask_b32 v209, 0, v209, vcc
    v_mfma_f32_16x16x32_bf16 v[56:59], a[128:131], v[160:163], v[56:59]
    ds_write_b128 v7, v[40:43] offset:8192
    s_waitcnt lgkmcnt(10)
    v_cvt_pk_bf16_f32 v210, v200, v201
    v_cvt_pk_bf16_f32 v211, v202, v203
    s_mov_b32 vcc_lo, 0x44444444
    ds_read_b128 v[200:203], v237 offset:64
    s_mov_b32 vcc_hi, 0x88884444
    v_cndmask_b32 v210, 0, v210, vcc
    v_cndmask_b32 v211, 0, v211, vcc
    s_waitcnt lgkmcnt(4)
    v_mfma_f32_16x16x32_bf16 v[60:63], a[132:135], v[160:163], v[60:63]
    v_cvt_pk_bf16_f32 v204, v188, v189
    v_cvt_pk_bf16_f32 v205, v190, v191
    v_mfma_f32_16x16x32_bf16 v[232:235], v[208:211], v[180:183], v[232:235]
    ds_read_b128 v[188:191], v238 offset:128
    s_waitcnt lgkmcnt(4)
    v_cvt_pk_bf16_f32 v206, v192, v193
    v_cvt_pk_bf16_f32 v207, v194, v195
    s_mov_b32 vcc_lo, 0xffff
    ds_read_b128 v[192:195], v238 offset:192
    s_mov_b32 vcc_hi, 0x0
    v_mfma_f32_16x16x32_bf16 v[64:67], a[136:139], v[160:163], v[64:67]
    v_cndmask_b32 v206, 0, v206, vcc
    v_cndmask_b32 v207, 0, v207, vcc
    s_waitcnt lgkmcnt(4)
    v_cvt_pk_bf16_f32 v208, v196, v197
    v_cvt_pk_bf16_f32 v209, v198, v199
    v_mfma_f32_16x16x32_bf16 v[212:215], v[204:207], v[176:179], 0
    s_mov_b32 vcc_lo, 0xf000f
    ds_read_b128 v[196:199], v239 offset:128
    s_mov_b32 vcc_hi, 0xf000f
    v_mfma_f32_16x16x32_bf16 v[68:71], a[80:83], v[164:167], v[68:71]
    s_add_u32 s60, s21, s14
    ds_write_b128 v7, v[44:47] offset:9216
    v_cndmask_b32 v208, 0, v208, vcc
    v_cndmask_b32 v209, 0, v209, vcc
    s_waitcnt lgkmcnt(4)
    v_cvt_pk_bf16_f32 v210, v200, v201
    v_cvt_pk_bf16_f32 v211, v202, v203
    s_mov_b32 vcc_lo, 0xfff0000f
    ds_read_b128 v[200:203], v239 offset:192
    s_mov_b32 vcc_hi, 0xfff0fff0
    v_mfma_f32_16x16x32_bf16 v[72:75], a[84:87], v[164:167], v[72:75]
    buffer_load_dwordx4 v[152:155], v3, s[16:19], s60 offen sc1
    v_cndmask_b32 v210, 0, v210, vcc
    v_cndmask_b32 v211, 0, v211, vcc
    s_waitcnt lgkmcnt(4)
    v_cvt_pk_bf16_f32 v204, v188, v189
    v_cvt_pk_bf16_f32 v205, v190, v191
    v_mfma_f32_16x16x32_bf16 v[216:219], v[208:211], v[176:179], 0
    s_mov_b32 vcc_lo, 0xff00ff
    ds_read_b128 v[188:191], v241 offset:256
    s_mov_b32 vcc_hi, 0xff00ff00
    v_mfma_f32_16x16x32_bf16 v[76:79], a[88:91], v[164:167], v[76:79]
    v_cndmask_b32 v204, 0, v204, vcc
    v_cndmask_b32 v205, 0, v205, vcc
    s_waitcnt lgkmcnt(4)
    v_cvt_pk_bf16_f32 v206, v192, v193
    v_cvt_pk_bf16_f32 v207, v194, v195
    s_mov_b32 vcc_lo, 0xff00ff00
    ds_read_b128 v[192:195], v237 offset:128
    s_mov_b32 vcc_hi, 0xff00
    v_cndmask_b32 v206, 0, v206, vcc
    v_cndmask_b32 v207, 0, v207, vcc
    v_mfma_f32_16x16x32_bf16 v[80:83], a[92:95], v[164:167], v[80:83]
    ds_write_b128 v7, v[48:51] offset:10240
    s_waitcnt lgkmcnt(5)
    v_cvt_pk_bf16_f32 v208, v196, v197
    v_cvt_pk_bf16_f32 v209, v198, v199
    v_mfma_f32_16x16x32_bf16 v[220:223], v[204:207], v[180:183], 0
    s_mov_b32 vcc_lo, 0x0
    ds_read_b128 v[196:199], v239 offset:256
    s_mov_b32 vcc_hi, 0xfff0fff
    v_cndmask_b32 v208, 0, v208, vcc
    v_cndmask_b32 v209, 0, v209, vcc
    v_mfma_f32_16x16x32_bf16 v[84:87], a[96:99], v[164:167], v[84:87]
    s_waitcnt vmcnt(8)
    s_waitcnt lgkmcnt(5)
    s_barrier
    v_mfma_f32_16x16x32_bf16 v[68:71], a[100:103], v[168:171], v[68:71]
    s_add_u32 s60, s60, 32768
    ds_read_b128 v[28:31], v245 offset:5120
    s_waitcnt lgkmcnt(5)
    v_cvt_pk_bf16_f32 v210, v200, v201
    v_cvt_pk_bf16_f32 v211, v202, v203
    s_mov_b32 vcc_lo, 0xfff0fff
    ds_read_b128 v[200:203], v240 offset:256
    s_mov_b32 vcc_hi, 0xf0000fff
    v_cndmask_b32 v210, 0, v210, vcc
    v_cndmask_b32 v211, 0, v211, vcc
    v_mfma_f32_16x16x32_bf16 v[72:75], a[104:107], v[168:171], v[72:75]
    buffer_load_dwordx4 v[156:159], v3, s[16:19], s60 offen sc1
    ds_write_b128 v7, v[52:55] offset:11264
    ds_read_b128 v[32:35], v245 offset:6144
    s_waitcnt lgkmcnt(7)
    v_cvt_pk_bf16_f32 v204, v188, v189
    v_cvt_pk_bf16_f32 v205, v190, v191
    v_mfma_f32_16x16x32_bf16 v[224:227], v[208:211], v[180:183], 0
    s_mov_b32 vcc_lo, 0x88888888
    ds_read_b128 v[188:191], v238 offset:64
    s_mov_b32 vcc_hi, 0x88888888
    v_mfma_f32_16x16x32_bf16 v[76:79], a[108:111], v[168:171], v[76:79]
    ds_read_b128 v[36:39], v245 offset:7168
    v_cndmask_b32 v204, 0, v204, vcc
    v_cndmask_b32 v205, 0, v205, vcc
    v_mov_b32 v206, 0
    v_mov_b32 v207, 0
    s_waitcnt lgkmcnt(8)
    v_cvt_pk_bf16_f32 v208, v192, v193
    v_cvt_pk_bf16_f32 v209, v194, v195
    v_mfma_f32_16x16x32_bf16 v[232:235], v[204:207], v[184:187], v[232:235]
    s_mov_b32 vcc_lo, 0xfff0fff0
    v_mfma_f32_16x16x32_bf16 v[80:83], a[112:115], v[168:171], v[80:83]
    ds_read_b128 v[40:43], v245 offset:8192
    ds_read_b128 v[192:195], v240 offset:192
    s_mov_b32 vcc_hi, 0x0
    v_cndmask_b32 v208, 0, v208, vcc
    v_cndmask_b32 v209, 0, v209, vcc
    v_mov_b32 v210, 0
    v_mov_b32 v211, 0
    s_waitcnt lgkmcnt(8)
    v_cvt_pk_bf16_f32 v204, v196, v197
    v_cvt_pk_bf16_f32 v205, v198, v199
    v_mfma_f32_16x16x32_bf16 v[84:87], a[116:119], v[168:171], v[84:87]
    s_waitcnt vmcnt(8)
    ds_write_b128 v7, v[56:59] offset:12288
    ds_read_b128 v[44:47], v245 offset:9216
    v_mfma_f32_16x16x32_bf16 v[216:219], v[208:211], v[180:183], v[216:219]
    s_mov_b32 vcc_lo, 0xf000f000
    s_mov_b32 vcc_hi, 0xf000f000
    v_cndmask_b32 v204, 0, v204, vcc
    v_cndmask_b32 v205, 0, v205, vcc
    s_waitcnt lgkmcnt(8)
    v_cvt_pk_bf16_f32 v208, v200, v201
    v_mfma_f32_16x16x32_bf16 v[68:71], a[120:123], v[172:175], v[68:71]
    s_add_u32 s60, s60, 32768
    v_cvt_pk_bf16_f32 v209, v202, v203
    v_mfma_f32_16x16x32_bf16 v[224:227], v[204:207], v[184:187], v[224:227]
    s_waitcnt lgkmcnt(5)
    v_cvt_pk_bf16_f32 v206, v188, v189
    v_cvt_pk_bf16_f32 v207, v190, v191
    v_mfma_f32_16x16x32_bf16 v[228:231], v[208:211], v[184:187], 0
    s_mov_b32 vcc_lo, 0xff0000
    s_mov_b32 vcc_hi, 0xff00ff
    v_cndmask_b32 v206, 0, v206, vcc
    v_mfma_f32_16x16x32_bf16 v[72:75], a[124:127], v[172:175], v[72:75]
    buffer_load_dwordx4 v[160:163], v3, s[16:19], s60 offen sc1
    v_cndmask_b32 v207, 0, v207, vcc
    v_mov_b32 v204, 0
    v_mov_b32 v205, 0
    s_waitcnt lgkmcnt(2)
    v_cvt_pk_bf16_f32 v210, v192, v193
    v_cvt_pk_bf16_f32 v211, v194, v195
    v_mfma_f32_16x16x32_bf16 v[220:223], v[204:207], v[176:179], v[220:223]
    s_mov_b32 vcc_lo, 0x0
    s_mov_b32 vcc_hi, 0xffff0000
    v_mfma_f32_16x16x32_bf16 v[76:79], a[128:131], v[172:175], v[76:79]
    ds_write_b128 v7, v[60:63] offset:13312
    v_cndmask_b32 v210, 0, v210, vcc
    v_cndmask_b32 v211, 0, v211, vcc
    v_mov_b32 v208, 0
    v_mov_b32 v209, 0
    v_add_f32 v188, 0x358637bd, v232
    v_add_f32 v189, 0x358637bd, v233
    v_mfma_f32_16x16x32_bf16 v[228:231], v[208:211], v[180:183], v[228:231]
    v_add_f32 v190, 0x358637bd, v234
    v_add_f32 v191, 0x358637bd, v235
    v_mfma_f32_16x16x32_bf16 v[80:83], a[132:135], v[172:175], v[80:83]
    v_rcp_f32 v188, -v188
    v_rcp_f32 v189, -v189
    v_rcp_f32 v190, -v190
    v_rcp_f32 v191, -v191
    s_bfm_b64 vcc, 16, 0
    v_cndmask_b32 v193, v189, v188, vcc
    v_mfma_f32_16x16x32_bf16 v[84:87], a[136:139], v[172:175], v[84:87]
    s_waitcnt vmcnt(8)
    s_waitcnt lgkmcnt(1)
    v_add_f32 v28, v28, v8
    s_bfm_b64 vcc, 32, 0
    v_cndmask_b32 v194, v190, v189, vcc
    s_bfm_b64 vcc, 48, 0
    v_cndmask_b32 v195, v191, v190, vcc
    v_mul_f32 v212, v212, v188
    v_mul_f32 v213, v213, v188
    v_mul_f32 v214, v214, v188
    v_mfma_f32_16x16x32_bf16 v[88:91], a[80:83], v[128:131], v[88:91]
    s_add_u32 s60, s60, 32768
    ds_write_b128 v7, v[64:67] offset:14336
    v_add_f32 v29, v29, v9
    v_mul_f32 v215, v215, v188
    v_cvt_pk_bf16_f32 v176, v212, v213
    v_cvt_pk_bf16_f32 v177, v214, v215
    v_mul_f32 v216, v216, v193
    v_mul_f32 v217, v217, v193
    v_mul_f32 v218, v218, v193
    v_mul_f32 v219, v219, v193
    v_mfma_f32_16x16x32_bf16 v[92:95], a[84:87], v[128:131], v[92:95]
    buffer_load_dwordx4 v[164:167], v3, s[16:19], s60 offen sc1
    v_add_f32 v30, v30, v10
    v_cvt_pk_bf16_f32 v178, v216, v217
    v_cvt_pk_bf16_f32 v179, v218, v219
    buffer_store_dwordx4 v[176:179], v3, s[16:19], s52 offen sc1
    v_mul_f32 v220, v220, v194
    v_mul_f32 v221, v221, v194
    v_mul_f32 v222, v222, v194
    v_mul_f32 v223, v223, v194
    v_cvt_pk_bf16_f32 v180, v220, v221
    v_mfma_f32_16x16x32_bf16 v[96:99], a[88:91], v[128:131], v[96:99]
    v_add_f32 v31, v31, v11
    v_add_f32 v32, v32, v12
    v_cvt_pk_bf16_f32 v181, v222, v223
    v_mul_f32 v224, v224, v195
    v_mul_f32 v225, v225, v195
    v_mul_f32 v226, v226, v195
    v_mul_f32 v227, v227, v195
    v_cvt_pk_bf16_f32 v182, v224, v225
    v_cvt_pk_bf16_f32 v183, v226, v227
    buffer_store_dwordx4 v[180:183], v3, s[16:19], s53 offen sc1
    v_mfma_f32_16x16x32_bf16 v[100:103], a[92:95], v[128:131], v[100:103]
    v_add_f32 v33, v33, v13
    v_add_f32 v34, v34, v14
    v_mul_f32 v228, v228, v191
    v_mul_f32 v229, v229, v191
    v_mul_f32 v230, v230, v191
    v_mul_f32 v231, v231, v191
    v_cvt_pk_bf16_f32 v184, v228, v229
    v_cvt_pk_bf16_f32 v185, v230, v231
    buffer_store_dwordx2 v[184:185], v243, s[16:19], s54 offen sc1
    v_mfma_f32_16x16x32_bf16 v[104:107], a[96:99], v[128:131], v[104:107]
    s_waitcnt vmcnt(11)
    s_waitcnt lgkmcnt(0)
    s_barrier
    v_mfma_f32_16x16x32_bf16 v[88:91], a[100:103], v[132:135], v[88:91]
    s_add_u32 s60, s60, 32768
    ds_read_b128 v[48:51], v244 offset:10240
    v_add_f32 v35, v35, v15
    v_mfma_f32_16x16x32_bf16 v[92:95], a[104:107], v[132:135], v[92:95]
    buffer_load_dwordx4 v[168:171], v3, s[16:19], s60 offen sc1
    ds_read_b128 v[52:55], v244 offset:11264
    ds_read_b64 v[216:217], v247 offset:0
    v_mfma_f32_16x16x32_bf16 v[96:99], a[108:111], v[132:135], v[96:99]
    ds_read_b128 v[56:59], v244 offset:12288
    v_add_f32 v36, v36, v16
    ds_read_b64 v[218:219], v247 offset:32
    v_mfma_f32_16x16x32_bf16 v[100:103], a[112:115], v[132:135], v[100:103]
    ds_read_b128 v[60:63], v244 offset:13312
    v_add_f32 v37, v37, v17
    ds_read_b64 v[220:221], v247 offset:64
    v_mfma_f32_16x16x32_bf16 v[104:107], a[116:119], v[132:135], v[104:107]
    s_waitcnt vmcnt(11)
    ds_read_b128 v[64:67], v244 offset:14336
    v_add_f32 v38, v38, v18
    ds_read_b64 v[222:223], v247 offset:96
    v_mfma_f32_16x16x32_bf16 v[88:91], a[120:123], v[136:139], v[88:91]
    s_add_u32 s60, s60, 32768
    v_add_f32 v39, v39, v19
    v_add_f32 v40, v40, v20
    ds_read_b64 v[224:225], v247 offset:128
    v_mfma_f32_16x16x32_bf16 v[92:95], a[124:127], v[136:139], v[92:95]
    buffer_load_dwordx4 v[172:175], v3, s[16:19], s60 offen sc1
    v_add_f32 v41, v41, v21
    v_mfma_f32_16x16x32_bf16 v[96:99], a[128:131], v[136:139], v[96:99]
    v_add_f32 v42, v42, v22
    v_add_f32 v43, v43, v23
    v_mfma_f32_16x16x32_bf16 v[100:103], a[132:135], v[136:139], v[100:103]
    v_add_f32 v44, v44, v24
    v_add_f32 v45, v45, v25
    v_mfma_f32_16x16x32_bf16 v[104:107], a[136:139], v[136:139], v[104:107]
    s_waitcnt vmcnt(11)
    v_add_f32 v46, v46, v26
    v_add_f32 v47, v47, v27
    v_mfma_f32_16x16x32_bf16 v[108:111], a[80:83], v[140:143], v[108:111]
    s_add_u32 s60, s60, 32768
    v_add_f32 v68, v68, v28
    v_add_f32 v69, v69, v29
    v_mfma_f32_16x16x32_bf16 v[112:115], a[84:87], v[140:143], v[112:115]
    buffer_load_dwordx4 v[128:131], v242, s[16:19], s60 offen sc1
    v_add_f32 v70, v70, v30
    s_waitcnt lgkmcnt(0)
    v_mfma_f32_16x16x32_bf16 v[116:119], a[88:91], v[140:143], v[116:119]
    v_add_f32 v71, v71, v31
    v_add_f32 v72, v72, v32
    v_mfma_f32_16x16x32_bf16 v[120:123], a[92:95], v[140:143], v[120:123]
    v_add_f32 v73, v73, v33
    v_add_f32 v74, v74, v34
    v_mfma_f32_16x16x32_bf16 v[124:127], a[96:99], v[140:143], v[124:127]
    s_waitcnt vmcnt(11)
    v_add_f32 v75, v75, v35
    v_add_f32 v76, v76, v36
    v_mfma_f32_16x16x32_bf16 v[108:111], a[100:103], v[144:147], v[108:111]
    s_add_u32 s60, s21, s15
    v_add_f32 v77, v77, v37
    v_add_f32 v78, v78, v38
    v_mfma_f32_16x16x32_bf16 v[112:115], a[104:107], v[144:147], v[112:115]
    buffer_load_dwordx4 v[132:135], v3, s[16:19], s60 offen sc1
    v_add_f32 v79, v79, v39
    v_mfma_f32_16x16x32_bf16 v[116:119], a[108:111], v[144:147], v[116:119]
    v_add_f32 v80, v80, v40
    v_add_f32 v81, v81, v41
    v_mfma_f32_16x16x32_bf16 v[120:123], a[112:115], v[144:147], v[120:123]
    v_add_f32 v82, v82, v42
    v_add_f32 v83, v83, v43
    v_mfma_f32_16x16x32_bf16 v[124:127], a[116:119], v[144:147], v[124:127]
    s_waitcnt vmcnt(11)
    v_add_f32 v84, v84, v44
    v_add_f32 v85, v85, v45
    v_mfma_f32_16x16x32_bf16 v[108:111], a[120:123], v[148:151], v[108:111]
    s_add_u32 s60, s60, 32768
    v_add_f32 v86, v86, v46
    v_add_f32 v87, v87, v47
    v_mfma_f32_16x16x32_bf16 v[112:115], a[124:127], v[148:151], v[112:115]
    buffer_load_dwordx4 v[136:139], v3, s[16:19], s60 offen sc1
    v_mfma_f32_16x16x32_bf16 v[116:119], a[128:131], v[148:151], v[116:119]
    v_add_f32 v68, v68, v48
    v_add_f32 v69, v69, v49
    v_mfma_f32_16x16x32_bf16 v[120:123], a[132:135], v[148:151], v[120:123]
    v_add_f32 v70, v70, v50
    v_add_f32 v71, v71, v51
    v_mfma_f32_16x16x32_bf16 v[124:127], a[136:139], v[148:151], v[124:127]
    s_waitcnt vmcnt(11)
    v_cvt_pk_bf16_f32 v68, v68, v69
    v_cvt_pk_bf16_f32 v69, v70, v71
    v_mfma_f32_16x16x32_bf16 v[8:11], a[0:3], v[152:155], 0
    s_add_u32 s60, s60, 32768
    v_add_f32 v72, v72, v52
    v_add_f32 v73, v73, v53
    v_mfma_f32_16x16x32_bf16 v[12:15], a[4:7], v[152:155], 0
    buffer_load_dwordx4 v[140:143], v3, s[16:19], s60 offen sc1
    v_add_f32 v74, v74, v54
    v_mfma_f32_16x16x32_bf16 v[16:19], a[8:11], v[152:155], 0
    v_add_f32 v75, v75, v55
    v_cvt_pk_bf16_f32 v70, v72, v73
    v_mfma_f32_16x16x32_bf16 v[20:23], a[12:15], v[152:155], 0
    v_cvt_pk_bf16_f32 v71, v74, v75
    v_add_f32 v76, v76, v56
    v_mfma_f32_16x16x32_bf16 v[24:27], a[16:19], v[152:155], 0
    s_waitcnt vmcnt(11)
    v_add_f32 v77, v77, v57
    v_add_f32 v78, v78, v58
    v_mfma_f32_16x16x32_bf16 v[8:11], a[20:23], v[156:159], v[8:11]
    s_add_u32 s60, s60, 32768
    v_add_f32 v79, v79, v59
    v_cvt_pk_bf16_f32 v72, v76, v77
    v_mfma_f32_16x16x32_bf16 v[12:15], a[24:27], v[156:159], v[12:15]
    buffer_load_dwordx4 v[144:147], v3, s[16:19], s60 offen sc1
    v_cvt_pk_bf16_f32 v73, v78, v79
    v_mfma_f32_16x16x32_bf16 v[16:19], a[28:31], v[156:159], v[16:19]
    v_add_f32 v80, v80, v60
    v_add_f32 v81, v81, v61
    s_waitcnt vmcnt(7)
    s_atomic_add s70, s[16:17], s27
    v_mfma_f32_16x16x32_bf16 v[20:23], a[32:35], v[156:159], v[20:23]
    v_add_f32 v82, v82, v62
    v_add_f32 v83, v83, v63
    v_mfma_f32_16x16x32_bf16 v[24:27], a[36:39], v[156:159], v[24:27]
    v_cvt_pk_bf16_f32 v74, v80, v81
    v_cvt_pk_bf16_f32 v75, v82, v83
    v_mfma_f32_16x16x32_bf16 v[8:11], a[40:43], v[160:163], v[8:11]
    s_add_u32 s60, s60, 32768
    v_add_f32 v84, v84, v64
    v_add_f32 v85, v85, v65
    v_mfma_f32_16x16x32_bf16 v[12:15], a[44:47], v[160:163], v[12:15]
    buffer_load_dwordx4 v[148:151], v3, s[16:19], s60 offen sc1
    v_add_f32 v86, v86, v66
    v_mfma_f32_16x16x32_bf16 v[16:19], a[48:51], v[160:163], v[16:19]
    v_add_f32 v87, v87, v67
    v_cvt_pk_bf16_f32 v76, v84, v85
    v_mfma_f32_16x16x32_bf16 v[20:23], a[52:55], v[160:163], v[20:23]
    v_cvt_pk_bf16_f32 v77, v86, v87
    v_lshlrev_b32 v176, 16, v216
    v_mfma_f32_16x16x32_bf16 v[24:27], a[56:59], v[160:163], v[24:27]
    v_and_b32 v177, 0xffff0000, v216
    v_lshlrev_b32 v178, 16, v217
    v_mfma_f32_16x16x32_bf16 v[8:11], a[60:63], v[164:167], v[8:11]
    s_add_u32 s60, s60, 32768
    v_and_b32 v179, 0xffff0000, v217
    v_lshlrev_b32 v180, 16, v218
    v_mfma_f32_16x16x32_bf16 v[12:15], a[64:67], v[164:167], v[12:15]
    buffer_load_dwordx4 v[152:155], v3, s[16:19], s60 offen sc1
    v_and_b32 v181, 0xffff0000, v218
    v_mfma_f32_16x16x32_bf16 v[16:19], a[68:71], v[164:167], v[16:19]
    v_lshlrev_b32 v182, 16, v219
    v_and_b32 v183, 0xffff0000, v219
    v_mfma_f32_16x16x32_bf16 v[20:23], a[72:75], v[164:167], v[20:23]
    buffer_store_dwordx4 v[68:71], v3, s[16:19], s23 offen offset:0 sc1
    v_lshlrev_b32 v184, 16, v220
    v_mfma_f32_16x16x32_bf16 v[24:27], a[76:79], v[164:167], v[24:27]
    s_waitcnt vmcnt(9)
    v_and_b32 v185, 0xffff0000, v220
    v_lshlrev_b32 v186, 16, v221
    v_mfma_f32_16x16x32_bf16 v[8:11], a[80:83], v[168:171], v[8:11]
    s_add_u32 s60, s60, 32768
    v_and_b32 v187, 0xffff0000, v221
    v_lshlrev_b32 v188, 16, v222
    v_mfma_f32_16x16x32_bf16 v[12:15], a[84:87], v[168:171], v[12:15]
    buffer_load_dwordx4 v[156:159], v242, s[16:19], s60 offen sc1
    v_and_b32 v189, 0xffff0000, v222
    v_mfma_f32_16x16x32_bf16 v[16:19], a[88:91], v[168:171], v[16:19]
    v_lshlrev_b32 v190, 16, v223
    v_and_b32 v191, 0xffff0000, v223
    v_mfma_f32_16x16x32_bf16 v[20:23], a[92:95], v[168:171], v[20:23]
    s_mov_b32 s44, 0
    s_atomic_add s44, s[16:17], s39 glc
    v_lshlrev_b32 v192, 16, v224
    v_mfma_f32_16x16x32_bf16 v[24:27], a[96:99], v[168:171], v[24:27]
    s_waitcnt vmcnt(9)
    v_and_b32 v193, 0xffff0000, v224
    v_lshlrev_b32 v194, 16, v225
    v_mfma_f32_16x16x32_bf16 v[8:11], a[100:103], v[172:175], v[8:11]
    v_and_b32 v195, 0xffff0000, v225
    v_mfma_f32_16x16x32_bf16 v[12:15], a[104:107], v[172:175], v[12:15]
    v_mfma_f32_16x16x32_bf16 v[16:19], a[108:111], v[172:175], v[16:19]
    v_mfma_f32_16x16x32_bf16 v[20:23], a[112:115], v[172:175], v[20:23]
    buffer_store_dwordx4 v[72:75], v3, s[16:19], s23 offen offset:1024 sc1
    v_mfma_f32_16x16x32_bf16 v[24:27], a[116:119], v[172:175], v[24:27]
    s_waitcnt vmcnt(9)
    v_mfma_f32_16x16x32_bf16 v[8:11], a[120:123], v[128:131], v[8:11]
    v_mfma_f32_16x16x32_bf16 v[12:15], a[124:127], v[128:131], v[12:15]
    v_mfma_f32_16x16x32_bf16 v[16:19], a[128:131], v[128:131], v[16:19]
    v_mfma_f32_16x16x32_bf16 v[20:23], a[132:135], v[128:131], v[20:23]
    v_mfma_f32_16x16x32_bf16 v[24:27], a[136:139], v[128:131], v[24:27]
    s_waitcnt vmcnt(8)
    v_mfma_f32_16x16x32_bf16 v[28:31], a[0:3], v[132:135], 0
    v_mfma_f32_16x16x32_bf16 v[32:35], a[4:7], v[132:135], 0
    v_mfma_f32_16x16x32_bf16 v[36:39], a[8:11], v[132:135], 0
    v_mfma_f32_16x16x32_bf16 v[40:43], a[12:15], v[132:135], 0
    buffer_store_dwordx2 v[76:77], v243, s[16:19], s23 offen offset:2048 sc1
    v_mfma_f32_16x16x32_bf16 v[44:47], a[16:19], v[132:135], 0
    s_waitcnt vmcnt(8)
    v_mfma_f32_16x16x32_bf16 v[28:31], a[20:23], v[136:139], v[28:31]
    v_mfma_f32_16x16x32_bf16 v[32:35], a[24:27], v[136:139], v[32:35]
    v_mfma_f32_16x16x32_bf16 v[36:39], a[28:31], v[136:139], v[36:39]
    v_mfma_f32_16x16x32_bf16 v[40:43], a[32:35], v[136:139], v[40:43]
    v_mfma_f32_16x16x32_bf16 v[44:47], a[36:39], v[136:139], v[44:47]
    s_waitcnt vmcnt(7)
    v_mfma_f32_16x16x32_bf16 v[28:31], a[40:43], v[140:143], v[28:31]
    v_mfma_f32_16x16x32_bf16 v[32:35], a[44:47], v[140:143], v[32:35]
    v_mfma_f32_16x16x32_bf16 v[36:39], a[48:51], v[140:143], v[36:39]
    v_mfma_f32_16x16x32_bf16 v[40:43], a[52:55], v[140:143], v[40:43]
    v_mfma_f32_16x16x32_bf16 v[44:47], a[56:59], v[140:143], v[44:47]
    s_waitcnt vmcnt(6)
L_s2_again:
    s_waitcnt lgkmcnt(0)
    s_xor_b32 s44, s44, 8
    s_cbranch_scc1 L_s2_slow
L_s2_ok:
    v_mfma_f32_16x16x32_bf16 v[28:31], a[60:63], v[144:147], v[28:31]
    s_add_u32 s60, s66, s12
    v_mfma_f32_16x16x32_bf16 v[32:35], a[64:67], v[144:147], v[32:35]
    buffer_load_dwordx4 v[160:163], v3, s[16:19], s60 offen sc1
    v_mfma_f32_16x16x32_bf16 v[36:39], a[68:71], v[144:147], v[36:39]
    v_mfma_f32_16x16x32_bf16 v[40:43], a[72:75], v[144:147], v[40:43]
    s_add_u32 s60, s67, s12
    v_mfma_f32_16x16x32_bf16 v[44:47], a[76:79], v[144:147], v[44:47]
    s_waitcnt vmcnt(6)
    buffer_load_dwordx4 v[164:167], v3, s[16:19], s60 offen sc1
    v_mfma_f32_16x16x32_bf16 v[28:31], a[80:83], v[148:151], v[28:31]
    v_mfma_f32_16x16x32_bf16 v[32:35], a[84:87], v[148:151], v[32:35]
    s_add_u32 s60, s68, s12
    v_mfma_f32_16x16x32_bf16 v[36:39], a[88:91], v[148:151], v[36:39]
    buffer_load_dwordx4 v[168:171], v3, s[16:19], s60 offen sc1
    v_mfma_f32_16x16x32_bf16 v[40:43], a[92:95], v[148:151], v[40:43]
    v_mfma_f32_16x16x32_bf16 v[44:47], a[96:99], v[148:151], v[44:47]
    s_waitcnt vmcnt(7)
    s_add_u32 s60, s69, s12
    v_mfma_f32_16x16x32_bf16 v[28:31], a[100:103], v[152:155], v[28:31]
    buffer_load_dwordx4 v[172:175], v3, s[16:19], s60 offen sc1
    v_mfma_f32_16x16x32_bf16 v[32:35], a[104:107], v[152:155], v[32:35]
    v_mfma_f32_16x16x32_bf16 v[36:39], a[108:111], v[152:155], v[36:39]
    s_add_u32 s60, s22, s12
    v_mfma_f32_16x16x32_bf16 v[40:43], a[112:115], v[152:155], v[40:43]
    buffer_load_dwordx2 v[128:129], v243, s[16:19], s60 offen sc1
    v_mfma_f32_16x16x32_bf16 v[44:47], a[116:119], v[152:155], v[44:47]
    s_waitcnt vmcnt(7)
    buffer_load_dwordx2 v[130:131], v243, s[16:19], s60 offen offset:512 sc1
    v_mfma_f32_16x16x32_bf16 v[28:31], a[120:123], v[156:159], v[28:31]
    v_mfma_f32_16x16x32_bf16 v[32:35], a[124:127], v[156:159], v[32:35]
    s_add_u32 s60, s66, s13
    v_mfma_f32_16x16x32_bf16 v[36:39], a[128:131], v[156:159], v[36:39]
    buffer_load_dwordx4 v[132:135], v3, s[16:19], s60 offen sc1
    v_mfma_f32_16x16x32_bf16 v[40:43], a[132:135], v[156:159], v[40:43]
    v_mfma_f32_16x16x32_bf16 v[44:47], a[136:139], v[156:159], v[44:47]
    s_waitcnt vmcnt(6)
    s_add_u32 s60, s67, s13
    v_mfma_f32_16x16x32_bf16 v[88:91], a[140:143], v[160:163], v[88:91]
    buffer_load_dwordx4 v[136:139], v3, s[16:19], s60 offen sc1
    v_mfma_f32_16x16x32_bf16 v[92:95], a[144:147], v[160:163], v[92:95]
    v_mfma_f32_16x16x32_bf16 v[96:99], a[148:151], v[160:163], v[96:99]
    s_add_u32 s60, s68, s13
    v_mfma_f32_16x16x32_bf16 v[100:103], a[152:155], v[160:163], v[100:103]
    buffer_load_dwordx4 v[140:143], v3, s[16:19], s60 offen sc1
    v_mfma_f32_16x16x32_bf16 v[104:107], a[156:159], v[160:163], v[104:107]
    s_waitcnt vmcnt(7)
    s_atomic_add s70, s[16:17], s25
    v_mfma_f32_16x16x32_bf16 v[88:91], a[160:163], v[164:167], v[88:91]
    s_add_u32 s60, s69, s13
    v_mfma_f32_16x16x32_bf16 v[92:95], a[164:167], v[164:167], v[92:95]
    buffer_load_dwordx4 v[144:147], v3, s[16:19], s60 offen sc1
    v_mfma_f32_16x16x32_bf16 v[96:99], a[168:171], v[164:167], v[96:99]
    v_mfma_f32_16x16x32_bf16 v[100:103], a[172:175], v[164:167], v[100:103]
    s_add_u32 s60, s22, s13
    v_mfma_f32_16x16x32_bf16 v[104:107], a[176:179], v[164:167], v[104:107]
    s_waitcnt vmcnt(7)
    buffer_load_dwordx2 v[148:149], v243, s[16:19], s60 offen sc1
    v_mfma_f32_16x16x32_bf16 v[88:91], a[180:183], v[168:171], v[88:91]
    buffer_load_dwordx2 v[150:151], v243, s[16:19], s60 offen offset:512 sc1
    v_mfma_f32_16x16x32_bf16 v[92:95], a[184:187], v[168:171], v[92:95]
    v_mfma_f32_16x16x32_bf16 v[96:99], a[188:191], v[168:171], v[96:99]
    s_add_u32 s60, s66, s14
    v_mfma_f32_16x16x32_bf16 v[100:103], a[192:195], v[168:171], v[100:103]
    buffer_load_dwordx4 v[152:155], v3, s[16:19], s60 offen sc1
    v_mfma_f32_16x16x32_bf16 v[104:107], a[196:199], v[168:171], v[104:107]
    s_waitcnt vmcnt(9)
    v_mfma_f32_16x16x32_bf16 v[88:91], a[200:203], v[172:175], v[88:91]
    s_add_u32 s60, s67, s14
    v_mfma_f32_16x16x32_bf16 v[92:95], a[204:207], v[172:175], v[92:95]
    buffer_load_dwordx4 v[156:159], v3, s[16:19], s60 offen sc1
    v_mfma_f32_16x16x32_bf16 v[96:99], a[208:211], v[172:175], v[96:99]
    v_mfma_f32_16x16x32_bf16 v[100:103], a[212:215], v[172:175], v[100:103]
    s_add_u32 s60, s68, s14
    v_mfma_f32_16x16x32_bf16 v[104:107], a[216:219], v[172:175], v[104:107]
L_st7:
    s_cbranch_execz L_st11
    s_waitcnt vmcnt(8)
    buffer_load_dwordx4 v[160:163], v3, s[16:19], s60 offen sc1
    v_mfma_f32_16x16x32_bf16 v[88:91], a[220:223], v[128:131], v[88:91]
    v_mfma_f32_16x16x32_bf16 v[92:95], a[224:227], v[128:131], v[92:95]
    s_add_u32 s60, s69, s14
    v_mfma_f32_16x16x32_bf16 v[96:99], a[228:231], v[128:131], v[96:99]
    buffer_load_dwordx4 v[164:167], v3, s[16:19], s60 offen sc1
    v_mfma_f32_16x16x32_bf16 v[100:103], a[232:235], v[128:131], v[100:103]
    v_mfma_f32_16x16x32_bf16 v[104:107], a[236:239], v[128:131], v[104:107]
    s_waitcnt vmcnt(9)
    s_mov_b32 s44, 0
    s_atomic_add s44, s[16:17], s26 glc
    v_mfma_f32_16x16x32_bf16 v[108:111], a[140:143], v[132:135], v[108:111]
    s_add_u32 s60, s22, s14
    v_mfma_f32_16x16x32_bf16 v[112:115], a[144:147], v[132:135], v[112:115]
    buffer_load_dwordx2 v[168:169], v243, s[16:19], s60 offen sc1
    v_mfma_f32_16x16x32_bf16 v[116:119], a[148:151], v[132:135], v[116:119]
    buffer_load_dwordx2 v[170:171], v243, s[16:19], s60 offen offset:512 sc1
    v_mfma_f32_16x16x32_bf16 v[120:123], a[152:155], v[132:135], v[120:123]
    ds_write_b128 v7, v[88:91] offset:15360
    v_mfma_f32_16x16x32_bf16 v[124:127], a[156:159], v[132:135], v[124:127]
    s_waitcnt vmcnt(10)
    v_mfma_f32_16x16x32_bf16 v[108:111], a[160:163], v[136:139], v[108:111]
    s_add_u32 s60, s66, s15
    v_mfma_f32_16x16x32_bf16 v[112:115], a[164:167], v[136:139], v[112:115]
    ds_write_b128 v7, v[92:95] offset:16384
    buffer_load_dwordx4 v[172:175], v3, s[16:19], s60 offen sc1
    v_mfma_f32_16x16x32_bf16 v[116:119], a[168:171], v[136:139], v[116:119]
    v_mfma_f32_16x16x32_bf16 v[120:123], a[172:175], v[136:139], v[120:123]
    v_mfma_f32_16x16x32_bf16 v[124:127], a[176:179], v[136:139], v[124:127]
    s_waitcnt vmcnt(10)
    ds_write_b128 v7, v[96:99] offset:17408
    v_mfma_f32_16x16x32_bf16 v[108:111], a[180:183], v[140:143], v[108:111]
    s_add_u32 s60, s67, s15
    v_mfma_f32_16x16x32_bf16 v[112:115], a[184:187], v[140:143], v[112:115]
    buffer_load_dwordx4 v[128:131], v3, s[16:19], s60 offen sc1
    v_mfma_f32_16x16x32_bf16 v[116:119], a[188:191], v[140:143], v[116:119]
    ds_write_b128 v7, v[100:103] offset:18432
    v_mfma_f32_16x16x32_bf16 v[120:123], a[192:195], v[140:143], v[120:123]
    v_mfma_f32_16x16x32_bf16 v[124:127], a[196:199], v[140:143], v[124:127]
    s_waitcnt vmcnt(10)
    v_mfma_f32_16x16x32_bf16 v[108:111], a[200:203], v[144:147], v[108:111]
    ds_write_b128 v7, v[104:107] offset:19456
    s_add_u32 s60, s68, s15
    v_mfma_f32_16x16x32_bf16 v[112:115], a[204:207], v[144:147], v[112:115]
    buffer_load_dwordx4 v[132:135], v3, s[16:19], s60 offen sc1
    v_mfma_f32_16x16x32_bf16 v[116:119], a[208:211], v[144:147], v[116:119]
    v_mfma_f32_16x16x32_bf16 v[120:123], a[212:215], v[144:147], v[120:123]
    v_mfma_f32_16x16x32_bf16 v[124:127], a[216:219], v[144:147], v[124:127]
    s_waitcnt vmcnt(9)
    s_waitcnt lgkmcnt(0)
    s_barrier
    v_mfma_f32_16x16x32_bf16 v[108:111], a[220:223], v[148:151], v[108:111]
    ds_read_b128 v[196:199], v246 offset:15360
    s_add_u32 s60, s69, s15
    v_mfma_f32_16x16x32_bf16 v[112:115], a[224:227], v[148:151], v[112:115]
    ds_read_b128 v[200:203], v246 offset:16384
    buffer_load_dwordx4 v[136:139], v3, s[16:19], s60 offen sc1
    v_mfma_f32_16x16x32_bf16 v[116:119], a[228:231], v[148:151], v[116:119]
    ds_read_b128 v[204:207], v246 offset:17408
    v_mfma_f32_16x16x32_bf16 v[120:123], a[232:235], v[148:151], v[120:123]
    ds_read_b128 v[208:211], v246 offset:18432
    v_mfma_f32_16x16x32_bf16 v[124:127], a[236:239], v[148:151], v[124:127]
    s_waitcnt vmcnt(9)
    ds_read_b128 v[212:215], v246 offset:19456
    v_mfma_f32_16x16x32_bf16 v[8:11], a[140:143], v[152:155], v[8:11]
    s_add_u32 s60, s22, s15
L_s3_again:
    s_waitcnt lgkmcnt(0)
    s_xor_b32 s44, s44, 4
    s_cbranch_scc1 L_s3_slow
L_s3_ok:
    v_mfma_f32_16x16x32_bf16 v[12:15], a[144:147], v[152:155], v[12:15]
    buffer_load_dwordx2 v[140:141], v243, s[16:19], s60 offen sc1
    v_mfma_f32_16x16x32_bf16 v[16:19], a[148:151], v[152:155], v[16:19]
    buffer_load_dwordx2 v[142:143], v243, s[16:19], s60 offen offset:512 sc1
    v_mfma_f32_16x16x32_bf16 v[20:23], a[152:155], v[152:155], v[20:23]
    ds_write_b128 v7, v[108:111] offset:20480
    buffer_load_dwordx4 v[216:219], v3, s[16:19], s24 offen offset:0 sc1
    v_mfma_f32_16x16x32_bf16 v[24:27], a[156:159], v[152:155], v[24:27]
    s_waitcnt vmcnt(11)
    v_fmac_f32 v176, s62, v196
    v_fmac_f32 v177, s62, v197
    v_mfma_f32_16x16x32_bf16 v[8:11], a[160:163], v[156:159], v[8:11]
    v_fmac_f32 v178, s62, v198
    v_fmac_f32 v179, s62, v199
    v_mfma_f32_16x16x32_bf16 v[12:15], a[164:167], v[156:159], v[12:15]
    ds_write_b128 v7, v[112:115] offset:21504
    v_mfma_f32_16x16x32_bf16 v[16:19], a[168:171], v[156:159], v[16:19]
    buffer_load_dwordx4 v[220:223], v3, s[16:19], s24 offen offset:1024 sc1
    v_fmac_f32 v180, s62, v200
    v_mfma_f32_16x16x32_bf16 v[20:23], a[172:175], v[156:159], v[20:23]
    v_fmac_f32 v181, s62, v201
    v_fmac_f32 v182, s62, v202
    v_mfma_f32_16x16x32_bf16 v[24:27], a[176:179], v[156:159], v[24:27]
    s_waitcnt vmcnt(11)
    ds_write_b128 v7, v[116:119] offset:22528
    v_fmac_f32 v183, s62, v203
    v_mfma_f32_16x16x32_bf16 v[8:11], a[180:183], v[160:163], v[8:11]
    v_fmac_f32 v184, s62, v204
    v_mfma_f32_16x16x32_bf16 v[12:15], a[184:187], v[160:163], v[12:15]
    buffer_load_dwordx2 v[224:225], v243, s[16:19], s24 offen offset:2048 sc1
    v_fmac_f32 v185, s62, v205
    v_mfma_f32_16x16x32_bf16 v[16:19], a[188:191], v[160:163], v[16:19]
    ds_write_b128 v7, v[120:123] offset:23552
    v_fmac_f32 v186, s62, v206
    v_mfma_f32_16x16x32_bf16 v[20:23], a[192:195], v[160:163], v[20:23]
    v_fmac_f32 v187, s62, v207
    v_mfma_f32_16x16x32_bf16 v[24:27], a[196:199], v[160:163], v[24:27]
    s_waitcnt vmcnt(11)
    v_fmac_f32 v188, s62, v208
    v_fmac_f32 v189, s62, v209
    v_mfma_f32_16x16x32_bf16 v[8:11], a[200:203], v[164:167], v[8:11]
    ds_write_b128 v7, v[124:127] offset:24576
    v_fmac_f32 v190, s62, v210
    v_mfma_f32_16x16x32_bf16 v[12:15], a[204:207], v[164:167], v[12:15]
    v_fmac_f32 v191, s62, v211
    v_mfma_f32_16x16x32_bf16 v[16:19], a[208:211], v[164:167], v[16:19]
    v_fmac_f32 v192, s62, v212
    v_fmac_f32 v193, s62, v213
    v_mfma_f32_16x16x32_bf16 v[20:23], a[212:215], v[164:167], v[20:23]
    v_fmac_f32 v194, s62, v214
    v_fmac_f32 v195, s62, v215
    v_mfma_f32_16x16x32_bf16 v[24:27], a[216:219], v[164:167], v[24:27]
    s_waitcnt vmcnt(9)
    s_waitcnt lgkmcnt(0)
    s_barrier
    v_mfma_f32_16x16x32_bf16 v[8:11], a[220:223], v[168:171], v[8:11]
    ds_read_b128 v[196:199], v245 offset:20480
    v_mfma_f32_16x16x32_bf16 v[12:15], a[224:227], v[168:171], v[12:15]
    ds_read_b128 v[200:203], v245 offset:21504
    v_mfma_f32_16x16x32_bf16 v[16:19], a[228:231], v[168:171], v[16:19]
    ds_read_b128 v[204:207], v245 offset:22528
    v_mfma_f32_16x16x32_bf16 v[20:23], a[232:235], v[168:171], v[20:23]
    ds_read_b128 v[208:211], v245 offset:23552
    v_mfma_f32_16x16x32_bf16 v[24:27], a[236:239], v[168:171], v[24:27]
    s_waitcnt vmcnt(8)
    ds_read_b128 v[212:215], v245 offset:24576
    v_mfma_f32_16x16x32_bf16 v[28:31], a[140:143], v[172:175], v[28:31]
    v_mfma_f32_16x16x32_bf16 v[32:35], a[144:147], v[172:175], v[32:35]
    v_mfma_f32_16x16x32_bf16 v[36:39], a[148:151], v[172:175], v[36:39]
    s_waitcnt lgkmcnt(4)
    v_fmac_f32 v176, s62, v196
    v_mfma_f32_16x16x32_bf16 v[40:43], a[152:155], v[172:175], v[40:43]
    ds_write_b128 v7, v[8:11] offset:25600
    v_fmac_f32 v177, s62, v197
    v_mfma_f32_16x16x32_bf16 v[44:47], a[156:159], v[172:175], v[44:47]
    s_waitcnt vmcnt(7)
    v_fmac_f32 v178, s62, v198
    v_fmac_f32 v179, s62, v199
    v_mfma_f32_16x16x32_bf16 v[28:31], a[160:163], v[128:131], v[28:31]
    s_waitcnt lgkmcnt(4)
    v_fmac_f32 v180, s62, v200
    v_mfma_f32_16x16x32_bf16 v[32:35], a[164:167], v[128:131], v[32:35]
    ds_write_b128 v7, v[12:15] offset:26624
    v_fmac_f32 v181, s62, v201
    v_mfma_f32_16x16x32_bf16 v[36:39], a[168:171], v[128:131], v[36:39]
    v_fmac_f32 v182, s62, v202
    v_fmac_f32 v183, s62, v203
    v_mfma_f32_16x16x32_bf16 v[40:43], a[172:175], v[128:131], v[40:43]
    s_waitcnt lgkmcnt(4)
    v_fmac_f32 v184, s62, v204
    v_mfma_f32_16x16x32_bf16 v[44:47], a[176:179], v[128:131], v[44:47]
    s_waitcnt vmcnt(6)
    ds_write_b128 v7, v[16:19] offset:27648
    v_fmac_f32 v185, s62, v205
    v_mfma_f32_16x16x32_bf16 v[28:31], a[180:183], v[132:135], v[28:31]
    v_fmac_f32 v186, s62, v206
    v_fmac_f32 v187, s62, v207
    v_mfma_f32_16x16x32_bf16 v[32:35], a[184:187], v[132:135], v[32:35]
    s_waitcnt lgkmcnt(4)
    v_fmac_f32 v188, s62, v208
    v_mfma_f32_16x16x32_bf16 v[36:39], a[188:191], v[132:135], v[36:39]
    ds_write_b128 v7, v[20:23] offset:28672
    v_fmac_f32 v189, s62, v209
    v_mfma_f32_16x16x32_bf16 v[40:43], a[192:195], v[132:135], v[40:43]
    v_fmac_f32 v190, s62, v210
    v_fmac_f32 v191, s62, v211
    v_mfma_f32_16x16x32_bf16 v[44:47], a[196:199], v[132:135], v[44:47]
    s_waitcnt vmcnt(5)
    s_waitcnt lgkmcnt(4)
    v_fmac_f32 v192, s62, v212
    v_mfma_f32_16x16x32_bf16 v[28:31], a[200:203], v[136:139], v[28:31]
    ds_write_b128 v7, v[24:27] offset:29696
    v_fmac_f32 v193, s62, v213
    v_mfma_f32_16x16x32_bf16 v[32:35], a[204:207], v[136:139], v[32:35]
    v_fmac_f32 v194, s62, v214
    v_fmac_f32 v195, s62, v215
    v_mfma_f32_16x16x32_bf16 v[36:39], a[208:211], v[136:139], v[36:39]
    v_mfma_f32_16x16x32_bf16 v[40:43], a[212:215], v[136:139], v[40:43]
    v_mfma_f32_16x16x32_bf16 v[44:47], a[216:219], v[136:139], v[44:47]
    s_waitcnt vmcnt(3)
    s_waitcnt lgkmcnt(0)
    s_barrier
    v_mfma_f32_16x16x32_bf16 v[28:31], a[220:223], v[140:143], v[28:31]
    ds_read_b128 v[196:199], v244 offset:25600
    s_waitcnt vmcnt(0)
    v_mfma_f32_16x16x32_bf16 v[32:35], a[224:227], v[140:143], v[32:35]
    ds_read_b128 v[200:203], v244 offset:26624
    v_lshlrev_b32 v226, 16, v216
    v_mfma_f32_16x16x32_bf16 v[36:39], a[228:231], v[140:143], v[36:39]
    ds_read_b128 v[204:207], v244 offset:27648
    v_and_b32 v227, 0xffff0000, v216
    v_mfma_f32_16x16x32_bf16 v[40:43], a[232:235], v[140:143], v[40:43]
    ds_read_b128 v[208:211], v244 offset:28672
    v_fmac_f32 v176, s62, v226
    v_mfma_f32_16x16x32_bf16 v[44:47], a[236:239], v[140:143], v[44:47]
    ds_read_b128 v[212:215], v244 offset:29696
    v_fmac_f32 v177, s62, v227
    v_lshlrev_b32 v228, 16, v217
    v_and_b32 v229, 0xffff0000, v217
    v_fmac_f32 v178, s62, v228
    v_fmac_f32 v179, s62, v229
    v_lshlrev_b32 v226, 16, v218
    v_and_b32 v227, 0xffff0000, v218
    v_fmac_f32 v180, s62, v226
    v_fmac_f32 v181, s62, v227
    v_lshlrev_b32 v228, 16, v219
    v_and_b32 v229, 0xffff0000, v219
    v_fmac_f32 v182, s62, v228
    v_fmac_f32 v183, s62, v229
    v_lshlrev_b32 v226, 16, v220
    v_and_b32 v227, 0xffff0000, v220
    v_fmac_f32 v184, s62, v226
    v_fmac_f32 v185, s62, v227
    v_lshlrev_b32 v228, 16, v221
    v_and_b32 v229, 0xffff0000, v221
    v_fmac_f32 v186, s62, v228
    v_fmac_f32 v187, s62, v229
    v_lshlrev_b32 v226, 16, v222
    v_and_b32 v227, 0xffff0000, v222
    v_fmac_f32 v188, s62, v226
    v_fmac_f32 v189, s62, v227
    v_lshlrev_b32 v228, 16, v223
    v_and_b32 v229, 0xffff0000, v223
    v_fmac_f32 v190, s62, v228
    v_fmac_f32 v191, s62, v229
    v_lshlrev_b32 v226, 16, v224
    v_and_b32 v227, 0xffff0000, v224
    v_fmac_f32 v192, s62, v226
    v_fmac_f32 v193, s62, v227
    v_lshlrev_b32 v228, 16, v225
    v_and_b32 v229, 0xffff0000, v225
    v_fmac_f32 v194, s62, v228
    v_fmac_f32 v195, s62, v229
    v_pk_fma_f32 v[176:177], v[28:29], s[62:63], v[176:177] op_sel_hi:[1,0,1]
    v_pk_fma_f32 v[178:179], v[30:31], s[62:63], v[178:179] op_sel_hi:[1,0,1]
    v_pk_fma_f32 v[180:181], v[32:33], s[62:63], v[180:181] op_sel_hi:[1,0,1]
    v_pk_fma_f32 v[182:183], v[34:35], s[62:63], v[182:183] op_sel_hi:[1,0,1]
    v_pk_fma_f32 v[184:185], v[36:37], s[62:63], v[184:185] op_sel_hi:[1,0,1]
    v_pk_fma_f32 v[186:187], v[38:39], s[62:63], v[186:187] op_sel_hi:[1,0,1]
    v_pk_fma_f32 v[188:189], v[40:41], s[62:63], v[188:189] op_sel_hi:[1,0,1]
    v_pk_fma_f32 v[190:191], v[42:43], s[62:63], v[190:191] op_sel_hi:[1,0,1]
    v_pk_fma_f32 v[192:193], v[44:45], s[62:63], v[192:193] op_sel_hi:[1,0,1]
    v_pk_fma_f32 v[194:195], v[46:47], s[62:63], v[194:195] op_sel_hi:[1,0,1]
    s_waitcnt lgkmcnt(4)
    v_pk_fma_f32 v[176:177], v[196:197], s[62:63], v[176:177] op_sel_hi:[1,0,1]
    v_pk_fma_f32 v[178:179], v[198:199], s[62:63], v[178:179] op_sel_hi:[1,0,1]
    v_cvt_pk_bf16_f32 v216, v176, v177
    v_cvt_pk_bf16_f32 v217, v178, v179
    ds_write_b64 v247, v[216:217] offset:0
    s_waitcnt lgkmcnt(4)
    v_pk_fma_f32 v[180:181], v[200:201], s[62:63], v[180:181] op_sel_hi:[1,0,1]
    v_pk_fma_f32 v[182:183], v[202:203], s[62:63], v[182:183] op_sel_hi:[1,0,1]
    v_cvt_pk_bf16_f32 v218, v180, v181
    v_cvt_pk_bf16_f32 v219, v182, v183
    ds_write_b64 v247, v[218:219] offset:32
    s_waitcnt lgkmcnt(4)
    v_pk_fma_f32 v[184:185], v[204:205], s[62:63], v[184:185] op_sel_hi:[1,0,1]
    v_pk_fma_f32 v[186:187], v[206:207], s[62:63], v[186:187] op_sel_hi:[1,0,1]
    v_cvt_pk_bf16_f32 v220, v184, v185
    v_cvt_pk_bf16_f32 v221, v186, v187
    ds_write_b64 v247, v[220:221] offset:64
    s_waitcnt lgkmcnt(4)
    v_pk_fma_f32 v[188:189], v[208:209], s[62:63], v[188:189] op_sel_hi:[1,0,1]
    v_pk_fma_f32 v[190:191], v[210:211], s[62:63], v[190:191] op_sel_hi:[1,0,1]
    v_cvt_pk_bf16_f32 v222, v188, v189
    v_cvt_pk_bf16_f32 v223, v190, v191
    ds_write_b64 v247, v[222:223] offset:96
    s_waitcnt lgkmcnt(4)
    v_pk_fma_f32 v[192:193], v[212:213], s[62:63], v[192:193] op_sel_hi:[1,0,1]
    v_pk_fma_f32 v[194:195], v[214:215], s[62:63], v[194:195] op_sel_hi:[1,0,1]
    v_cvt_pk_bf16_f32 v224, v192, v193
    v_cvt_pk_bf16_f32 v225, v194, v195
    ds_write_b64 v247, v[224:225] offset:128
    ds_read_b128 v[128:131], v251 offset:0
    ds_read_b128 v[132:135], v251 offset:1024
    ds_read_b128 v[136:139], v251 offset:2048
    s_waitcnt lgkmcnt(2)
    buffer_store_dwordx4 v[128:131], v248, s[28:31], 0 offen
    s_waitcnt lgkmcnt(1)
    buffer_store_dwordx4 v[132:135], v249, s[28:31], 0 offen
    s_waitcnt lgkmcnt(0)
    buffer_store_dwordx4 v[136:139], v250, s[28:31], 0 offen
L_exit:
    s_endpgm
L_s1e_slow:
    s_add_u32 s56, s56, 1
    s_cmp_gt_u32 s56, 65536
    s_cbranch_scc1 L_s1e_ok
    s_mov_b32 s44, 0
    s_atomic_add s44, s[16:17], s6 offset:0x1000 glc
    s_branch L_s1e_again
L_s1f_slow:
    s_add_u32 s56, s56, 1
    s_cmp_gt_u32 s56, 65536
    s_cbranch_scc1 L_s1f_ok
    s_mov_b32 s44, 0
    s_atomic_add s44, s[16:17], s6 glc
    s_branch L_s1f_again
L_s1b_slow:
    s_add_u32 s56, s56, 1
    s_cmp_gt_u32 s56, 65536
    s_cbranch_scc1 L_s1b_ok
    s_mov_b32 s44, 0
    s_atomic_add s44, s[16:17], s6 glc
    s_branch L_s1b_again
L_s2_slow:
    s_add_u32 s56, s56, 1
    s_cmp_gt_u32 s56, 65536
    s_cbranch_scc1 L_s2_ok
    s_mov_b32 s44, 0
    s_atomic_add s44, s[16:17], s39 glc
    s_branch L_s2_again
L_s3_slow:
    s_add_u32 s56, s56, 1
    s_cmp_gt_u32 s56, 65536
    s_cbranch_scc1 L_s3_ok
    s_mov_b32 s44, 0
    s_atomic_add s44, s[16:17], s26 glc
    s_branch L_s3_again
L_q:
L_st8:
    s_cbranch_execz L_st12
    s_waitcnt lgkmcnt(4)
    v_pk_fma_f32 v[128:129], v[208:209], v[192:193], v[8:9] op_sel_hi:[1,0,1] neg_lo:[0,1,0] neg_hi:[0,1,0]
    v_pk_fma_f32 v[130:131], v[210:211], v[192:193], v[10:11] op_sel_hi:[1,0,1] neg_lo:[0,1,0] neg_hi:[0,1,0]
    v_pk_fma_f32 v[132:133], v[212:213], v[192:193], v[20:21] op_sel_hi:[1,0,1] neg_lo:[0,1,0] neg_hi:[0,1,0]
    v_pk_fma_f32 v[134:135], v[214:215], v[192:193], v[22:23] op_sel_hi:[1,0,1] neg_lo:[0,1,0] neg_hi:[0,1,0]
    v_pk_mul_f32 v[128:129], v[128:129], v[192:193] op_sel:[0,1] op_sel_hi:[1,1]
    v_pk_mul_f32 v[130:131], v[130:131], v[192:193] op_sel:[0,1] op_sel_hi:[1,1]
    v_pk_mul_f32 v[132:133], v[132:133], v[192:193] op_sel:[0,1] op_sel_hi:[1,1]
    v_pk_mul_f32 v[134:135], v[134:135], v[192:193] op_sel:[0,1] op_sel_hi:[1,1]
    buffer_load_dwordx4 a[88:91], v3, s[16:19], s58 offen offset:2048 sc1
    v_exp_f32 v136, v128 clamp
    v_exp_f32 v137, v129 clamp
    v_exp_f32 v138, v130 clamp
    v_exp_f32 v139, v131 clamp
    v_exp_f32 v140, v132 clamp
    v_exp_f32 v141, v133 clamp
    v_exp_f32 v142, v134 clamp
    v_exp_f32 v143, v135 clamp
    v_pk_fma_f32 v[128:129], v[128:129], s[62:63], 1.0 op_sel_hi:[1,0,0]
    v_pk_fma_f32 v[130:131], v[130:131], s[62:63], 1.0 op_sel_hi:[1,0,0]
    v_pk_fma_f32 v[132:133], v[132:133], s[62:63], 1.0 op_sel_hi:[1,0,0]
    v_pk_fma_f32 v[134:135], v[134:135], s[62:63], 1.0 op_sel_hi:[1,0,0]
    buffer_load_dwordx4 a[92:95], v3, s[16:19], s58 offen offset:3072 sc1
    v_max_f32 v128, v128, v136
    v_max_f32 v129, v129, v137
    v_max_f32 v130, v130, v138
    v_max_f32 v131, v131, v139
    v_max_f32 v132, v132, v140
    v_max_f32 v133, v133, v141
    v_max_f32 v134, v134, v142
    v_max_f32 v135, v135, v143
    v_pk_add_f32 v[128:129], v[128:129], s[62:63] op_sel:[0,1] op_sel_hi:[1,1]
    v_pk_add_f32 v[130:131], v[130:131], s[62:63] op_sel:[0,1] op_sel_hi:[1,1]
    v_pk_add_f32 v[132:133], v[132:133], s[62:63] op_sel:[0,1] op_sel_hi:[1,1]
    v_pk_add_f32 v[134:135], v[134:135], s[62:63] op_sel:[0,1] op_sel_hi:[1,1]
    v_cvt_pk_bf16_f32 v144, v128, v129
    v_cvt_pk_bf16_f32 v145, v130, v131
    v_cvt_pk_bf16_f32 v146, v132, v133
    v_cvt_pk_bf16_f32 v147, v134, v135
    buffer_store_dwordx4 v[144:147], v200, s[16:19], s66 offen sc1
    v_cndmask_b32 v204, v112, v113, s[34:35]
    v_cndmask_b32 v205, v114, v115, s[34:35]
    v_cndmask_b32 v204, v204, v205, s[32:33]
    ds_write_b32 v199, v204 offset:512
    v_cndmask_b32 v206, v124, v125, s[34:35]
    v_cndmask_b32 v207, v126, v127, s[34:35]
    v_cndmask_b32 v206, v206, v207, s[32:33]
    ds_write_b32 v199, v206 offset:576
    v_pk_fma_f32 v[128:129], v[208:209], v[194:195], v[12:13] op_sel_hi:[1,0,1] neg_lo:[0,1,0] neg_hi:[0,1,0]
    v_pk_fma_f32 v[130:131], v[210:211], v[194:195], v[14:15] op_sel_hi:[1,0,1] neg_lo:[0,1,0] neg_hi:[0,1,0]
    v_pk_fma_f32 v[132:133], v[212:213], v[194:195], v[24:25] op_sel_hi:[1,0,1] neg_lo:[0,1,0] neg_hi:[0,1,0]
    v_pk_fma_f32 v[134:135], v[214:215], v[194:195], v[26:27] op_sel_hi:[1,0,1] neg_lo:[0,1,0] neg_hi:[0,1,0]
    v_pk_mul_f32 v[128:129], v[128:129], v[194:195] op_sel:[0,1] op_sel_hi:[1,1]
    v_pk_mul_f32 v[130:131], v[130:131], v[194:195] op_sel:[0,1] op_sel_hi:[1,1]
    v_pk_mul_f32 v[132:133], v[132:133], v[194:195] op_sel:[0,1] op_sel_hi:[1,1]
    v_pk_mul_f32 v[134:135], v[134:135], v[194:195] op_sel:[0,1] op_sel_hi:[1,1]
    buffer_load_dwordx4 a[96:99], v4, s[16:19], s58 offen offset:0 sc1
    v_exp_f32 v136, v128 clamp
    v_exp_f32 v137, v129 clamp
    v_exp_f32 v138, v130 clamp
    v_exp_f32 v139, v131 clamp
    v_exp_f32 v140, v132 clamp
    v_exp_f32 v141, v133 clamp
    v_exp_f32 v142, v134 clamp
    v_exp_f32 v143, v135 clamp
    v_pk_fma_f32 v[128:129], v[128:129], s[62:63], 1.0 op_sel_hi:[1,0,0]
    v_pk_fma_f32 v[130:131], v[130:131], s[62:63], 1.0 op_sel_hi:[1,0,0]
    v_pk_fma_f32 v[132:133], v[132:133], s[62:63], 1.0 op_sel_hi:[1,0,0]
    v_pk_fma_f32 v[134:135], v[134:135], s[62:63], 1.0 op_sel_hi:[1,0,0]
    s_add_u32 s58, s57, 327680
    buffer_load_dwordx4 a[100:103], v3, s[16:19], s58 offen offset:0 sc1
    v_max_f32 v128, v128, v136
    v_max_f32 v129, v129, v137
    v_max_f32 v130, v130, v138
    v_max_f32 v131, v131, v139
    v_max_f32 v132, v132, v140
    v_max_f32 v133, v133, v141
    v_max_f32 v134, v134, v142
    v_max_f32 v135, v135, v143
    v_pk_add_f32 v[128:129], v[128:129], s[62:63] op_sel:[0,1] op_sel_hi:[1,1]
    v_pk_add_f32 v[130:131], v[130:131], s[62:63] op_sel:[0,1] op_sel_hi:[1,1]
    v_pk_add_f32 v[132:133], v[132:133], s[62:63] op_sel:[0,1] op_sel_hi:[1,1]
    v_pk_add_f32 v[134:135], v[134:135], s[62:63] op_sel:[0,1] op_sel_hi:[1,1]
    v_cvt_pk_bf16_f32 v148, v128, v129
    v_cvt_pk_bf16_f32 v149, v130, v131
    v_cvt_pk_bf16_f32 v150, v132, v133
    v_cvt_pk_bf16_f32 v151, v134, v135
    buffer_store_dwordx4 v[148:151], v201, s[16:19], s66 offen sc1
    s_waitcnt lgkmcnt(0)
    s_barrier
    ds_read_b128 v[224:227], v7 offset:256
    ds_read_b128 v[228:231], v7 offset:320
    ds_read_b128 v[232:235], v7 offset:384
    ds_read_b128 v[236:239], v7 offset:448
    ds_read_b128 v[240:243], v7 offset:512
    ds_read_b128 v[244:247], v7 offset:576
    v_pk_fma_f32 v[128:129], v[208:209], v[196:197], v[16:17] op_sel_hi:[1,0,1] neg_lo:[0,1,0] neg_hi:[0,1,0]
    v_pk_fma_f32 v[130:131], v[210:211], v[196:197], v[18:19] op_sel_hi:[1,0,1] neg_lo:[0,1,0] neg_hi:[0,1,0]
    v_pk_fma_f32 v[132:133], v[212:213], v[196:197], v[28:29] op_sel_hi:[1,0,1] neg_lo:[0,1,0] neg_hi:[0,1,0]
    v_pk_fma_f32 v[134:135], v[214:215], v[196:197], v[30:31] op_sel_hi:[1,0,1] neg_lo:[0,1,0] neg_hi:[0,1,0]
    v_pk_mul_f32 v[128:129], v[128:129], v[196:197] op_sel:[0,1] op_sel_hi:[1,1]
    v_pk_mul_f32 v[130:131], v[130:131], v[196:197] op_sel:[0,1] op_sel_hi:[1,1]
    v_pk_mul_f32 v[132:133], v[132:133], v[196:197] op_sel:[0,1] op_sel_hi:[1,1]
    v_pk_mul_f32 v[134:135], v[134:135], v[196:197] op_sel:[0,1] op_sel_hi:[1,1]
    buffer_load_dwordx4 a[104:107], v3, s[16:19], s58 offen offset:1024 sc1
    v_exp_f32 v136, v128 clamp
    v_exp_f32 v137, v129 clamp
    v_exp_f32 v138, v130 clamp
    v_exp_f32 v139, v131 clamp
    v_exp_f32 v140, v132 clamp
    v_exp_f32 v141, v133 clamp
    v_exp_f32 v142, v134 clamp
    v_exp_f32 v143, v135 clamp
    v_pk_fma_f32 v[128:129], v[128:129], s[62:63], 1.0 op_sel_hi:[1,0,0]
    v_pk_fma_f32 v[130:131], v[130:131], s[62:63], 1.0 op_sel_hi:[1,0,0]
    v_pk_fma_f32 v[132:133], v[132:133], s[62:63], 1.0 op_sel_hi:[1,0,0]
    v_pk_fma_f32 v[134:135], v[134:135], s[62:63], 1.0 op_sel_hi:[1,0,0]
    v_max_f32 v128, v128, v136
    v_max_f32 v129, v129, v137
    v_max_f32 v130, v130, v138
    v_max_f32 v131, v131, v139
    v_max_f32 v132, v132, v140
    v_max_f32 v133, v133, v141
    v_max_f32 v134, v134, v142
    v_max_f32 v135, v135, v143
    v_pk_add_f32 v[128:129], v[128:129], s[62:63] op_sel:[0,1] op_sel_hi:[1,1]
    v_pk_add_f32 v[130:131], v[130:131], s[62:63] op_sel:[0,1] op_sel_hi:[1,1]
    v_pk_add_f32 v[132:133], v[132:133], s[62:63] op_sel:[0,1] op_sel_hi:[1,1]
    v_pk_add_f32 v[134:135], v[134:135], s[62:63] op_sel:[0,1] op_sel_hi:[1,1]
    v_cvt_pk_bf16_f32 v144, v128, v129
    v_cvt_pk_bf16_f32 v145, v130, v131
    v_cvt_pk_bf16_f32 v146, v132, v133
    v_cvt_pk_bf16_f32 v147, v134, v135
    buffer_store_dwordx4 v[144:147], v202, s[16:19], s66 offen sc1
    v_pk_fma_f32 v[128:129], v[216:217], v[192:193], v[32:33] op_sel_hi:[1,0,1] neg_lo:[0,1,0] neg_hi:[0,1,0]
    v_pk_fma_f32 v[130:131], v[218:219], v[192:193], v[34:35] op_sel_hi:[1,0,1] neg_lo:[0,1,0] neg_hi:[0,1,0]
    v_pk_fma_f32 v[132:133], v[220:221], v[192:193], v[44:45] op_sel_hi:[1,0,1] neg_lo:[0,1,0] neg_hi:[0,1,0]
    v_pk_fma_f32 v[134:135], v[222:223], v[192:193], v[46:47] op_sel_hi:[1,0,1] neg_lo:[0,1,0] neg_hi:[0,1,0]
    v_pk_mul_f32 v[128:129], v[128:129], v[192:193] op_sel:[0,1] op_sel_hi:[1,1]
    v_pk_mul_f32 v[130:131], v[130:131], v[192:193] op_sel:[0,1] op_sel_hi:[1,1]
    v_pk_mul_f32 v[132:133], v[132:133], v[192:193] op_sel:[0,1] op_sel_hi:[1,1]
    v_pk_mul_f32 v[134:135], v[134:135], v[192:193] op_sel:[0,1] op_sel_hi:[1,1]
    buffer_load_dwordx4 a[108:111], v3, s[16:19], s58 offen offset:2048 sc1
    v_exp_f32 v136, v128 clamp
    v_exp_f32 v137, v129 clamp
    v_exp_f32 v138, v130 clamp
    v_exp_f32 v139, v131 clamp
    v_exp_f32 v140, v132 clamp
    v_exp_f32 v141, v133 clamp
    v_exp_f32 v142, v134 clamp
    v_exp_f32 v143, v135 clamp
    v_pk_fma_f32 v[128:129], v[128:129], s[62:63], 1.0 op_sel_hi:[1,0,0]
    v_pk_fma_f32 v[130:131], v[130:131], s[62:63], 1.0 op_sel_hi:[1,0,0]
    v_pk_fma_f32 v[132:133], v[132:133], s[62:63], 1.0 op_sel_hi:[1,0,0]
    v_pk_fma_f32 v[134:135], v[134:135], s[62:63], 1.0 op_sel_hi:[1,0,0]
    buffer_load_dwordx4 a[112:115], v3, s[16:19], s58 offen offset:3072 sc1
    v_max_f32 v128, v128, v136
    v_max_f32 v129, v129, v137
    v_max_f32 v130, v130, v138
    v_max_f32 v131, v131, v139
    v_max_f32 v132, v132, v140
    v_max_f32 v133, v133, v141
    v_max_f32 v134, v134, v142
    v_max_f32 v135, v135, v143
    v_pk_add_f32 v[128:129], v[128:129], s[62:63] op_sel:[0,1] op_sel_hi:[1,1]
    v_pk_add_f32 v[130:131], v[130:131], s[62:63] op_sel:[0,1] op_sel_hi:[1,1]
    v_pk_add_f32 v[132:133], v[132:133], s[62:63] op_sel:[0,1] op_sel_hi:[1,1]
    v_pk_add_f32 v[134:135], v[134:135], s[62:63] op_sel:[0,1] op_sel_hi:[1,1]
    v_cvt_pk_bf16_f32 v148, v128, v129
    v_cvt_pk_bf16_f32 v149, v130, v131
    v_cvt_pk_bf16_f32 v150, v132, v133
    v_cvt_pk_bf16_f32 v151, v134, v135
    buffer_store_dwordx4 v[148:151], v200, s[16:19], s67 offen sc1
    v_pk_fma_f32 v[128:129], v[216:217], v[194:195], v[36:37] op_sel_hi:[1,0,1] neg_lo:[0,1,0] neg_hi:[0,1,0]
    v_pk_fma_f32 v[130:131], v[218:219], v[194:195], v[38:39] op_sel_hi:[1,0,1] neg_lo:[0,1,0] neg_hi:[0,1,0]
    v_pk_fma_f32 v[132:133], v[220:221], v[194:195], v[48:49] op_sel_hi:[1,0,1] neg_lo:[0,1,0] neg_hi:[0,1,0]
    v_pk_fma_f32 v[134:135], v[222:223], v[194:195], v[50:51] op_sel_hi:[1,0,1] neg_lo:[0,1,0] neg_hi:[0,1,0]
    v_pk_mul_f32 v[128:129], v[128:129], v[194:195] op_sel:[0,1] op_sel_hi:[1,1]
    v_pk_mul_f32 v[130:131], v[130:131], v[194:195] op_sel:[0,1] op_sel_hi:[1,1]
    v_pk_mul_f32 v[132:133], v[132:133], v[194:195] op_sel:[0,1] op_sel_hi:[1,1]
    v_pk_mul_f32 v[134:135], v[134:135], v[194:195] op_sel:[0,1] op_sel_hi:[1,1]
    buffer_load_dwordx4 a[116:119], v4, s[16:19], s58 offen offset:0 sc1
    v_exp_f32 v136, v128 clamp
    v_exp_f32 v137, v129 clamp
    v_exp_f32 v138, v130 clamp
    v_exp_f32 v139, v131 clamp
    v_exp_f32 v140, v132 clamp
    v_exp_f32 v141, v133 clamp
    v_exp_f32 v142, v134 clamp
    v_exp_f32 v143, v135 clamp
    v_pk_fma_f32 v[128:129], v[128:129], s[62:63], 1.0 op_sel_hi:[1,0,0]
    v_pk_fma_f32 v[130:131], v[130:131], s[62:63], 1.0 op_sel_hi:[1,0,0]
    v_pk_fma_f32 v[132:133], v[132:133], s[62:63], 1.0 op_sel_hi:[1,0,0]
    v_pk_fma_f32 v[134:135], v[134:135], s[62:63], 1.0 op_sel_hi:[1,0,0]
    s_add_u32 s58, s57, 393216
    v_or_b32 v188, s72, v3
    buffer_load_dwordx4 a[120:123], v188, s[16:19], s58 offen offset:0 sc1
    v_max_f32 v128, v128, v136
    v_max_f32 v129, v129, v137
    v_max_f32 v130, v130, v138
    v_max_f32 v131, v131, v139
    v_max_f32 v132, v132, v140
    v_max_f32 v133, v133, v141
    v_max_f32 v134, v134, v142
    v_max_f32 v135, v135, v143
    v_pk_add_f32 v[128:129], v[128:129], s[62:63] op_sel:[0,1] op_sel_hi:[1,1]
    v_pk_add_f32 v[130:131], v[130:131], s[62:63] op_sel:[0,1] op_sel_hi:[1,1]
    v_pk_add_f32 v[132:133], v[132:133], s[62:63] op_sel:[0,1] op_sel_hi:[1,1]
    v_pk_add_f32 v[134:135], v[134:135], s[62:63] op_sel:[0,1] op_sel_hi:[1,1]
    v_cvt_pk_bf16_f32 v144, v128, v129
    v_cvt_pk_bf16_f32 v145, v130, v131
    v_cvt_pk_bf16_f32 v146, v132, v133
    v_cvt_pk_bf16_f32 v147, v134, v135
    buffer_store_dwordx4 v[144:147], v201, s[16:19], s67 offen sc1
    v_pk_fma_f32 v[128:129], v[216:217], v[196:197], v[40:41] op_sel_hi:[1,0,1] neg_lo:[0,1,0] neg_hi:[0,1,0]
    v_pk_fma_f32 v[130:131], v[218:219], v[196:197], v[42:43] op_sel_hi:[1,0,1] neg_lo:[0,1,0] neg_hi:[0,1,0]
    v_pk_fma_f32 v[132:133], v[220:221], v[196:197], v[52:53] op_sel_hi:[1,0,1] neg_lo:[0,1,0] neg_hi:[0,1,0]
    v_pk_fma_f32 v[134:135], v[222:223], v[196:197], v[54:55] op_sel_hi:[1,0,1] neg_lo:[0,1,0] neg_hi:[0,1,0]
    v_pk_mul_f32 v[128:129], v[128:129], v[196:197] op_sel:[0,1] op_sel_hi:[1,1]
    v_pk_mul_f32 v[130:131], v[130:131], v[196:197] op_sel:[0,1] op_sel_hi:[1,1]
    v_pk_mul_f32 v[132:133], v[132:133], v[196:197] op_sel:[0,1] op_sel_hi:[1,1]
    v_pk_mul_f32 v[134:135], v[134:135], v[196:197] op_sel:[0,1] op_sel_hi:[1,1]
    buffer_load_dwordx4 a[124:127], v188, s[16:19], s58 offen offset:1024 sc1
    v_exp_f32 v136, v128 clamp
    v_exp_f32 v137, v129 clamp
    v_exp_f32 v138, v130 clamp
    v_exp_f32 v139, v131 clamp
    v_exp_f32 v140, v132 clamp
    v_exp_f32 v141, v133 clamp
    v_exp_f32 v142, v134 clamp
    v_exp_f32 v143, v135 clamp
    v_pk_fma_f32 v[128:129], v[128:129], s[62:63], 1.0 op_sel_hi:[1,0,0]
    v_pk_fma_f32 v[130:131], v[130:131], s[62:63], 1.0 op_sel_hi:[1,0,0]
    v_pk_fma_f32 v[132:133], v[132:133], s[62:63], 1.0 op_sel_hi:[1,0,0]
    v_pk_fma_f32 v[134:135], v[134:135], s[62:63], 1.0 op_sel_hi:[1,0,0]
    v_max_f32 v128, v128, v136
    v_max_f32 v129, v129, v137
    v_max_f32 v130, v130, v138
    v_max_f32 v131, v131, v139
    v_max_f32 v132, v132, v140
    v_max_f32 v133, v133, v141
    v_max_f32 v134, v134, v142
    v_max_f32 v135, v135, v143
    v_pk_add_f32 v[128:129], v[128:129], s[62:63] op_sel:[0,1] op_sel_hi:[1,1]
    v_pk_add_f32 v[130:131], v[130:131], s[62:63] op_sel:[0,1] op_sel_hi:[1,1]
    v_pk_add_f32 v[132:133], v[132:133], s[62:63] op_sel:[0,1] op_sel_hi:[1,1]
    v_pk_add_f32 v[134:135], v[134:135], s[62:63] op_sel:[0,1] op_sel_hi:[1,1]
    v_cvt_pk_bf16_f32 v148, v128, v129
    v_cvt_pk_bf16_f32 v149, v130, v131
    v_cvt_pk_bf16_f32 v150, v132, v133
    v_cvt_pk_bf16_f32 v151, v134, v135
    buffer_store_dwordx4 v[148:151], v202, s[16:19], s67 offen sc1
    s_waitcnt lgkmcnt(3)
    v_pk_fma_f32 v[128:129], v[228:229], v[192:193], v[68:69] op_sel_hi:[1,0,1] neg_lo:[0,1,0] neg_hi:[0,1,0]
    v_pk_fma_f32 v[130:131], v[230:231], v[192:193], v[70:71] op_sel_hi:[1,0,1] neg_lo:[0,1,0] neg_hi:[0,1,0]
    v_pk_fma_f32 v[132:133], v[232:233], v[192:193], v[80:81] op_sel_hi:[1,0,1] neg_lo:[0,1,0] neg_hi:[0,1,0]
    v_pk_fma_f32 v[134:135], v[234:235], v[192:193], v[82:83] op_sel_hi:[1,0,1] neg_lo:[0,1,0] neg_hi:[0,1,0]
    v_pk_mul_f32 v[128:129], v[128:129], v[192:193] op_sel:[0,1] op_sel_hi:[1,1]
    v_pk_mul_f32 v[130:131], v[130:131], v[192:193] op_sel:[0,1] op_sel_hi:[1,1]
    v_pk_mul_f32 v[132:133], v[132:133], v[192:193] op_sel:[0,1] op_sel_hi:[1,1]
    v_pk_mul_f32 v[134:135], v[134:135], v[192:193] op_sel:[0,1] op_sel_hi:[1,1]
    buffer_load_dwordx4 a[128:131], v188, s[16:19], s58 offen offset:2048 sc1
    v_exp_f32 v136, v128 clamp
    v_exp_f32 v137, v129 clamp
    v_exp_f32 v138, v130 clamp
    v_exp_f32 v139, v131 clamp
    v_exp_f32 v140, v132 clamp
    v_exp_f32 v141, v133 clamp
    v_exp_f32 v142, v134 clamp
    v_exp_f32 v143, v135 clamp
    v_pk_fma_f32 v[128:129], v[128:129], s[62:63], 1.0 op_sel_hi:[1,0,0]
    v_pk_fma_f32 v[130:131], v[130:131], s[62:63], 1.0 op_sel_hi:[1,0,0]
    v_pk_fma_f32 v[132:133], v[132:133], s[62:63], 1.0 op_sel_hi:[1,0,0]
    v_pk_fma_f32 v[134:135], v[134:135], s[62:63], 1.0 op_sel_hi:[1,0,0]
    buffer_load_dwordx4 a[132:135], v188, s[16:19], s58 offen offset:3072 sc1
    v_max_f32 v128, v128, v136
    v_max_f32 v129, v129, v137
    v_max_f32 v130, v130, v138
    v_max_f32 v131, v131, v139
    v_max_f32 v132, v132, v140
    v_max_f32 v133, v133, v141
    v_max_f32 v134, v134, v142
    v_max_f32 v135, v135, v143
    v_pk_add_f32 v[128:129], v[128:129], s[62:63] op_sel:[0,1] op_sel_hi:[1,1]
    v_pk_add_f32 v[130:131], v[130:131], s[62:63] op_sel:[0,1] op_sel_hi:[1,1]
    v_pk_add_f32 v[132:133], v[132:133], s[62:63] op_sel:[0,1] op_sel_hi:[1,1]
    v_pk_add_f32 v[134:135], v[134:135], s[62:63] op_sel:[0,1] op_sel_hi:[1,1]
    v_cvt_pk_bf16_f32 v144, v128, v129
    v_cvt_pk_bf16_f32 v145, v130, v131
    v_cvt_pk_bf16_f32 v146, v132, v133
    v_cvt_pk_bf16_f32 v147, v134, v135
    buffer_store_dwordx4 v[144:147], v200, s[16:19], s68 offen sc1
L_st9:
    s_cbranch_execz L_st13
    v_pk_fma_f32 v[128:129], v[228:229], v[194:195], v[72:73] op_sel_hi:[1,0,1] neg_lo:[0,1,0] neg_hi:[0,1,0]
    v_pk_fma_f32 v[130:131], v[230:231], v[194:195], v[74:75] op_sel_hi:[1,0,1] neg_lo:[0,1,0] neg_hi:[0,1,0]
    v_pk_fma_f32 v[132:133], v[232:233], v[194:195], v[84:85] op_sel_hi:[1,0,1] neg_lo:[0,1,0] neg_hi:[0,1,0]
    v_pk_fma_f32 v[134:135], v[234:235], v[194:195], v[86:87] op_sel_hi:[1,0,1] neg_lo:[0,1,0] neg_hi:[0,1,0]
    v_pk_mul_f32 v[128:129], v[128:129], v[194:195] op_sel:[0,1] op_sel_hi:[1,1]
    v_pk_mul_f32 v[130:131], v[130:131], v[194:195] op_sel:[0,1] op_sel_hi:[1,1]
    v_pk_mul_f32 v[132:133], v[132:133], v[194:195] op_sel:[0,1] op_sel_hi:[1,1]
    v_pk_mul_f32 v[134:135], v[134:135], v[194:195] op_sel:[0,1] op_sel_hi:[1,1]
    v_or_b32 v188, s72, v4
    buffer_load_dwordx4 a[136:139], v188, s[16:19], s58 offen offset:0 sc1
    v_exp_f32 v136, v128 clamp
    v_exp_f32 v137, v129 clamp
    v_exp_f32 v138, v130 clamp
    v_exp_f32 v139, v131 clamp
    v_exp_f32 v140, v132 clamp
    v_exp_f32 v141, v133 clamp
    v_exp_f32 v142, v134 clamp
    v_exp_f32 v143, v135 clamp
    v_pk_fma_f32 v[128:129], v[128:129], s[62:63], 1.0 op_sel_hi:[1,0,0]
    v_pk_fma_f32 v[130:131], v[130:131], s[62:63], 1.0 op_sel_hi:[1,0,0]
    v_pk_fma_f32 v[132:133], v[132:133], s[62:63], 1.0 op_sel_hi:[1,0,0]
    v_pk_fma_f32 v[134:135], v[134:135], s[62:63], 1.0 op_sel_hi:[1,0,0]
    s_add_u32 s58, s36, 2
    s_and_b32 s58, s58, 2
    s_mul_i32 s58, s58, 1536
    s_add_u32 s58, s58, s65
    s_add_u32 s65, s65, 16384
    buffer_load_dwordx4 a[140:143], v3, s[16:19], s58 offen offset:0 sc1
    v_max_f32 v128, v128, v136
    v_max_f32 v129, v129, v137
    v_max_f32 v130, v130, v138
    v_max_f32 v131, v131, v139
    v_max_f32 v132, v132, v140
    v_max_f32 v133, v133, v141
    v_max_f32 v134, v134, v142
    v_max_f32 v135, v135, v143
    v_pk_add_f32 v[128:129], v[128:129], s[62:63] op_sel:[0,1] op_sel_hi:[1,1]
    v_pk_add_f32 v[130:131], v[130:131], s[62:63] op_sel:[0,1] op_sel_hi:[1,1]
    v_pk_add_f32 v[132:133], v[132:133], s[62:63] op_sel:[0,1] op_sel_hi:[1,1]
    v_pk_add_f32 v[134:135], v[134:135], s[62:63] op_sel:[0,1] op_sel_hi:[1,1]
    v_cvt_pk_bf16_f32 v148, v128, v129
    v_cvt_pk_bf16_f32 v149, v130, v131
    v_cvt_pk_bf16_f32 v150, v132, v133
    v_cvt_pk_bf16_f32 v151, v134, v135
    buffer_store_dwordx4 v[148:151], v201, s[16:19], s68 offen sc1
    v_pk_fma_f32 v[128:129], v[228:229], v[196:197], v[76:77] op_sel_hi:[1,0,1] neg_lo:[0,1,0] neg_hi:[0,1,0]
    v_pk_fma_f32 v[130:131], v[230:231], v[196:197], v[78:79] op_sel_hi:[1,0,1] neg_lo:[0,1,0] neg_hi:[0,1,0]
    v_pk_fma_f32 v[132:133], v[232:233], v[196:197], v[88:89] op_sel_hi:[1,0,1] neg_lo:[0,1,0] neg_hi:[0,1,0]
    v_pk_fma_f32 v[134:135], v[234:235], v[196:197], v[90:91] op_sel_hi:[1,0,1] neg_lo:[0,1,0] neg_hi:[0,1,0]
    v_pk_mul_f32 v[128:129], v[128:129], v[196:197] op_sel:[0,1] op_sel_hi:[1,1]
    v_pk_mul_f32 v[130:131], v[130:131], v[196:197] op_sel:[0,1] op_sel_hi:[1,1]
    v_pk_mul_f32 v[132:133], v[132:133], v[196:197] op_sel:[0,1] op_sel_hi:[1,1]
    v_pk_mul_f32 v[134:135], v[134:135], v[196:197] op_sel:[0,1] op_sel_hi:[1,1]
    buffer_load_dwordx4 a[144:147], v3, s[16:19], s58 offen offset:1024 sc1
    v_exp_f32 v136, v128 clamp
    v_exp_f32 v137, v129 clamp
    v_exp_f32 v138, v130 clamp
    v_exp_f32 v139, v131 clamp
    v_exp_f32 v140, v132 clamp
    v_exp_f32 v141, v133 clamp
    v_exp_f32 v142, v134 clamp
    v_exp_f32 v143, v135 clamp
    v_pk_fma_f32 v[128:129], v[128:129], s[62:63], 1.0 op_sel_hi:[1,0,0]
    v_pk_fma_f32 v[130:131], v[130:131], s[62:63], 1.0 op_sel_hi:[1,0,0]
    v_pk_fma_f32 v[132:133], v[132:133], s[62:63], 1.0 op_sel_hi:[1,0,0]
    v_pk_fma_f32 v[134:135], v[134:135], s[62:63], 1.0 op_sel_hi:[1,0,0]
    v_max_f32 v128, v128, v136
    v_max_f32 v129, v129, v137
    v_max_f32 v130, v130, v138
    v_max_f32 v131, v131, v139
    v_max_f32 v132, v132, v140
    v_max_f32 v133, v133, v141
    v_max_f32 v134, v134, v142
    v_max_f32 v135, v135, v143
    v_pk_add_f32 v[128:129], v[128:129], s[62:63] op_sel:[0,1] op_sel_hi:[1,1]
    v_pk_add_f32 v[130:131], v[130:131], s[62:63] op_sel:[0,1] op_sel_hi:[1,1]
    v_pk_add_f32 v[132:133], v[132:133], s[62:63] op_sel:[0,1] op_sel_hi:[1,1]
    v_pk_add_f32 v[134:135], v[134:135], s[62:63] op_sel:[0,1] op_sel_hi:[1,1]
    v_cvt_pk_bf16_f32 v144, v128, v129
    v_cvt_pk_bf16_f32 v145, v130, v131
    v_cvt_pk_bf16_f32 v146, v132, v133
    v_cvt_pk_bf16_f32 v147, v134, v135
    buffer_store_dwordx4 v[144:147], v202, s[16:19], s68 offen sc1
    s_waitcnt lgkmcnt(1)
    v_pk_fma_f32 v[128:129], v[236:237], v[192:193], v[92:93] op_sel_hi:[1,0,1] neg_lo:[0,1,0] neg_hi:[0,1,0]
    v_pk_fma_f32 v[130:131], v[238:239], v[192:193], v[94:95] op_sel_hi:[1,0,1] neg_lo:[0,1,0] neg_hi:[0,1,0]
    v_pk_fma_f32 v[132:133], v[240:241], v[192:193], v[104:105] op_sel_hi:[1,0,1] neg_lo:[0,1,0] neg_hi:[0,1,0]
    v_pk_fma_f32 v[134:135], v[242:243], v[192:193], v[106:107] op_sel_hi:[1,0,1] neg_lo:[0,1,0] neg_hi:[0,1,0]
    v_pk_mul_f32 v[128:129], v[128:129], v[192:193] op_sel:[0,1] op_sel_hi:[1,1]
    v_pk_mul_f32 v[130:131], v[130:131], v[192:193] op_sel:[0,1] op_sel_hi:[1,1]
    v_pk_mul_f32 v[132:133], v[132:133], v[192:193] op_sel:[0,1] op_sel_hi:[1,1]
    v_pk_mul_f32 v[134:135], v[134:135], v[192:193] op_sel:[0,1] op_sel_hi:[1,1]
    buffer_load_dwordx4 a[148:151], v3, s[16:19], s58 offen offset:2048 sc1
    v_exp_f32 v136, v128 clamp
    v_exp_f32 v137, v129 clamp
    v_exp_f32 v138, v130 clamp
    v_exp_f32 v139, v131 clamp
    v_exp_f32 v140, v132 clamp
    v_exp_f32 v141, v133 clamp
    v_exp_f32 v142, v134 clamp
    v_exp_f32 v143, v135 clamp
    v_pk_fma_f32 v[128:129], v[128:129], s[62:63], 1.0 op_sel_hi:[1,0,0]
    v_pk_fma_f32 v[130:131], v[130:131], s[62:63], 1.0 op_sel_hi:[1,0,0]
    v_pk_fma_f32 v[132:133], v[132:133], s[62:63], 1.0 op_sel_hi:[1,0,0]
    v_pk_fma_f32 v[134:135], v[134:135], s[62:63], 1.0 op_sel_hi:[1,0,0]
    buffer_load_dwordx4 a[152:155], v3, s[16:19], s58 offen offset:3072 sc1
    v_max_f32 v128, v128, v136
    v_max_f32 v129, v129, v137
    v_max_f32 v130, v130, v138
    v_max_f32 v131, v131, v139
    v_max_f32 v132, v132, v140
    v_max_f32 v133, v133, v141
    v_max_f32 v134, v134, v142
    v_max_f32 v135, v135, v143
    v_pk_add_f32 v[128:129], v[128:129], s[62:63] op_sel:[0,1] op_sel_hi:[1,1]
    v_pk_add_f32 v[130:131], v[130:131], s[62:63] op_sel:[0,1] op_sel_hi:[1,1]
    v_pk_add_f32 v[132:133], v[132:133], s[62:63] op_sel:[0,1] op_sel_hi:[1,1]
    v_pk_add_f32 v[134:135], v[134:135], s[62:63] op_sel:[0,1] op_sel_hi:[1,1]
    v_cvt_pk_bf16_f32 v148, v128, v129
    v_cvt_pk_bf16_f32 v149, v130, v131
    v_cvt_pk_bf16_f32 v150, v132, v133
    v_cvt_pk_bf16_f32 v151, v134, v135
    buffer_store_dwordx4 v[148:151], v200, s[16:19], s69 offen sc1
    v_pk_fma_f32 v[128:129], v[236:237], v[194:195], v[96:97] op_sel_hi:[1,0,1] neg_lo:[0,1,0] neg_hi:[0,1,0]
    v_pk_fma_f32 v[130:131], v[238:239], v[194:195], v[98:99] op_sel_hi:[1,0,1] neg_lo:[0,1,0] neg_hi:[0,1,0]
    v_pk_fma_f32 v[132:133], v[240:241], v[194:195], v[108:109] op_sel_hi:[1,0,1] neg_lo:[0,1,0] neg_hi:[0,1,0]
    v_pk_fma_f32 v[134:135], v[242:243], v[194:195], v[110:111] op_sel_hi:[1,0,1] neg_lo:[0,1,0] neg_hi:[0,1,0]
    v_pk_mul_f32 v[128:129], v[128:129], v[194:195] op_sel:[0,1] op_sel_hi:[1,1]
    v_pk_mul_f32 v[130:131], v[130:131], v[194:195] op_sel:[0,1] op_sel_hi:[1,1]
    v_pk_mul_f32 v[132:133], v[132:133], v[194:195] op_sel:[0,1] op_sel_hi:[1,1]
    v_pk_mul_f32 v[134:135], v[134:135], v[194:195] op_sel:[0,1] op_sel_hi:[1,1]
    buffer_load_dwordx4 a[156:159], v4, s[16:19], s58 offen offset:0 sc1
    v_exp_f32 v136, v128 clamp
    v_exp_f32 v137, v129 clamp
    v_exp_f32 v138, v130 clamp
    v_exp_f32 v139, v131 clamp
    v_exp_f32 v140, v132 clamp
    v_exp_f32 v141, v133 clamp
    v_exp_f32 v142, v134 clamp
    v_exp_f32 v143, v135 clamp
    v_pk_fma_f32 v[128:129], v[128:129], s[62:63], 1.0 op_sel_hi:[1,0,0]
    v_pk_fma_f32 v[130:131], v[130:131], s[62:63], 1.0 op_sel_hi:[1,0,0]
    v_pk_fma_f32 v[132:133], v[132:133], s[62:63], 1.0 op_sel_hi:[1,0,0]
    v_pk_fma_f32 v[134:135], v[134:135], s[62:63], 1.0 op_sel_hi:[1,0,0]
    s_add_u32 s58, s36, 3
    s_and_b32 s58, s58, 2
    s_mul_i32 s58, s58, 1536
    s_add_u32 s58, s58, s65
    s_add_u32 s65, s65, 16384
    buffer_load_dwordx4 a[160:163], v3, s[16:19], s58 offen offset:0 sc1
    v_max_f32 v128, v128, v136
    v_max_f32 v129, v129, v137
    v_max_f32 v130, v130, v138
    v_max_f32 v131, v131, v139
    v_max_f32 v132, v132, v140
    v_max_f32 v133, v133, v141
    v_max_f32 v134, v134, v142
    v_max_f32 v135, v135, v143
    v_pk_add_f32 v[128:129], v[128:129], s[62:63] op_sel:[0,1] op_sel_hi:[1,1]
    v_pk_add_f32 v[130:131], v[130:131], s[62:63] op_sel:[0,1] op_sel_hi:[1,1]
    v_pk_add_f32 v[132:133], v[132:133], s[62:63] op_sel:[0,1] op_sel_hi:[1,1]
    v_pk_add_f32 v[134:135], v[134:135], s[62:63] op_sel:[0,1] op_sel_hi:[1,1]
    v_cvt_pk_bf16_f32 v144, v128, v129
    v_cvt_pk_bf16_f32 v145, v130, v131
    v_cvt_pk_bf16_f32 v146, v132, v133
    v_cvt_pk_bf16_f32 v147, v134, v135
    buffer_store_dwordx4 v[144:147], v201, s[16:19], s69 offen sc1
    v_pk_fma_f32 v[128:129], v[236:237], v[196:197], v[100:101] op_sel_hi:[1,0,1] neg_lo:[0,1,0] neg_hi:[0,1,0]
    v_pk_fma_f32 v[130:131], v[238:239], v[196:197], v[102:103] op_sel_hi:[1,0,1] neg_lo:[0,1,0] neg_hi:[0,1,0]
    v_pk_fma_f32 v[132:133], v[240:241], v[196:197], v[112:113] op_sel_hi:[1,0,1] neg_lo:[0,1,0] neg_hi:[0,1,0]
    v_pk_fma_f32 v[134:135], v[242:243], v[196:197], v[114:115] op_sel_hi:[1,0,1] neg_lo:[0,1,0] neg_hi:[0,1,0]
    v_pk_mul_f32 v[128:129], v[128:129], v[196:197] op_sel:[0,1] op_sel_hi:[1,1]
    v_pk_mul_f32 v[130:131], v[130:131], v[196:197] op_sel:[0,1] op_sel_hi:[1,1]
    v_pk_mul_f32 v[132:133], v[132:133], v[196:197] op_sel:[0,1] op_sel_hi:[1,1]
    v_pk_mul_f32 v[134:135], v[134:135], v[196:197] op_sel:[0,1] op_sel_hi:[1,1]
    buffer_load_dwordx4 a[164:167], v3, s[16:19], s58 offen offset:1024 sc1
    v_exp_f32 v136, v128 clamp
    v_exp_f32 v137, v129 clamp
    v_exp_f32 v138, v130 clamp
    v_exp_f32 v139, v131 clamp
    v_exp_f32 v140, v132 clamp
    v_exp_f32 v141, v133 clamp
    v_exp_f32 v142, v134 clamp
    v_exp_f32 v143, v135 clamp
    v_pk_fma_f32 v[128:129], v[128:129], s[62:63], 1.0 op_sel_hi:[1,0,0]
    v_pk_fma_f32 v[130:131], v[130:131], s[62:63], 1.0 op_sel_hi:[1,0,0]
    v_pk_fma_f32 v[132:133], v[132:133], s[62:63], 1.0 op_sel_hi:[1,0,0]
    v_pk_fma_f32 v[134:135], v[134:135], s[62:63], 1.0 op_sel_hi:[1,0,0]
    v_max_f32 v128, v128, v136
    v_max_f32 v129, v129, v137
    v_max_f32 v130, v130, v138
    v_max_f32 v131, v131, v139
    v_max_f32 v132, v132, v140
    v_max_f32 v133, v133, v141
    v_max_f32 v134, v134, v142
    v_max_f32 v135, v135, v143
    v_pk_add_f32 v[128:129], v[128:129], s[62:63] op_sel:[0,1] op_sel_hi:[1,1]
    v_pk_add_f32 v[130:131], v[130:131], s[62:63] op_sel:[0,1] op_sel_hi:[1,1]
    v_pk_add_f32 v[132:133], v[132:133], s[62:63] op_sel:[0,1] op_sel_hi:[1,1]
    v_pk_add_f32 v[134:135], v[134:135], s[62:63] op_sel:[0,1] op_sel_hi:[1,1]
    v_cvt_pk_bf16_f32 v148, v128, v129
    v_cvt_pk_bf16_f32 v149, v130, v131
    v_cvt_pk_bf16_f32 v150, v132, v133
    v_cvt_pk_bf16_f32 v151, v134, v135
    buffer_store_dwordx4 v[148:151], v202, s[16:19], s69 offen sc1
    s_waitcnt lgkmcnt(0)
    v_pk_fma_f32 v[128:129], v[224:225], v[192:193], v[56:57] op_sel_hi:[1,0,1] neg_lo:[0,1,0] neg_hi:[0,1,0]
    v_pk_fma_f32 v[130:131], v[226:227], v[192:193], v[58:59] op_sel_hi:[1,0,1] neg_lo:[0,1,0] neg_hi:[0,1,0]
    v_pk_fma_f32 v[132:133], v[244:245], v[192:193], v[116:117] op_sel_hi:[1,0,1] neg_lo:[0,1,0] neg_hi:[0,1,0]
    v_pk_fma_f32 v[134:135], v[246:247], v[192:193], v[118:119] op_sel_hi:[1,0,1] neg_lo:[0,1,0] neg_hi:[0,1,0]
    v_pk_mul_f32 v[128:129], v[128:129], v[192:193] op_sel:[0,1] op_sel_hi:[1,1]
    v_pk_mul_f32 v[130:131], v[130:131], v[192:193] op_sel:[0,1] op_sel_hi:[1,1]
    v_pk_mul_f32 v[132:133], v[132:133], v[192:193] op_sel:[0,1] op_sel_hi:[1,1]
    v_pk_mul_f32 v[134:135], v[134:135], v[192:193] op_sel:[0,1] op_sel_hi:[1,1]
    v_exp_f32 v136, v128 clamp
    v_exp_f32 v137, v129 clamp
    v_exp_f32 v138, v130 clamp
    v_exp_f32 v139, v131 clamp
    v_exp_f32 v140, v132 clamp
    v_exp_f32 v141, v133 clamp
    v_exp_f32 v142, v134 clamp
    v_exp_f32 v143, v135 clamp
    v_pk_fma_f32 v[128:129], v[128:129], s[62:63], 1.0 op_sel_hi:[1,0,0]
    v_pk_fma_f32 v[130:131], v[130:131], s[62:63], 1.0 op_sel_hi:[1,0,0]
    v_pk_fma_f32 v[132:133], v[132:133], s[62:63], 1.0 op_sel_hi:[1,0,0]
    v_pk_fma_f32 v[134:135], v[134:135], s[62:63], 1.0 op_sel_hi:[1,0,0]
    v_max_f32 v128, v128, v136
    v_max_f32 v129, v129, v137
    v_max_f32 v130, v130, v138
    v_max_f32 v131, v131, v139
    v_max_f32 v132, v132, v140
    v_max_f32 v133, v133, v141
    v_max_f32 v134, v134, v142
    v_max_f32 v135, v135, v143
    v_pk_add_f32 v[128:129], v[128:129], s[62:63] op_sel:[0,1] op_sel_hi:[1,1]
    v_pk_add_f32 v[130:131], v[130:131], s[62:63] op_sel:[0,1] op_sel_hi:[1,1]
    v_pk_add_f32 v[132:133], v[132:133], s[62:63] op_sel:[0,1] op_sel_hi:[1,1]
    v_pk_add_f32 v[134:135], v[134:135], s[62:63] op_sel:[0,1] op_sel_hi:[1,1]
    v_cvt_pk_bf16_f32 v144, v128, v129
    v_cvt_pk_bf16_f32 v145, v130, v131
    v_cvt_pk_bf16_f32 v146, v132, v133
    v_cvt_pk_bf16_f32 v147, v134, v135
    buffer_store_dwordx4 v[144:147], v200, s[16:19], s70 offen sc1
    v_pk_fma_f32 v[128:129], v[224:225], v[194:195], v[60:61] op_sel_hi:[1,0,1] neg_lo:[0,1,0] neg_hi:[0,1,0]
    v_pk_fma_f32 v[130:131], v[226:227], v[194:195], v[62:63] op_sel_hi:[1,0,1] neg_lo:[0,1,0] neg_hi:[0,1,0]
    v_pk_fma_f32 v[132:133], v[244:245], v[194:195], v[120:121] op_sel_hi:[1,0,1] neg_lo:[0,1,0] neg_hi:[0,1,0]
    v_pk_fma_f32 v[134:135], v[246:247], v[194:195], v[122:123] op_sel_hi:[1,0,1] neg_lo:[0,1,0] neg_hi:[0,1,0]
    v_pk_mul_f32 v[128:129], v[128:129], v[194:195] op_sel:[0,1] op_sel_hi:[1,1]
    v_pk_mul_f32 v[130:131], v[130:131], v[194:195] op_sel:[0,1] op_sel_hi:[1,1]
    v_pk_mul_f32 v[132:133], v[132:133], v[194:195] op_sel:[0,1] op_sel_hi:[1,1]
    v_pk_mul_f32 v[134:135], v[134:135], v[194:195] op_sel:[0,1] op_sel_hi:[1,1]
    v_exp_f32 v136, v128 clamp
    v_exp_f32 v137, v129 clamp
    v_exp_f32 v138, v130 clamp
    v_exp_f32 v139, v131 clamp
    v_exp_f32 v140, v132 clamp
    v_exp_f32 v141, v133 clamp
    v_exp_f32 v142, v134 clamp
    v_exp_f32 v143, v135 clamp
    v_pk_fma_f32 v[128:129], v[128:129], s[62:63], 1.0 op_sel_hi:[1,0,0]
    v_pk_fma_f32 v[130:131], v[130:131], s[62:63], 1.0 op_sel_hi:[1,0,0]
    v_pk_fma_f32 v[132:133], v[132:133], s[62:63], 1.0 op_sel_hi:[1,0,0]
    v_pk_fma_f32 v[134:135], v[134:135], s[62:63], 1.0 op_sel_hi:[1,0,0]
    v_max_f32 v128, v128, v136
    v_max_f32 v129, v129, v137
    v_max_f32 v130, v130, v138
    v_max_f32 v131, v131, v139
    v_max_f32 v132, v132, v140
    v_max_f32 v133, v133, v141
    v_max_f32 v134, v134, v142
    v_max_f32 v135, v135, v143
    v_pk_add_f32 v[128:129], v[128:129], s[62:63] op_sel:[0,1] op_sel_hi:[1,1]
    v_pk_add_f32 v[130:131], v[130:131], s[62:63] op_sel:[0,1] op_sel_hi:[1,1]
    v_pk_add_f32 v[132:133], v[132:133], s[62:63] op_sel:[0,1] op_sel_hi:[1,1]
    v_pk_add_f32 v[134:135], v[134:135], s[62:63] op_sel:[0,1] op_sel_hi:[1,1]
    v_cvt_pk_bf16_f32 v148, v128, v129
    v_cvt_pk_bf16_f32 v149, v130, v131
    v_cvt_pk_bf16_f32 v150, v132, v133
    v_cvt_pk_bf16_f32 v151, v134, v135
    buffer_store_dwordx4 v[148:151], v201, s[16:19], s70 offen sc1
    v_pk_fma_f32 v[128:129], v[224:225], v[196:197], v[64:65] op_sel_hi:[1,0,1] neg_lo:[0,1,0] neg_hi:[0,1,0]
    v_pk_fma_f32 v[130:131], v[226:227], v[196:197], v[66:67] op_sel_hi:[1,0,1] neg_lo:[0,1,0] neg_hi:[0,1,0]
    v_pk_fma_f32 v[132:133], v[244:245], v[196:197], v[124:125] op_sel_hi:[1,0,1] neg_lo:[0,1,0] neg_hi:[0,1,0]
    v_pk_fma_f32 v[134:135], v[246:247], v[196:197], v[126:127] op_sel_hi:[1,0,1] neg_lo:[0,1,0] neg_hi:[0,1,0]
    v_pk_mul_f32 v[128:129], v[128:129], v[196:197] op_sel:[0,1] op_sel_hi:[1,1]
    v_pk_mul_f32 v[130:131], v[130:131], v[196:197] op_sel:[0,1] op_sel_hi:[1,1]
    v_pk_mul_f32 v[132:133], v[132:133], v[196:197] op_sel:[0,1] op_sel_hi:[1,1]
    v_pk_mul_f32 v[134:135], v[134:135], v[196:197] op_sel:[0,1] op_sel_hi:[1,1]
    v_exp_f32 v136, v128 clamp
    v_exp_f32 v137, v129 clamp
    v_exp_f32 v138, v130 clamp
    v_exp_f32 v139, v131 clamp
    v_exp_f32 v140, v132 clamp
    v_exp_f32 v141, v133 clamp
    v_exp_f32 v142, v134 clamp
    v_exp_f32 v143, v135 clamp
    v_pk_fma_f32 v[128:129], v[128:129], s[62:63], 1.0 op_sel_hi:[1,0,0]
    v_pk_fma_f32 v[130:131], v[130:131], s[62:63], 1.0 op_sel_hi:[1,0,0]
    v_pk_fma_f32 v[132:133], v[132:133], s[62:63], 1.0 op_sel_hi:[1,0,0]
    v_pk_fma_f32 v[134:135], v[134:135], s[62:63], 1.0 op_sel_hi:[1,0,0]
    v_max_f32 v128, v128, v136
    v_max_f32 v129, v129, v137
    v_max_f32 v130, v130, v138
    v_max_f32 v131, v131, v139
    v_max_f32 v132, v132, v140
    v_max_f32 v133, v133, v141
    v_max_f32 v134, v134, v142
    v_max_f32 v135, v135, v143
    v_pk_add_f32 v[128:129], v[128:129], s[62:63] op_sel:[0,1] op_sel_hi:[1,1]
    v_pk_add_f32 v[130:131], v[130:131], s[62:63] op_sel:[0,1] op_sel_hi:[1,1]
    v_pk_add_f32 v[132:133], v[132:133], s[62:63] op_sel:[0,1] op_sel_hi:[1,1]
    v_pk_add_f32 v[134:135], v[134:135], s[62:63] op_sel:[0,1] op_sel_hi:[1,1]
    v_cvt_pk_bf16_f32 v144, v128, v129
    v_cvt_pk_bf16_f32 v145, v130, v131
    v_cvt_pk_bf16_f32 v146, v132, v133
    v_cvt_pk_bf16_f32 v147, v134, v135
    buffer_store_dwordx4 v[144:147], v202, s[16:19], s70 offen sc1
    s_branch L_join
L_kv:
L_st10:
    s_cbranch_execz L_st14
    s_waitcnt vmcnt(11) lgkmcnt(0)
    s_barrier
    ds_read_b128 v[148:151], v187 offset:0
    ds_read_b128 v[152:155], v187 offset:2048
    ds_read_b128 v[156:159], v240
    ds_read_b64_tr_b16 v[128:129], v183 offset:0
    ds_read_b64_tr_b16 v[130:131], v183 offset:1280
    ds_read_b64_tr_b16 v[132:133], v184 offset:32
    ds_read_b64_tr_b16 v[134:135], v184 offset:1312
    ds_read_b64_tr_b16 v[136:137], v183 offset:64
    ds_read_b64_tr_b16 v[138:139], v183 offset:1344
    ds_read_b64_tr_b16 v[140:141], v184 offset:96
    ds_read_b64_tr_b16 v[142:143], v184 offset:1376
    s_waitcnt lgkmcnt(6)
    v_mfma_f32_16x16x32_bf16 v[8:11], v[148:151], v[128:131], 0
    ds_read_b64_tr_b16 v[144:145], v183 offset:128
    v_mfma_f32_16x16x32_bf16 v[12:15], v[152:155], v[128:131], 0
    s_add_u32 m0, s46, 12288
    ds_read_b64_tr_b16 v[146:147], v183 offset:1408
    s_mul_i32 s50, s75, 192
    v_mfma_f32_16x16x32_bf16 v[16:19], v[156:159], v[128:131], 0
    s_waitcnt lgkmcnt(6)
    buffer_load_dwordx4 v177, s[8:11], s43 offen lds
    s_add_u32 s50, s50, 65536
    v_mfma_f32_16x16x32_bf16 v[20:23], v[148:151], v[132:135], 0
    ds_read_b64_tr_b16 v[128:129], v184 offset:160
    s_lshl_b32 s51, s75, 6
    v_mfma_f32_16x16x32_bf16 v[24:27], v[152:155], v[132:135], 0
    s_add_u32 m0, s47, 40960
    ds_read_b64_tr_b16 v[130:131], v184 offset:1440
    v_mov_b32 v248, 0
    v_mfma_f32_16x16x32_bf16 v[28:31], v[156:159], v[132:135], 0
    s_waitcnt lgkmcnt(6)
    buffer_load_dwordx4 v172, s[12:15], s44 offen lds
    v_mov_b32 v249, 0
    v_mfma_f32_16x16x32_bf16 v[32:35], v[148:151], v[136:139], 0
    ds_read_b64_tr_b16 v[132:133], v183 offset:192
    v_mov_b32 v250, 0
    v_mfma_f32_16x16x32_bf16 v[36:39], v[152:155], v[136:139], 0
    ds_read_b64_tr_b16 v[134:135], v183 offset:1472
    v_mov_b32 v251, 0
    v_mfma_f32_16x16x32_bf16 v[40:43], v[156:159], v[136:139], 0
    s_waitcnt lgkmcnt(6)
    buffer_store_dwordx4 v[224:227], v203, s[16:19], s66 offen sc1
    v_mfma_f32_16x16x32_bf16 v[44:47], v[148:151], v[140:143], 0
    ds_read_b64_tr_b16 v[136:137], v184 offset:224
    s_mov_b64 exec, 0xfff
    buffer_store_dwordx4 v[248:251], v3, s[16:19], s50 offen sc1
    s_mov_b64 exec, -1
    v_mfma_f32_16x16x32_bf16 v[48:51], v[152:155], v[140:143], 0
    s_add_u32 m0, s46, 13312
    ds_read_b64_tr_b16 v[138:139], v184 offset:1504
    v_mfma_f32_16x16x32_bf16 v[52:55], v[156:159], v[140:143], 0
    s_waitcnt lgkmcnt(6)
    buffer_load_dwordx4 v178, s[8:11], s43 offen lds
    v_lshlrev_b32 v204, 16, v192
    v_mfma_f32_16x16x32_bf16 v[56:59], v[148:151], v[144:147], 0
    ds_read_b64_tr_b16 v[140:141], v183 offset:256
    v_and_b32 v205, 0xffff0000, v192
    v_mfma_f32_16x16x32_bf16 v[60:63], v[152:155], v[144:147], 0
    ds_read_b64_tr_b16 v[142:143], v183 offset:1536
    v_lshlrev_b32 v206, 16, v193
    v_mfma_f32_16x16x32_bf16 v[64:67], v[156:159], v[144:147], 0
    s_waitcnt lgkmcnt(6)
    v_and_b32 v207, 0xffff0000, v193
    v_lshlrev_b32 v208, 16, v194
    v_mfma_f32_16x16x32_bf16 v[68:71], v[148:151], v[128:131], 0
    ds_read_b64_tr_b16 v[144:145], v184 offset:288
    v_and_b32 v209, 0xffff0000, v194
    v_mfma_f32_16x16x32_bf16 v[72:75], v[152:155], v[128:131], 0
    s_add_u32 m0, s47, 41984
    ds_read_b64_tr_b16 v[146:147], v184 offset:1568
    v_lshlrev_b32 v210, 16, v195
    v_mfma_f32_16x16x32_bf16 v[76:79], v[156:159], v[128:131], 0
    s_waitcnt lgkmcnt(6)
    buffer_load_dwordx4 v173, s[12:15], s44 offen lds
    v_and_b32 v211, 0xffff0000, v195
    v_mfma_f32_16x16x32_bf16 v[80:83], v[148:151], v[132:135], 0
    ds_read_b64_tr_b16 v[128:129], v183 offset:10240
    v_lshlrev_b32 v212, 16, v196
    v_mfma_f32_16x16x32_bf16 v[84:87], v[152:155], v[132:135], 0
    ds_read_b64_tr_b16 v[130:131], v183 offset:11520
    ds_read_b128 v[160:163], v188 offset:0
    v_mfma_f32_16x16x32_bf16 v[88:91], v[156:159], v[132:135], 0
    s_waitcnt lgkmcnt(7)
    buffer_store_dwordx4 v[224:227], v202, s[16:19], s66 offen sc1
    v_and_b32 v213, 0xffff0000, v196
    v_mfma_f32_16x16x32_bf16 v[92:95], v[148:151], v[136:139], 0
    ds_read_b64_tr_b16 v[132:133], v184 offset:10272
    ds_read_b128 v[164:167], v188 offset:2048
    v_mfma_f32_16x16x32_bf16 v[96:99], v[152:155], v[136:139], 0
    s_add_u32 m0, s46, 14336
    ds_read_b64_tr_b16 v[134:135], v184 offset:11552
    v_lshlrev_b32 v214, 16, v197
    v_mfma_f32_16x16x32_bf16 v[100:103], v[156:159], v[136:139], 0
    s_waitcnt lgkmcnt(8)
    ds_read_b128 v[168:171], v241
    buffer_load_dwordx4 v179, s[8:11], s43 offen lds
    v_mfma_f32_16x16x32_bf16 v[104:107], v[148:151], v[140:143], 0
    ds_read_b64_tr_b16 v[136:137], v183 offset:10304
    v_and_b32 v215, 0xffff0000, v197
    v_mfma_f32_16x16x32_bf16 v[108:111], v[152:155], v[140:143], 0
    ds_read_b64_tr_b16 v[138:139], v183 offset:11584
    v_lshlrev_b32 v216, 16, v198
    v_mfma_f32_16x16x32_bf16 v[112:115], v[156:159], v[140:143], 0
    s_waitcnt lgkmcnt(9)
    v_and_b32 v217, 0xffff0000, v198
    v_lshlrev_b32 v218, 16, v199
    v_mfma_f32_16x16x32_bf16 v[116:119], v[148:151], v[144:147], 0
    ds_read_b64_tr_b16 v[140:141], v184 offset:10336
    v_and_b32 v219, 0xffff0000, v199
    v_mfma_f32_16x16x32_bf16 v[120:123], v[152:155], v[144:147], 0
    s_add_u32 m0, s47, 43008
    ds_read_b64_tr_b16 v[142:143], v184 offset:11616
    v_lshlrev_b32 v220, 16, v200
    v_mfma_f32_16x16x32_bf16 v[124:127], v[156:159], v[144:147], 0
    s_waitcnt lgkmcnt(4)
    buffer_load_dwordx4 v174, s[12:15], s44 offen lds
    v_and_b32 v221, 0xffff0000, v200
    v_mfma_f32_16x16x32_bf16 v[8:11], v[160:163], v[128:131], v[8:11]
    ds_read_b64_tr_b16 v[144:145], v183 offset:10368
    v_lshlrev_b32 v222, 16, v201
    v_mfma_f32_16x16x32_bf16 v[12:15], v[164:167], v[128:131], v[12:15]
    s_add_u32 m0, s46, 15360
    ds_read_b64_tr_b16 v[146:147], v183 offset:11648
    v_and_b32 v223, 0xffff0000, v201
    v_mfma_f32_16x16x32_bf16 v[16:19], v[168:171], v[128:131], v[16:19]
    buffer_load_dwordx4 v180, s[8:11], s43 offen lds
    v_add_f32 v192, v204, v205
    v_mfma_f32_16x16x32_bf16 v[20:23], v[160:163], v[132:135], v[20:23]
    ds_read_b64_tr_b16 v[128:129], v184 offset:10400
    v_add_f32 v193, v206, v207
    v_mfma_f32_16x16x32_bf16 v[24:27], v[164:167], v[132:135], v[24:27]
    ds_read_b64_tr_b16 v[130:131], v184 offset:11680
    v_add_f32 v192, v192, v208
    v_mfma_f32_16x16x32_bf16 v[28:31], v[168:171], v[132:135], v[28:31]
    s_waitcnt lgkmcnt(6)
    buffer_store_dwordx4 v[228:231], v203, s[16:19], s67 offen sc1
    v_add_f32 v193, v193, v209
    v_mfma_f32_16x16x32_bf16 v[32:35], v[160:163], v[136:139], v[32:35]
    ds_read_b64_tr_b16 v[132:133], v183 offset:10432
    v_add_f32 v192, v192, v210
    v_mfma_f32_16x16x32_bf16 v[36:39], v[164:167], v[136:139], v[36:39]
    s_add_u32 m0, s47, 44032
    ds_read_b64_tr_b16 v[134:135], v183 offset:11712
    v_add_f32 v193, v193, v211
    v_mfma_f32_16x16x32_bf16 v[40:43], v[168:171], v[136:139], v[40:43]
    s_waitcnt lgkmcnt(6)
    buffer_load_dwordx4 v175, s[12:15], s44 offen lds
    v_add_f32 v192, v192, v212
    v_mfma_f32_16x16x32_bf16 v[44:47], v[160:163], v[140:143], v[44:47]
    ds_read_b64_tr_b16 v[136:137], v184 offset:10464
    v_add_f32 v193, v193, v213
    v_mfma_f32_16x16x32_bf16 v[48:51], v[164:167], v[140:143], v[48:51]
    ds_read_b64_tr_b16 v[138:139], v184 offset:11744
    v_add_f32 v192, v192, v214
    v_mfma_f32_16x16x32_bf16 v[52:55], v[168:171], v[140:143], v[52:55]
    s_waitcnt lgkmcnt(6)
    v_add_f32 v193, v193, v215
    v_add_f32 v192, v192, v216
    v_mfma_f32_16x16x32_bf16 v[56:59], v[160:163], v[144:147], v[56:59]
    ds_read_b64_tr_b16 v[140:141], v183 offset:10496
    v_add_f32 v193, v193, v217
    v_mfma_f32_16x16x32_bf16 v[60:63], v[164:167], v[144:147], v[60:63]
    s_add_u32 m0, s46, 16384
    ds_read_b64_tr_b16 v[142:143], v183 offset:11776
    v_add_f32 v192, v192, v218
    v_mfma_f32_16x16x32_bf16 v[64:67], v[168:171], v[144:147], v[64:67]
    s_waitcnt lgkmcnt(6)
    buffer_load_dwordx4 v181, s[8:11], s43 offen lds
    v_add_f32 v193, v193, v219
    v_mfma_f32_16x16x32_bf16 v[68:71], v[160:163], v[128:131], v[68:71]
    ds_read_b64_tr_b16 v[144:145], v184 offset:10528
    v_add_f32 v192, v192, v220
    v_mfma_f32_16x16x32_bf16 v[72:75], v[164:167], v[128:131], v[72:75]
    ds_read_b64_tr_b16 v[146:147], v184 offset:11808
    v_add_f32 v193, v193, v221
    v_mfma_f32_16x16x32_bf16 v[76:79], v[168:171], v[128:131], v[76:79]
    s_waitcnt vmcnt(13) lgkmcnt(6)
    s_barrier
    v_mfma_f32_16x16x32_bf16 v[80:83], v[160:163], v[132:135], v[80:83]
    ds_read_b64_tr_b16 v[128:129], v183 offset:20480
    v_add_f32 v192, v192, v222
    v_mfma_f32_16x16x32_bf16 v[84:87], v[164:167], v[132:135], v[84:87]
    s_add_u32 m0, s47, 45056
    ds_read_b64_tr_b16 v[130:131], v183 offset:21760
    ds_read_b128 v[148:151], v187 offset:6144
    v_mfma_f32_16x16x32_bf16 v[88:91], v[168:171], v[132:135], v[88:91]
    s_waitcnt lgkmcnt(7)
    buffer_load_dwordx4 v176, s[12:15], s44 offen lds
    v_add_f32 v193, v193, v223
    v_mfma_f32_16x16x32_bf16 v[92:95], v[160:163], v[136:139], v[92:95]
    ds_read_b64_tr_b16 v[132:133], v184 offset:20512
    ds_read_b128 v[152:155], v187 offset:8192
    v_mfma_f32_16x16x32_bf16 v[96:99], v[164:167], v[136:139], v[96:99]
    s_add_u32 s44, s44, s45
    ds_read_b64_tr_b16 v[134:135], v184 offset:21792
    v_add_f32 v192, v192, v193
    v_mfma_f32_16x16x32_bf16 v[100:103], v[168:171], v[136:139], v[100:103]
    s_waitcnt lgkmcnt(8)
    ds_read_b128 v[156:159], v242
    v_add_f32_dpp v192, v192, v192 quad_perm:[1,0,3,2] row_mask:0xf bank_mask:0xf
    v_mfma_f32_16x16x32_bf16 v[104:107], v[160:163], v[140:143], v[104:107]
    ds_read_b64_tr_b16 v[136:137], v183 offset:20544
    v_add_f32_dpp v192, v192, v192 quad_perm:[2,3,0,1] row_mask:0xf bank_mask:0xf
    v_mfma_f32_16x16x32_bf16 v[108:111], v[164:167], v[140:143], v[108:111]
    s_add_u32 m0, s46, 17408
    ds_read_b64_tr_b16 v[138:139], v183 offset:21824
    v_add_f32_dpp v192, v192, v192 row_half_mirror row_mask:0xf bank_mask:0xf
    v_mfma_f32_16x16x32_bf16 v[112:115], v[168:171], v[140:143], v[112:115]
    s_waitcnt lgkmcnt(9)
    buffer_load_dwordx4 v182, s[8:11], s43 offen lds
    v_add_f32_dpp v192, v192, v192 row_mirror row_mask:0xf bank_mask:0xf
    v_mfma_f32_16x16x32_bf16 v[116:119], v[160:163], v[144:147], v[116:119]
    ds_read_b64_tr_b16 v[140:141], v184 offset:20576
    v_mov_b32 v193, v192
    v_mfma_f32_16x16x32_bf16 v[120:123], v[164:167], v[144:147], v[120:123]
    s_add_u32 s43, s43, 128
    ds_read_b64_tr_b16 v[142:143], v184 offset:21856
    v_permlane16_swap_b32 v192, v193
    v_mfma_f32_16x16x32_bf16 v[124:127], v[168:171], v[144:147], v[124:127]
    s_waitcnt lgkmcnt(4)
    v_add_f32 v192, v192, v193
    v_mul_f32 v192, 0x3acccccd, v192
    v_mfma_f32_16x16x32_bf16 v[8:11], v[148:151], v[128:131], v[8:11]
    ds_read_b64_tr_b16 v[144:145], v183 offset:20608
    v_sub_f32 v204, v204, v192
    v_mfma_f32_16x16x32_bf16 v[12:15], v[152:155], v[128:131], v[12:15]
    s_add_u32 m0, s46, 0
    ds_read_b64_tr_b16 v[146:147], v183 offset:21888
    v_sub_f32 v205, v205, v192
    v_mfma_f32_16x16x32_bf16 v[16:19], v[156:159], v[128:131], v[16:19]
    buffer_load_dwordx4 v177, s[8:11], s43 offen lds
    v_sub_f32 v206, v206, v192
    v_mfma_f32_16x16x32_bf16 v[20:23], v[148:151], v[132:135], v[20:23]
    ds_read_b64_tr_b16 v[128:129], v184 offset:20640
    v_sub_f32 v207, v207, v192
    v_mfma_f32_16x16x32_bf16 v[24:27], v[152:155], v[132:135], v[24:27]
    s_add_u32 m0, s47, 61440
    ds_read_b64_tr_b16 v[130:131], v184 offset:21920
    v_sub_f32 v208, v208, v192
    v_mfma_f32_16x16x32_bf16 v[28:31], v[156:159], v[132:135], v[28:31]
    s_waitcnt lgkmcnt(6)
    buffer_load_dwordx4 v172, s[12:15], s44 offen lds
    v_sub_f32 v209, v209, v192
    v_mfma_f32_16x16x32_bf16 v[32:35], v[148:151], v[136:139], v[32:35]
    ds_read_b64_tr_b16 v[132:133], v183 offset:20672
    v_sub_f32 v210, v210, v192
    v_mfma_f32_16x16x32_bf16 v[36:39], v[152:155], v[136:139], v[36:39]
    ds_read_b64_tr_b16 v[134:135], v183 offset:21952
    v_sub_f32 v211, v211, v192
    v_mfma_f32_16x16x32_bf16 v[40:43], v[156:159], v[136:139], v[40:43]
    s_waitcnt lgkmcnt(6)
    buffer_store_dwordx4 v[228:231], v202, s[16:19], s67 offen sc1
    v_sub_f32 v212, v212, v192
    v_mfma_f32_16x16x32_bf16 v[44:47], v[148:151], v[140:143], v[44:47]
    ds_read_b64_tr_b16 v[136:137], v184 offset:20704
    v_sub_f32 v213, v213, v192
    v_mfma_f32_16x16x32_bf16 v[48:51], v[152:155], v[140:143], v[48:51]
    s_add_u32 m0, s46, 1024
    ds_read_b64_tr_b16 v[138:139], v184 offset:21984
    v_sub_f32 v214, v214, v192
    v_mfma_f32_16x16x32_bf16 v[52:55], v[156:159], v[140:143], v[52:55]
    s_waitcnt lgkmcnt(6)
    buffer_load_dwordx4 v178, s[8:11], s43 offen lds
    v_sub_f32 v215, v215, v192
    v_mfma_f32_16x16x32_bf16 v[56:59], v[148:151], v[144:147], v[56:59]
L_st11:
    s_cbranch_execz L_iwback
    ds_read_b64_tr_b16 v[140:141], v183 offset:20736
    v_sub_f32 v216, v216, v192
    v_mfma_f32_16x16x32_bf16 v[60:63], v[152:155], v[144:147], v[60:63]
    ds_read_b64_tr_b16 v[142:143], v183 offset:22016
    v_sub_f32 v217, v217, v192
    v_mfma_f32_16x16x32_bf16 v[64:67], v[156:159], v[144:147], v[64:67]
    s_waitcnt lgkmcnt(6)
    v_sub_f32 v218, v218, v192
    v_sub_f32 v219, v219, v192
    v_mfma_f32_16x16x32_bf16 v[68:71], v[148:151], v[128:131], v[68:71]
    ds_read_b64_tr_b16 v[144:145], v184 offset:20768
    v_sub_f32 v220, v220, v192
    v_mfma_f32_16x16x32_bf16 v[72:75], v[152:155], v[128:131], v[72:75]
    s_add_u32 m0, s47, 62464
    ds_read_b64_tr_b16 v[146:147], v184 offset:22048
    v_sub_f32 v221, v221, v192
    v_mfma_f32_16x16x32_bf16 v[76:79], v[156:159], v[128:131], v[76:79]
    s_waitcnt lgkmcnt(6)
    buffer_load_dwordx4 v173, s[12:15], s44 offen lds
    v_sub_f32 v222, v222, v192
    v_mfma_f32_16x16x32_bf16 v[80:83], v[148:151], v[132:135], v[80:83]
    ds_read_b64_tr_b16 v[128:129], v183 offset:30720
    v_sub_f32 v223, v223, v192
    v_mfma_f32_16x16x32_bf16 v[84:87], v[152:155], v[132:135], v[84:87]
    ds_read_b64_tr_b16 v[130:131], v183 offset:32000
    ds_read_b128 v[160:163], v188 offset:6144
    v_mfma_f32_16x16x32_bf16 v[88:91], v[156:159], v[132:135], v[88:91]
    s_waitcnt lgkmcnt(7)
    buffer_store_dwordx4 v[232:235], v203, s[16:19], s68 offen sc1
    v_mul_f32 v193, v204, v204
    v_mfma_f32_16x16x32_bf16 v[92:95], v[148:151], v[136:139], v[92:95]
    ds_read_b64_tr_b16 v[132:133], v184 offset:30752
    ds_read_b128 v[164:167], v188 offset:8192
    v_mfma_f32_16x16x32_bf16 v[96:99], v[152:155], v[136:139], v[96:99]
    s_add_u32 m0, s46, 2048
    ds_read_b64_tr_b16 v[134:135], v184 offset:32032
    v_mul_f32 v194, v205, v205
    v_mfma_f32_16x16x32_bf16 v[100:103], v[156:159], v[136:139], v[100:103]
    s_waitcnt lgkmcnt(8)
    ds_read_b128 v[168:171], v243
    buffer_load_dwordx4 v179, s[8:11], s43 offen lds
    v_mfma_f32_16x16x32_bf16 v[104:107], v[148:151], v[140:143], v[104:107]
    ds_read_b64_tr_b16 v[136:137], v183 offset:30784
    v_fmac_f32 v193, v206, v206
    v_mfma_f32_16x16x32_bf16 v[108:111], v[152:155], v[140:143], v[108:111]
    ds_read_b64_tr_b16 v[138:139], v183 offset:32064
    v_fmac_f32 v194, v207, v207
    v_mfma_f32_16x16x32_bf16 v[112:115], v[156:159], v[140:143], v[112:115]
    s_waitcnt lgkmcnt(9)
    v_fmac_f32 v193, v208, v208
    v_fmac_f32 v194, v209, v209
    v_mfma_f32_16x16x32_bf16 v[116:119], v[148:151], v[144:147], v[116:119]
    ds_read_b64_tr_b16 v[140:141], v184 offset:30816
    v_fmac_f32 v193, v210, v210
    v_mfma_f32_16x16x32_bf16 v[120:123], v[152:155], v[144:147], v[120:123]
    s_add_u32 m0, s47, 63488
    ds_read_b64_tr_b16 v[142:143], v184 offset:32096
    v_fmac_f32 v194, v211, v211
    v_mfma_f32_16x16x32_bf16 v[124:127], v[156:159], v[144:147], v[124:127]
    s_waitcnt lgkmcnt(4)
    buffer_load_dwordx4 v174, s[12:15], s44 offen lds
    v_fmac_f32 v193, v212, v212
    v_mfma_f32_16x16x32_bf16 v[8:11], v[160:163], v[128:131], v[8:11]
    ds_read_b64_tr_b16 v[144:145], v183 offset:30848
    v_fmac_f32 v194, v213, v213
    v_mfma_f32_16x16x32_bf16 v[12:15], v[164:167], v[128:131], v[12:15]
    s_add_u32 m0, s46, 3072
    ds_read_b64_tr_b16 v[146:147], v183 offset:32128
    v_fmac_f32 v193, v214, v214
    v_mfma_f32_16x16x32_bf16 v[16:19], v[168:171], v[128:131], v[16:19]
    buffer_load_dwordx4 v180, s[8:11], s43 offen lds
    v_fmac_f32 v194, v215, v215
    v_mfma_f32_16x16x32_bf16 v[20:23], v[160:163], v[132:135], v[20:23]
    ds_read_b64_tr_b16 v[128:129], v184 offset:30880
    v_fmac_f32 v193, v216, v216
    v_mfma_f32_16x16x32_bf16 v[24:27], v[164:167], v[132:135], v[24:27]
    ds_read_b64_tr_b16 v[130:131], v184 offset:32160
    v_fmac_f32 v194, v217, v217
    v_mfma_f32_16x16x32_bf16 v[28:31], v[168:171], v[132:135], v[28:31]
    s_waitcnt lgkmcnt(6)
    buffer_store_dwordx4 v[232:235], v202, s[16:19], s68 offen sc1
    v_fmac_f32 v193, v218, v218
    v_mfma_f32_16x16x32_bf16 v[32:35], v[160:163], v[136:139], v[32:35]
    ds_read_b64_tr_b16 v[132:133], v183 offset:30912
    v_fmac_f32 v194, v219, v219
    v_mfma_f32_16x16x32_bf16 v[36:39], v[164:167], v[136:139], v[36:39]
    s_add_u32 m0, s47, 64512
    ds_read_b64_tr_b16 v[134:135], v183 offset:32192
    v_fmac_f32 v193, v220, v220
    v_mfma_f32_16x16x32_bf16 v[40:43], v[168:171], v[136:139], v[40:43]
    s_waitcnt lgkmcnt(6)
    buffer_load_dwordx4 v175, s[12:15], s44 offen lds
    v_fmac_f32 v194, v221, v221
    v_mfma_f32_16x16x32_bf16 v[44:47], v[160:163], v[140:143], v[44:47]
    ds_read_b64_tr_b16 v[136:137], v184 offset:30944
    v_fmac_f32 v193, v222, v222
    v_mfma_f32_16x16x32_bf16 v[48:51], v[164:167], v[140:143], v[48:51]
    ds_read_b64_tr_b16 v[138:139], v184 offset:32224
    v_fmac_f32 v194, v223, v223
    v_mfma_f32_16x16x32_bf16 v[52:55], v[168:171], v[140:143], v[52:55]
    s_waitcnt lgkmcnt(6)
    v_add_f32 v193, v193, v194
    s_nop 1
    v_add_f32_dpp v193, v193, v193 quad_perm:[1,0,3,2] row_mask:0xf bank_mask:0xf
    v_mfma_f32_16x16x32_bf16 v[56:59], v[160:163], v[144:147], v[56:59]
    ds_read_b64_tr_b16 v[140:141], v183 offset:30976
    v_add_f32_dpp v193, v193, v193 quad_perm:[2,3,0,1] row_mask:0xf bank_mask:0xf
    v_mfma_f32_16x16x32_bf16 v[60:63], v[164:167], v[144:147], v[60:63]
    s_add_u32 m0, s46, 4096
    ds_read_b64_tr_b16 v[142:143], v183 offset:32256
    v_add_f32_dpp v193, v193, v193 row_half_mirror row_mask:0xf bank_mask:0xf
    v_mfma_f32_16x16x32_bf16 v[64:67], v[168:171], v[144:147], v[64:67]
    s_waitcnt lgkmcnt(6)
    buffer_load_dwordx4 v181, s[8:11], s43 offen lds
    v_add_f32_dpp v193, v193, v193 row_mirror row_mask:0xf bank_mask:0xf
    v_mfma_f32_16x16x32_bf16 v[68:71], v[160:163], v[128:131], v[68:71]
    ds_read_b64_tr_b16 v[144:145], v184 offset:31008
    v_mov_b32 v194, v193
    v_mfma_f32_16x16x32_bf16 v[72:75], v[164:167], v[128:131], v[72:75]
    ds_read_b64_tr_b16 v[146:147], v184 offset:32288
    v_permlane16_swap_b32 v193, v194
    v_mfma_f32_16x16x32_bf16 v[76:79], v[168:171], v[128:131], v[76:79]
    s_waitcnt vmcnt(12) lgkmcnt(6)
    s_barrier
    v_mfma_f32_16x16x32_bf16 v[80:83], v[160:163], v[132:135], v[80:83]
    ds_read_b64_tr_b16 v[128:129], v185 offset:0
    v_add_f32 v193, v193, v194
    v_mfma_f32_16x16x32_bf16 v[84:87], v[164:167], v[132:135], v[84:87]
    s_add_u32 m0, s47, 65536
    ds_read_b64_tr_b16 v[130:131], v185 offset:1280
    ds_read_b128 v[148:151], v187 offset:12288
    v_mfma_f32_16x16x32_bf16 v[88:91], v[168:171], v[132:135], v[88:91]
    s_waitcnt lgkmcnt(7)
    buffer_load_dwordx4 v176, s[12:15], s44 offen lds
    v_mov_b32 v194, 0x3727c5ac
    v_mfma_f32_16x16x32_bf16 v[92:95], v[160:163], v[136:139], v[92:95]
    ds_read_b64_tr_b16 v[132:133], v186 offset:32
    ds_read_b128 v[152:155], v187 offset:14336
    v_mfma_f32_16x16x32_bf16 v[96:99], v[164:167], v[136:139], v[96:99]
    s_add_u32 s44, s44, s45
    ds_read_b64_tr_b16 v[134:135], v186 offset:1312
    v_fmac_f32 v194, 0x3acccccd, v193
    v_mfma_f32_16x16x32_bf16 v[100:103], v[168:171], v[136:139], v[100:103]
    s_waitcnt lgkmcnt(8)
    ds_read_b128 v[156:159], v244
    v_mfma_f32_16x16x32_bf16 v[104:107], v[160:163], v[140:143], v[104:107]
    ds_read_b64_tr_b16 v[136:137], v185 offset:64
    v_mfma_f32_16x16x32_bf16 v[108:111], v[164:167], v[140:143], v[108:111]
    s_add_u32 m0, s46, 5120
    ds_read_b64_tr_b16 v[138:139], v185 offset:1344
    v_mfma_f32_16x16x32_bf16 v[112:115], v[168:171], v[140:143], v[112:115]
    s_waitcnt lgkmcnt(9)
    buffer_load_dwordx4 v182, s[8:11], s43 offen lds
    v_mfma_f32_16x16x32_bf16 v[116:119], v[160:163], v[144:147], v[116:119]
    ds_read_b64_tr_b16 v[140:141], v186 offset:96
    v_mfma_f32_16x16x32_bf16 v[120:123], v[164:167], v[144:147], v[120:123]
    s_add_u32 s43, s43, 128
    ds_read_b64_tr_b16 v[142:143], v186 offset:1376
    v_mfma_f32_16x16x32_bf16 v[124:127], v[168:171], v[144:147], v[124:127]
    s_waitcnt lgkmcnt(4)
    v_rsq_f32 v193, v194
    v_mfma_f32_16x16x32_bf16 v[8:11], v[148:151], v[128:131], v[8:11]
    ds_read_b64_tr_b16 v[144:145], v185 offset:128
    v_mov_b32 v194, v192
    v_mfma_f32_16x16x32_bf16 v[12:15], v[152:155], v[128:131], v[12:15]
    s_add_u32 m0, s46, 6144
    ds_read_b64_tr_b16 v[146:147], v185 offset:1408
    v_mov_b32 v195, v193
    v_mfma_f32_16x16x32_bf16 v[16:19], v[156:159], v[128:131], v[16:19]
    buffer_load_dwordx4 v177, s[8:11], s43 offen lds
    v_permlane32_swap_b32 v192, v194
    v_mfma_f32_16x16x32_bf16 v[20:23], v[148:151], v[132:135], v[20:23]
    ds_read_b64_tr_b16 v[128:129], v186 offset:160
    v_permlane32_swap_b32 v193, v195
    v_mfma_f32_16x16x32_bf16 v[24:27], v[152:155], v[132:135], v[24:27]
    s_add_u32 m0, s47, 0
    ds_read_b64_tr_b16 v[130:131], v186 offset:1440
    v_mfma_f32_16x16x32_bf16 v[28:31], v[156:159], v[132:135], v[28:31]
    s_waitcnt lgkmcnt(6)
    buffer_load_dwordx4 v172, s[12:15], s44 offen lds
    v_mfma_f32_16x16x32_bf16 v[32:35], v[148:151], v[136:139], v[32:35]
    ds_read_b64_tr_b16 v[132:133], v185 offset:192
    s_mov_b64 exec, 15
    buffer_store_dwordx4 v[192:195], v3, s[20:23], s51 offen sc1
    s_mov_b64 exec, -1
    v_mfma_f32_16x16x32_bf16 v[36:39], v[152:155], v[136:139], v[36:39]
    ds_read_b64_tr_b16 v[134:135], v185 offset:1472
    v_mfma_f32_16x16x32_bf16 v[40:43], v[156:159], v[136:139], v[40:43]
    s_waitcnt lgkmcnt(6)
    buffer_store_dwordx4 v[236:239], v203, s[16:19], s69 offen sc1
    v_mfma_f32_16x16x32_bf16 v[44:47], v[148:151], v[140:143], v[44:47]
    ds_read_b64_tr_b16 v[136:137], v186 offset:224
    v_mfma_f32_16x16x32_bf16 v[48:51], v[152:155], v[140:143], v[48:51]
    s_add_u32 m0, s46, 7168
    ds_read_b64_tr_b16 v[138:139], v186 offset:1504
    v_mfma_f32_16x16x32_bf16 v[52:55], v[156:159], v[140:143], v[52:55]
    s_waitcnt lgkmcnt(6)
    buffer_load_dwordx4 v178, s[8:11], s43 offen lds
    v_mfma_f32_16x16x32_bf16 v[56:59], v[148:151], v[144:147], v[56:59]
    ds_read_b64_tr_b16 v[140:141], v185 offset:256
    v_mfma_f32_16x16x32_bf16 v[60:63], v[152:155], v[144:147], v[60:63]
    ds_read_b64_tr_b16 v[142:143], v185 offset:1536
    v_mfma_f32_16x16x32_bf16 v[64:67], v[156:159], v[144:147], v[64:67]
    s_waitcnt lgkmcnt(6)
    v_mfma_f32_16x16x32_bf16 v[68:71], v[148:151], v[128:131], v[68:71]
    ds_read_b64_tr_b16 v[144:145], v186 offset:288
    v_mfma_f32_16x16x32_bf16 v[72:75], v[152:155], v[128:131], v[72:75]
    s_add_u32 m0, s47, 1024
    ds_read_b64_tr_b16 v[146:147], v186 offset:1568
    v_mfma_f32_16x16x32_bf16 v[76:79], v[156:159], v[128:131], v[76:79]
    s_waitcnt lgkmcnt(6)
    buffer_load_dwordx4 v173, s[12:15], s44 offen lds
    v_mfma_f32_16x16x32_bf16 v[80:83], v[148:151], v[132:135], v[80:83]
    ds_read_b64_tr_b16 v[128:129], v185 offset:10240
    v_mfma_f32_16x16x32_bf16 v[84:87], v[152:155], v[132:135], v[84:87]
    ds_read_b64_tr_b16 v[130:131], v185 offset:11520
    ds_read_b128 v[160:163], v188 offset:12288
    v_mfma_f32_16x16x32_bf16 v[88:91], v[156:159], v[132:135], v[88:91]
    s_waitcnt lgkmcnt(7)
    buffer_store_dwordx4 v[236:239], v202, s[16:19], s69 offen sc1
    v_mfma_f32_16x16x32_bf16 v[92:95], v[148:151], v[136:139], v[92:95]
    ds_read_b64_tr_b16 v[132:133], v186 offset:10272
    ds_read_b128 v[164:167], v188 offset:14336
    v_mfma_f32_16x16x32_bf16 v[96:99], v[152:155], v[136:139], v[96:99]
    s_add_u32 m0, s46, 8192
    ds_read_b64_tr_b16 v[134:135], v186 offset:11552
    v_mfma_f32_16x16x32_bf16 v[100:103], v[156:159], v[136:139], v[100:103]
    s_waitcnt lgkmcnt(8)
    ds_read_b128 v[168:171], v245
    buffer_load_dwordx4 v179, s[8:11], s43 offen lds
    v_mfma_f32_16x16x32_bf16 v[104:107], v[148:151], v[140:143], v[104:107]
    ds_read_b64_tr_b16 v[136:137], v185 offset:10304
    v_mfma_f32_16x16x32_bf16 v[108:111], v[152:155], v[140:143], v[108:111]
    ds_read_b64_tr_b16 v[138:139], v185 offset:11584
    v_mfma_f32_16x16x32_bf16 v[112:115], v[156:159], v[140:143], v[112:115]
    s_waitcnt lgkmcnt(9)
    v_mfma_f32_16x16x32_bf16 v[116:119], v[148:151], v[144:147], v[116:119]
    ds_read_b64_tr_b16 v[140:141], v186 offset:10336
    v_mfma_f32_16x16x32_bf16 v[120:123], v[152:155], v[144:147], v[120:123]
    s_add_u32 m0, s47, 2048
    ds_read_b64_tr_b16 v[142:143], v186 offset:11616
    v_mfma_f32_16x16x32_bf16 v[124:127], v[156:159], v[144:147], v[124:127]
    s_waitcnt lgkmcnt(4)
    buffer_load_dwordx4 v174, s[12:15], s44 offen lds
    v_mfma_f32_16x16x32_bf16 v[8:11], v[160:163], v[128:131], v[8:11]
    ds_read_b64_tr_b16 v[144:145], v185 offset:10368
    v_mfma_f32_16x16x32_bf16 v[12:15], v[164:167], v[128:131], v[12:15]
    s_add_u32 m0, s46, 9216
    ds_read_b64_tr_b16 v[146:147], v185 offset:11648
    v_mfma_f32_16x16x32_bf16 v[16:19], v[168:171], v[128:131], v[16:19]
    buffer_load_dwordx4 v180, s[8:11], s43 offen lds
    v_mfma_f32_16x16x32_bf16 v[20:23], v[160:163], v[132:135], v[20:23]
    ds_read_b64_tr_b16 v[128:129], v186 offset:10400
    v_mfma_f32_16x16x32_bf16 v[24:27], v[164:167], v[132:135], v[24:27]
    ds_read_b64_tr_b16 v[130:131], v186 offset:11680
    v_mfma_f32_16x16x32_bf16 v[28:31], v[168:171], v[132:135], v[28:31]
    s_waitcnt lgkmcnt(6)
    v_mfma_f32_16x16x32_bf16 v[32:35], v[160:163], v[136:139], v[32:35]
    ds_read_b64_tr_b16 v[132:133], v185 offset:10432
    v_mfma_f32_16x16x32_bf16 v[36:39], v[164:167], v[136:139], v[36:39]
    s_add_u32 m0, s47, 3072
    ds_read_b64_tr_b16 v[134:135], v185 offset:11712
    v_mfma_f32_16x16x32_bf16 v[40:43], v[168:171], v[136:139], v[40:43]
    s_waitcnt lgkmcnt(6)
    buffer_load_dwordx4 v175, s[12:15], s44 offen lds
    v_mfma_f32_16x16x32_bf16 v[44:47], v[160:163], v[140:143], v[44:47]
    ds_read_b64_tr_b16 v[136:137], v186 offset:10464
    v_mfma_f32_16x16x32_bf16 v[48:51], v[164:167], v[140:143], v[48:51]
    ds_read_b64_tr_b16 v[138:139], v186 offset:11744
    v_mfma_f32_16x16x32_bf16 v[52:55], v[168:171], v[140:143], v[52:55]
    s_waitcnt lgkmcnt(6)
    v_mfma_f32_16x16x32_bf16 v[56:59], v[160:163], v[144:147], v[56:59]
    ds_read_b64_tr_b16 v[140:141], v185 offset:10496
    v_mfma_f32_16x16x32_bf16 v[60:63], v[164:167], v[144:147], v[60:63]
    s_add_u32 m0, s46, 10240
    ds_read_b64_tr_b16 v[142:143], v185 offset:11776
    v_mfma_f32_16x16x32_bf16 v[64:67], v[168:171], v[144:147], v[64:67]
    s_waitcnt lgkmcnt(6)
    buffer_load_dwordx4 v181, s[8:11], s43 offen lds
    v_mfma_f32_16x16x32_bf16 v[68:71], v[160:163], v[128:131], v[68:71]
    ds_read_b64_tr_b16 v[144:145], v186 offset:10528
    v_mfma_f32_16x16x32_bf16 v[72:75], v[164:167], v[128:131], v[72:75]
    ds_read_b64_tr_b16 v[146:147], v186 offset:11808
    v_mfma_f32_16x16x32_bf16 v[76:79], v[168:171], v[128:131], v[76:79]
    s_waitcnt vmcnt(12) lgkmcnt(6)
    s_barrier
    v_mfma_f32_16x16x32_bf16 v[80:83], v[160:163], v[132:135], v[80:83]
    ds_read_b64_tr_b16 v[128:129], v185 offset:20480
    v_mfma_f32_16x16x32_bf16 v[84:87], v[164:167], v[132:135], v[84:87]
    s_add_u32 m0, s47, 4096
    ds_read_b64_tr_b16 v[130:131], v185 offset:21760
    ds_read_b128 v[148:151], v187 offset:0
    v_mfma_f32_16x16x32_bf16 v[88:91], v[168:171], v[132:135], v[88:91]
    s_waitcnt lgkmcnt(7)
    buffer_load_dwordx4 v176, s[12:15], s44 offen lds
    v_mfma_f32_16x16x32_bf16 v[92:95], v[160:163], v[136:139], v[92:95]
    ds_read_b64_tr_b16 v[132:133], v186 offset:20512
    ds_read_b128 v[152:155], v187 offset:2048
    v_mfma_f32_16x16x32_bf16 v[96:99], v[164:167], v[136:139], v[96:99]
    s_add_u32 s44, s44, s45
    ds_read_b64_tr_b16 v[134:135], v186 offset:21792
    v_mfma_f32_16x16x32_bf16 v[100:103], v[168:171], v[136:139], v[100:103]
    s_waitcnt lgkmcnt(8)
    ds_read_b128 v[156:159], v240
    v_mfma_f32_16x16x32_bf16 v[104:107], v[160:163], v[140:143], v[104:107]
    ds_read_b64_tr_b16 v[136:137], v185 offset:20544
    v_mfma_f32_16x16x32_bf16 v[108:111], v[164:167], v[140:143], v[108:111]
    s_add_u32 m0, s46, 11264
    ds_read_b64_tr_b16 v[138:139], v185 offset:21824
    v_mfma_f32_16x16x32_bf16 v[112:115], v[168:171], v[140:143], v[112:115]
    s_waitcnt lgkmcnt(9)
    buffer_load_dwordx4 v182, s[8:11], s43 offen lds
    v_mfma_f32_16x16x32_bf16 v[116:119], v[160:163], v[144:147], v[116:119]
    ds_read_b64_tr_b16 v[140:141], v186 offset:20576
    v_mfma_f32_16x16x32_bf16 v[120:123], v[164:167], v[144:147], v[120:123]
    s_add_u32 s43, s43, 128
    ds_read_b64_tr_b16 v[142:143], v186 offset:21856
    v_mfma_f32_16x16x32_bf16 v[124:127], v[168:171], v[144:147], v[124:127]
    s_waitcnt lgkmcnt(4)
    v_mfma_f32_16x16x32_bf16 v[8:11], v[148:151], v[128:131], v[8:11]
    ds_read_b64_tr_b16 v[144:145], v185 offset:20608
    v_mov_b32 v6, 0
    v_mfma_f32_16x16x32_bf16 v[12:15], v[152:155], v[128:131], v[12:15]
    s_add_u32 m0, s46, 12288
    ds_read_b64_tr_b16 v[146:147], v185 offset:21888
    v_mfma_f32_16x16x32_bf16 v[16:19], v[156:159], v[128:131], v[16:19]
    buffer_load_dwordx4 v177, s[8:11], s43 offen lds
    v_mfma_f32_16x16x32_bf16 v[20:23], v[148:151], v[132:135], v[20:23]
    ds_read_b64_tr_b16 v[128:129], v186 offset:20640
    buffer_load_dword v5, v6, s[24:27], 0 offen sc1
    v_mfma_f32_16x16x32_bf16 v[24:27], v[152:155], v[132:135], v[24:27]
    s_add_u32 m0, s47, 20480
    ds_read_b64_tr_b16 v[130:131], v186 offset:21920
    v_mfma_f32_16x16x32_bf16 v[28:31], v[156:159], v[132:135], v[28:31]
    s_waitcnt lgkmcnt(6)
    buffer_load_dwordx4 v172, s[12:15], s44 offen lds
    v_mfma_f32_16x16x32_bf16 v[32:35], v[148:151], v[136:139], v[32:35]
    ds_read_b64_tr_b16 v[132:133], v185 offset:20672
    v_mfma_f32_16x16x32_bf16 v[36:39], v[152:155], v[136:139], v[36:39]
    ds_read_b64_tr_b16 v[134:135], v185 offset:21952
    v_mfma_f32_16x16x32_bf16 v[40:43], v[156:159], v[136:139], v[40:43]
    s_waitcnt lgkmcnt(6)
    v_mfma_f32_16x16x32_bf16 v[44:47], v[148:151], v[140:143], v[44:47]
    ds_read_b64_tr_b16 v[136:137], v186 offset:20704
    v_mfma_f32_16x16x32_bf16 v[48:51], v[152:155], v[140:143], v[48:51]
    s_add_u32 m0, s46, 13312
    ds_read_b64_tr_b16 v[138:139], v186 offset:21984
    v_mfma_f32_16x16x32_bf16 v[52:55], v[156:159], v[140:143], v[52:55]
    s_waitcnt lgkmcnt(6)
    buffer_load_dwordx4 v178, s[8:11], s43 offen lds
    v_mfma_f32_16x16x32_bf16 v[56:59], v[148:151], v[144:147], v[56:59]
    ds_read_b64_tr_b16 v[140:141], v185 offset:20736
    v_mfma_f32_16x16x32_bf16 v[60:63], v[152:155], v[144:147], v[60:63]
    ds_read_b64_tr_b16 v[142:143], v185 offset:22016
    v_mfma_f32_16x16x32_bf16 v[64:67], v[156:159], v[144:147], v[64:67]
    s_waitcnt lgkmcnt(6)
    v_mfma_f32_16x16x32_bf16 v[68:71], v[148:151], v[128:131], v[68:71]
    ds_read_b64_tr_b16 v[144:145], v186 offset:20768
    v_mfma_f32_16x16x32_bf16 v[72:75], v[152:155], v[128:131], v[72:75]
    s_add_u32 m0, s47, 21504
    ds_read_b64_tr_b16 v[146:147], v186 offset:22048
    v_mfma_f32_16x16x32_bf16 v[76:79], v[156:159], v[128:131], v[76:79]
    s_waitcnt lgkmcnt(6)
    buffer_load_dwordx4 v173, s[12:15], s44 offen lds
    v_mfma_f32_16x16x32_bf16 v[80:83], v[148:151], v[132:135], v[80:83]
    ds_read_b64_tr_b16 v[128:129], v185 offset:30720
    v_mfma_f32_16x16x32_bf16 v[84:87], v[152:155], v[132:135], v[84:87]
    ds_read_b64_tr_b16 v[130:131], v185 offset:32000
    ds_read_b128 v[160:163], v188 offset:0
    v_mfma_f32_16x16x32_bf16 v[88:91], v[156:159], v[132:135], v[88:91]
    s_waitcnt lgkmcnt(7)
    v_mfma_f32_16x16x32_bf16 v[92:95], v[148:151], v[136:139], v[92:95]
    ds_read_b64_tr_b16 v[132:133], v186 offset:30752
    ds_read_b128 v[164:167], v188 offset:2048
    v_mfma_f32_16x16x32_bf16 v[96:99], v[152:155], v[136:139], v[96:99]
    s_add_u32 m0, s46, 14336
    ds_read_b64_tr_b16 v[134:135], v186 offset:32032
    v_mfma_f32_16x16x32_bf16 v[100:103], v[156:159], v[136:139], v[100:103]
    s_waitcnt lgkmcnt(8)
    ds_read_b128 v[168:171], v241
    buffer_load_dwordx4 v179, s[8:11], s43 offen lds
    v_mfma_f32_16x16x32_bf16 v[104:107], v[148:151], v[140:143], v[104:107]
    ds_read_b64_tr_b16 v[136:137], v185 offset:30784
    v_mfma_f32_16x16x32_bf16 v[108:111], v[152:155], v[140:143], v[108:111]
    ds_read_b64_tr_b16 v[138:139], v185 offset:32064
    v_mfma_f32_16x16x32_bf16 v[112:115], v[156:159], v[140:143], v[112:115]
    s_waitcnt lgkmcnt(9)
    v_mfma_f32_16x16x32_bf16 v[116:119], v[148:151], v[144:147], v[116:119]
    ds_read_b64_tr_b16 v[140:141], v186 offset:30816
    v_mfma_f32_16x16x32_bf16 v[120:123], v[152:155], v[144:147], v[120:123]
    s_add_u32 m0, s47, 22528
    ds_read_b64_tr_b16 v[142:143], v186 offset:32096
    v_mfma_f32_16x16x32_bf16 v[124:127], v[156:159], v[144:147], v[124:127]
    s_waitcnt lgkmcnt(4)
    buffer_load_dwordx4 v174, s[12:15], s44 offen lds
    v_mfma_f32_16x16x32_bf16 v[8:11], v[160:163], v[128:131], v[8:11]
    ds_read_b64_tr_b16 v[144:145], v185 offset:30848
    v_mfma_f32_16x16x32_bf16 v[12:15], v[164:167], v[128:131], v[12:15]
    s_add_u32 m0, s46, 15360
    ds_read_b64_tr_b16 v[146:147], v185 offset:32128
    v_mfma_f32_16x16x32_bf16 v[16:19], v[168:171], v[128:131], v[16:19]
    buffer_load_dwordx4 v180, s[8:11], s43 offen lds
    v_mfma_f32_16x16x32_bf16 v[20:23], v[160:163], v[132:135], v[20:23]
    ds_read_b64_tr_b16 v[128:129], v186 offset:30880
    v_mfma_f32_16x16x32_bf16 v[24:27], v[164:167], v[132:135], v[24:27]
    ds_read_b64_tr_b16 v[130:131], v186 offset:32160
    v_mfma_f32_16x16x32_bf16 v[28:31], v[168:171], v[132:135], v[28:31]
    s_waitcnt lgkmcnt(6)
    v_mfma_f32_16x16x32_bf16 v[32:35], v[160:163], v[136:139], v[32:35]
    ds_read_b64_tr_b16 v[132:133], v185 offset:30912
    v_mfma_f32_16x16x32_bf16 v[36:39], v[164:167], v[136:139], v[36:39]
    s_add_u32 m0, s47, 23552
    ds_read_b64_tr_b16 v[134:135], v185 offset:32192
    v_mfma_f32_16x16x32_bf16 v[40:43], v[168:171], v[136:139], v[40:43]
    s_waitcnt lgkmcnt(6)
    buffer_load_dwordx4 v175, s[12:15], s44 offen lds
    v_mfma_f32_16x16x32_bf16 v[44:47], v[160:163], v[140:143], v[44:47]
    ds_read_b64_tr_b16 v[136:137], v186 offset:30944
    v_mfma_f32_16x16x32_bf16 v[48:51], v[164:167], v[140:143], v[48:51]
    ds_read_b64_tr_b16 v[138:139], v186 offset:32224
    v_mfma_f32_16x16x32_bf16 v[52:55], v[168:171], v[140:143], v[52:55]
    s_waitcnt lgkmcnt(6)
    v_mfma_f32_16x16x32_bf16 v[56:59], v[160:163], v[144:147], v[56:59]
    ds_read_b64_tr_b16 v[140:141], v185 offset:30976
    v_mfma_f32_16x16x32_bf16 v[60:63], v[164:167], v[144:147], v[60:63]
    s_add_u32 m0, s46, 16384
    ds_read_b64_tr_b16 v[142:143], v185 offset:32256
    v_mfma_f32_16x16x32_bf16 v[64:67], v[168:171], v[144:147], v[64:67]
    s_waitcnt lgkmcnt(6)
    buffer_load_dwordx4 v181, s[8:11], s43 offen lds
    v_mfma_f32_16x16x32_bf16 v[68:71], v[160:163], v[128:131], v[68:71]
    ds_read_b64_tr_b16 v[144:145], v186 offset:31008
    v_mfma_f32_16x16x32_bf16 v[72:75], v[164:167], v[128:131], v[72:75]
    ds_read_b64_tr_b16 v[146:147], v186 offset:32288
    v_mfma_f32_16x16x32_bf16 v[76:79], v[168:171], v[128:131], v[76:79]
    s_waitcnt vmcnt(10) lgkmcnt(6)
    s_barrier
    v_mfma_f32_16x16x32_bf16 v[80:83], v[160:163], v[132:135], v[80:83]
    ds_read_b64_tr_b16 v[128:129], v183 offset:0
    v_mfma_f32_16x16x32_bf16 v[84:87], v[164:167], v[132:135], v[84:87]
    s_add_u32 m0, s47, 24576
    ds_read_b64_tr_b16 v[130:131], v183 offset:1280
    ds_read_b128 v[148:151], v187 offset:6144
    v_mfma_f32_16x16x32_bf16 v[88:91], v[168:171], v[132:135], v[88:91]
    s_waitcnt lgkmcnt(7)
    buffer_load_dwordx4 v176, s[12:15], s44 offen lds
    v_mfma_f32_16x16x32_bf16 v[92:95], v[160:163], v[136:139], v[92:95]
    ds_read_b64_tr_b16 v[132:133], v184 offset:32
    ds_read_b128 v[152:155], v187 offset:8192
    v_mfma_f32_16x16x32_bf16 v[96:99], v[164:167], v[136:139], v[96:99]
    s_add_u32 s44, s44, s45
    ds_read_b64_tr_b16 v[134:135], v184 offset:1312
    v_mfma_f32_16x16x32_bf16 v[100:103], v[168:171], v[136:139], v[100:103]
    s_waitcnt lgkmcnt(8)
    ds_read_b128 v[156:159], v242
    v_mfma_f32_16x16x32_bf16 v[104:107], v[160:163], v[140:143], v[104:107]
    ds_read_b64_tr_b16 v[136:137], v183 offset:64
    s_lshr_b32 s3, s2, 3
    v_mfma_f32_16x16x32_bf16 v[108:111], v[164:167], v[140:143], v[108:111]
    s_add_u32 m0, s46, 17408
    ds_read_b64_tr_b16 v[138:139], v183 offset:1344
    v_mfma_f32_16x16x32_bf16 v[112:115], v[168:171], v[140:143], v[112:115]
    s_waitcnt lgkmcnt(9)
    buffer_load_dwordx4 v182, s[8:11], s43 offen lds
    v_mfma_f32_16x16x32_bf16 v[116:119], v[160:163], v[144:147], v[116:119]
    ds_read_b64_tr_b16 v[140:141], v184 offset:96
    s_lshl_b32 s3, s3, 7
    v_mfma_f32_16x16x32_bf16 v[120:123], v[164:167], v[144:147], v[120:123]
    s_add_u32 s43, s43, 128
    ds_read_b64_tr_b16 v[142:143], v184 offset:1376
    v_mfma_f32_16x16x32_bf16 v[124:127], v[168:171], v[144:147], v[124:127]
    s_waitcnt lgkmcnt(4)
    v_mfma_f32_16x16x32_bf16 v[8:11], v[148:151], v[128:131], v[8:11]
    ds_read_b64_tr_b16 v[144:145], v183 offset:128
    s_add_u32 s3, s3, 294912
    v_mfma_f32_16x16x32_bf16 v[12:15], v[152:155], v[128:131], v[12:15]
    s_add_u32 m0, s46, 0
    ds_read_b64_tr_b16 v[146:147], v183 offset:1408
    v_mfma_f32_16x16x32_bf16 v[16:19], v[156:159], v[128:131], v[16:19]
    buffer_load_dwordx4 v177, s[8:11], s43 offen lds
    v_mfma_f32_16x16x32_bf16 v[20:23], v[148:151], v[132:135], v[20:23]
    ds_read_b64_tr_b16 v[128:129], v184 offset:160
    s_waitcnt vmcnt(11)
    s_cmp_lg_u32 s36, 0
    s_cbranch_scc1 L_noarr_kv
    v_cmp_gt_u32 vcc, 4, v5
    s_cbranch_vccz L_clr_kv_ok
    s_mov_b32 s56, 0
L_clr_kv_again:
    s_sleep 4
    buffer_load_dword v5, v6, s[24:27], 0 offen sc1
    s_waitcnt vmcnt(0)
    v_cmp_gt_u32 vcc, 4, v5
    s_add_u32 s56, s56, 1
    s_cmp_gt_u32 s56, 65536
    s_cbranch_scc1 L_clr_kv_ok
    s_cbranch_vccnz L_clr_kv_again
L_clr_kv_ok:
    v_mov_b32 v5, 1
    s_mov_b64 exec, 1
    buffer_atomic_add v5, v6, s[16:19], s3 offen sc1
    s_mov_b64 exec, -1
L_noarr_kv:
    v_mfma_f32_16x16x32_bf16 v[24:27], v[152:155], v[132:135], v[24:27]
    s_add_u32 m0, s47, 40960
    ds_read_b64_tr_b16 v[130:131], v184 offset:1440
    v_mfma_f32_16x16x32_bf16 v[28:31], v[156:159], v[132:135], v[28:31]
    s_waitcnt lgkmcnt(6)
    buffer_load_dwordx4 v172, s[12:15], s44 offen lds
    v_mfma_f32_16x16x32_bf16 v[32:35], v[148:151], v[136:139], v[32:35]
    ds_read_b64_tr_b16 v[132:133], v183 offset:192
    v_mfma_f32_16x16x32_bf16 v[36:39], v[152:155], v[136:139], v[36:39]
    ds_read_b64_tr_b16 v[134:135], v183 offset:1472
    v_mfma_f32_16x16x32_bf16 v[40:43], v[156:159], v[136:139], v[40:43]
    s_waitcnt lgkmcnt(6)
    v_mfma_f32_16x16x32_bf16 v[44:47], v[148:151], v[140:143], v[44:47]
    ds_read_b64_tr_b16 v[136:137], v184 offset:224
    v_mfma_f32_16x16x32_bf16 v[48:51], v[152:155], v[140:143], v[48:51]
    s_add_u32 m0, s46, 1024
    ds_read_b64_tr_b16 v[138:139], v184 offset:1504
    v_lshlrev_b32 v250, 5, v189
    v_mfma_f32_16x16x32_bf16 v[52:55], v[156:159], v[140:143], v[52:55]
    s_waitcnt lgkmcnt(6)
    buffer_load_dwordx4 v178, s[8:11], s43 offen lds
    v_lshlrev_b32 v251, 5, v190
    v_mfma_f32_16x16x32_bf16 v[56:59], v[148:151], v[144:147], v[56:59]
    ds_read_b64_tr_b16 v[140:141], v183 offset:256
    v_lshlrev_b32 v252, 5, v191
    v_mfma_f32_16x16x32_bf16 v[60:63], v[152:155], v[144:147], v[60:63]
    ds_read_b64_tr_b16 v[142:143], v183 offset:1536
    s_mul_i32 s42, s36, 35840
    v_mfma_f32_16x16x32_bf16 v[64:67], v[156:159], v[144:147], v[64:67]
    s_waitcnt lgkmcnt(6)
    s_lshl_b32 s65, s49, 22
    s_add_u32 s65, s65, 4194304
    v_mfma_f32_16x16x32_bf16 v[68:71], v[148:151], v[128:131], v[68:71]
    ds_read_b64_tr_b16 v[144:145], v184 offset:288
    s_and_b32 s40, s2, 1
    v_mfma_f32_16x16x32_bf16 v[72:75], v[152:155], v[128:131], v[72:75]
    s_add_u32 m0, s47, 41984
    ds_read_b64_tr_b16 v[146:147], v184 offset:1568
    s_mul_i32 s40, s40, 27
    v_mfma_f32_16x16x32_bf16 v[76:79], v[156:159], v[128:131], v[76:79]
    s_waitcnt lgkmcnt(6)
    buffer_load_dwordx4 v173, s[12:15], s44 offen lds
    s_add_u32 s40, s40, s36
    v_mfma_f32_16x16x32_bf16 v[80:83], v[148:151], v[132:135], v[80:83]
    ds_read_b64_tr_b16 v[128:129], v183 offset:10240
    s_lshl_b32 s57, s40, 14
    v_mfma_f32_16x16x32_bf16 v[84:87], v[152:155], v[132:135], v[84:87]
    ds_read_b64_tr_b16 v[130:131], v183 offset:11520
    ds_read_b128 v[160:163], v188 offset:6144
    v_mfma_f32_16x16x32_bf16 v[88:91], v[156:159], v[132:135], v[88:91]
    s_waitcnt lgkmcnt(7)
    s_add_u32 s57, s57, s65
    s_and_b32 s50, s40, 2
    v_mfma_f32_16x16x32_bf16 v[92:95], v[148:151], v[136:139], v[92:95]
    ds_read_b64_tr_b16 v[132:133], v184 offset:10272
    ds_read_b128 v[164:167], v188 offset:8192
    v_mfma_f32_16x16x32_bf16 v[96:99], v[152:155], v[136:139], v[96:99]
    s_add_u32 m0, s46, 2048
    ds_read_b64_tr_b16 v[134:135], v184 offset:11552
    s_mul_i32 s50, s50, 1536
    v_mfma_f32_16x16x32_bf16 v[100:103], v[156:159], v[136:139], v[100:103]
    s_waitcnt lgkmcnt(8)
    ds_read_b128 v[168:171], v243
    buffer_load_dwordx4 v179, s[8:11], s43 offen lds
    v_mfma_f32_16x16x32_bf16 v[104:107], v[148:151], v[140:143], v[104:107]
    ds_read_b64_tr_b16 v[136:137], v183 offset:10304
    s_add_u32 s57, s57, s50
    v_mfma_f32_16x16x32_bf16 v[108:111], v[152:155], v[140:143], v[108:111]
    ds_read_b64_tr_b16 v[138:139], v183 offset:11584
    s_mul_i32 s50, s36, 81920
    v_mfma_f32_16x16x32_bf16 v[112:115], v[156:159], v[140:143], v[112:115]
    s_waitcnt lgkmcnt(9)
    s_add_u32 s65, s65, s50
    s_add_u32 s65, s65, 884736
    v_mfma_f32_16x16x32_bf16 v[116:119], v[148:151], v[144:147], v[116:119]
    ds_read_b64_tr_b16 v[140:141], v184 offset:10336
    s_add_u32 s72, s36, 1
    v_mfma_f32_16x16x32_bf16 v[120:123], v[152:155], v[144:147], v[120:123]
L_st12:
    s_cbranch_execz L_iwback
    s_add_u32 m0, s47, 43008
    ds_read_b64_tr_b16 v[142:143], v184 offset:11616
    s_lshr_b32 s72, s72, 2
    v_mfma_f32_16x16x32_bf16 v[124:127], v[156:159], v[144:147], v[124:127]
    s_waitcnt lgkmcnt(4)
    buffer_load_dwordx4 v174, s[12:15], s44 offen lds
    s_lshl_b32 s72, s72, 30
    v_mfma_f32_16x16x32_bf16 v[8:11], v[160:163], v[128:131], v[8:11]
    ds_read_b64_tr_b16 v[144:145], v183 offset:10368
    s_mov_b32 s62, 0x3f317218
    v_mfma_f32_16x16x32_bf16 v[12:15], v[164:167], v[128:131], v[12:15]
    s_add_u32 m0, s46, 3072
    ds_read_b64_tr_b16 v[146:147], v183 offset:11648
    s_mov_b32 s63, 0x358637bd
    v_mfma_f32_16x16x32_bf16 v[16:19], v[168:171], v[128:131], v[16:19]
    buffer_load_dwordx4 v180, s[8:11], s43 offen lds
    v_mfma_f32_16x16x32_bf16 v[20:23], v[160:163], v[132:135], v[20:23]
    ds_read_b64_tr_b16 v[128:129], v184 offset:10400
    v_mfma_f32_16x16x32_bf16 v[24:27], v[164:167], v[132:135], v[24:27]
    ds_read_b64_tr_b16 v[130:131], v184 offset:11680
    v_mfma_f32_16x16x32_bf16 v[28:31], v[168:171], v[132:135], v[28:31]
    s_waitcnt lgkmcnt(6)
    v_mfma_f32_16x16x32_bf16 v[32:35], v[160:163], v[136:139], v[32:35]
    ds_read_b64_tr_b16 v[132:133], v183 offset:10432
    v_mfma_f32_16x16x32_bf16 v[36:39], v[164:167], v[136:139], v[36:39]
    s_add_u32 m0, s47, 44032
    ds_read_b64_tr_b16 v[134:135], v183 offset:11712
    v_mfma_f32_16x16x32_bf16 v[40:43], v[168:171], v[136:139], v[40:43]
    s_waitcnt lgkmcnt(6)
    buffer_load_dwordx4 v175, s[12:15], s44 offen lds
    v_mfma_f32_16x16x32_bf16 v[44:47], v[160:163], v[140:143], v[44:47]
    ds_read_b64_tr_b16 v[136:137], v184 offset:10464
    v_mfma_f32_16x16x32_bf16 v[48:51], v[164:167], v[140:143], v[48:51]
    ds_read_b64_tr_b16 v[138:139], v184 offset:11744
    v_mfma_f32_16x16x32_bf16 v[52:55], v[168:171], v[140:143], v[52:55]
    s_waitcnt lgkmcnt(6)
    v_mfma_f32_16x16x32_bf16 v[56:59], v[160:163], v[144:147], v[56:59]
    ds_read_b64_tr_b16 v[140:141], v183 offset:10496
    v_mfma_f32_16x16x32_bf16 v[60:63], v[164:167], v[144:147], v[60:63]
    s_add_u32 m0, s46, 4096
    ds_read_b64_tr_b16 v[142:143], v183 offset:11776
    v_mfma_f32_16x16x32_bf16 v[64:67], v[168:171], v[144:147], v[64:67]
    s_waitcnt lgkmcnt(6)
    buffer_load_dwordx4 v181, s[8:11], s43 offen lds
    v_mfma_f32_16x16x32_bf16 v[68:71], v[160:163], v[128:131], v[68:71]
    ds_read_b64_tr_b16 v[144:145], v184 offset:10528
    v_mfma_f32_16x16x32_bf16 v[72:75], v[164:167], v[128:131], v[72:75]
    ds_read_b64_tr_b16 v[146:147], v184 offset:11808
    v_mfma_f32_16x16x32_bf16 v[76:79], v[168:171], v[128:131], v[76:79]
    s_waitcnt vmcnt(9) lgkmcnt(6)
    s_barrier
    v_mfma_f32_16x16x32_bf16 v[80:83], v[160:163], v[132:135], v[80:83]
    ds_read_b64_tr_b16 v[128:129], v183 offset:20480
    v_mfma_f32_16x16x32_bf16 v[84:87], v[164:167], v[132:135], v[84:87]
    s_add_u32 m0, s47, 45056
    ds_read_b64_tr_b16 v[130:131], v183 offset:21760
    ds_read_b128 v[148:151], v187 offset:12288
    v_mfma_f32_16x16x32_bf16 v[88:91], v[168:171], v[132:135], v[88:91]
    s_waitcnt lgkmcnt(7)
    buffer_load_dwordx4 v176, s[12:15], s44 offen lds
    v_mfma_f32_16x16x32_bf16 v[92:95], v[160:163], v[136:139], v[92:95]
    ds_read_b64_tr_b16 v[132:133], v184 offset:20512
    ds_read_b128 v[152:155], v187 offset:14336
    v_mfma_f32_16x16x32_bf16 v[96:99], v[164:167], v[136:139], v[96:99]
    s_add_u32 s44, s44, s45
    ds_read_b64_tr_b16 v[134:135], v184 offset:21792
    v_mfma_f32_16x16x32_bf16 v[100:103], v[168:171], v[136:139], v[100:103]
    s_waitcnt lgkmcnt(8)
    ds_read_b128 v[156:159], v244
    v_mfma_f32_16x16x32_bf16 v[104:107], v[160:163], v[140:143], v[104:107]
    ds_read_b64_tr_b16 v[136:137], v183 offset:20544
    v_mfma_f32_16x16x32_bf16 v[108:111], v[164:167], v[140:143], v[108:111]
    s_add_u32 m0, s46, 5120
    ds_read_b64_tr_b16 v[138:139], v183 offset:21824
    v_mfma_f32_16x16x32_bf16 v[112:115], v[168:171], v[140:143], v[112:115]
    s_waitcnt lgkmcnt(9)
    buffer_load_dwordx4 v182, s[8:11], s43 offen lds
    v_mfma_f32_16x16x32_bf16 v[116:119], v[160:163], v[144:147], v[116:119]
    ds_read_b64_tr_b16 v[140:141], v184 offset:20576
    v_mfma_f32_16x16x32_bf16 v[120:123], v[164:167], v[144:147], v[120:123]
    s_add_u32 s43, s43, 128
    ds_read_b64_tr_b16 v[142:143], v184 offset:21856
    v_mfma_f32_16x16x32_bf16 v[124:127], v[168:171], v[144:147], v[124:127]
    s_waitcnt lgkmcnt(4)
    v_mfma_f32_16x16x32_bf16 v[8:11], v[148:151], v[128:131], v[8:11]
    ds_read_b64_tr_b16 v[144:145], v183 offset:20608
    v_mfma_f32_16x16x32_bf16 v[12:15], v[152:155], v[128:131], v[12:15]
    s_add_u32 m0, s46, 6144
    ds_read_b64_tr_b16 v[146:147], v183 offset:21888
    v_mfma_f32_16x16x32_bf16 v[16:19], v[156:159], v[128:131], v[16:19]
    buffer_load_dwordx4 v177, s[8:11], s43 offen lds
    v_mfma_f32_16x16x32_bf16 v[20:23], v[148:151], v[132:135], v[20:23]
    ds_read_b64_tr_b16 v[128:129], v184 offset:20640
    v_mfma_f32_16x16x32_bf16 v[24:27], v[152:155], v[132:135], v[24:27]
    s_add_u32 m0, s47, 61440
    ds_read_b64_tr_b16 v[130:131], v184 offset:21920
    v_mfma_f32_16x16x32_bf16 v[28:31], v[156:159], v[132:135], v[28:31]
    s_waitcnt lgkmcnt(6)
    buffer_load_dwordx4 v172, s[12:15], s44 offen lds
    v_mfma_f32_16x16x32_bf16 v[32:35], v[148:151], v[136:139], v[32:35]
    ds_read_b64_tr_b16 v[132:133], v183 offset:20672
    v_mfma_f32_16x16x32_bf16 v[36:39], v[152:155], v[136:139], v[36:39]
    ds_read_b64_tr_b16 v[134:135], v183 offset:21952
    v_mfma_f32_16x16x32_bf16 v[40:43], v[156:159], v[136:139], v[40:43]
    s_waitcnt lgkmcnt(6)
    v_mfma_f32_16x16x32_bf16 v[44:47], v[148:151], v[140:143], v[44:47]
    ds_read_b64_tr_b16 v[136:137], v184 offset:20704
    v_mfma_f32_16x16x32_bf16 v[48:51], v[152:155], v[140:143], v[48:51]
    s_add_u32 m0, s46, 7168
    ds_read_b64_tr_b16 v[138:139], v184 offset:21984
    v_mfma_f32_16x16x32_bf16 v[52:55], v[156:159], v[140:143], v[52:55]
    s_waitcnt lgkmcnt(6)
    buffer_load_dwordx4 v178, s[8:11], s43 offen lds
    v_mfma_f32_16x16x32_bf16 v[56:59], v[148:151], v[144:147], v[56:59]
    ds_read_b64_tr_b16 v[140:141], v183 offset:20736
    v_mfma_f32_16x16x32_bf16 v[60:63], v[152:155], v[144:147], v[60:63]
    ds_read_b64_tr_b16 v[142:143], v183 offset:22016
    v_mfma_f32_16x16x32_bf16 v[64:67], v[156:159], v[144:147], v[64:67]
    s_waitcnt lgkmcnt(6)
    v_mfma_f32_16x16x32_bf16 v[68:71], v[148:151], v[128:131], v[68:71]
    ds_read_b64_tr_b16 v[144:145], v184 offset:20768
    v_mfma_f32_16x16x32_bf16 v[72:75], v[152:155], v[128:131], v[72:75]
    s_add_u32 m0, s47, 62464
    ds_read_b64_tr_b16 v[146:147], v184 offset:22048
    v_mfma_f32_16x16x32_bf16 v[76:79], v[156:159], v[128:131], v[76:79]
    s_waitcnt lgkmcnt(6)
    buffer_load_dwordx4 v173, s[12:15], s44 offen lds
    v_mfma_f32_16x16x32_bf16 v[80:83], v[148:151], v[132:135], v[80:83]
    ds_read_b64_tr_b16 v[128:129], v183 offset:30720
    v_mfma_f32_16x16x32_bf16 v[84:87], v[152:155], v[132:135], v[84:87]
    ds_read_b64_tr_b16 v[130:131], v183 offset:32000
    ds_read_b128 v[160:163], v188 offset:12288
    v_mfma_f32_16x16x32_bf16 v[88:91], v[156:159], v[132:135], v[88:91]
    s_waitcnt lgkmcnt(7)
    v_mfma_f32_16x16x32_bf16 v[92:95], v[148:151], v[136:139], v[92:95]
    ds_read_b64_tr_b16 v[132:133], v184 offset:30752
    ds_read_b128 v[164:167], v188 offset:14336
    v_mfma_f32_16x16x32_bf16 v[96:99], v[152:155], v[136:139], v[96:99]
    s_add_u32 m0, s46, 8192
    ds_read_b64_tr_b16 v[134:135], v184 offset:32032
    v_mfma_f32_16x16x32_bf16 v[100:103], v[156:159], v[136:139], v[100:103]
    s_waitcnt lgkmcnt(8)
    ds_read_b128 v[168:171], v245
    buffer_load_dwordx4 v179, s[8:11], s43 offen lds
    v_mfma_f32_16x16x32_bf16 v[104:107], v[148:151], v[140:143], v[104:107]
    ds_read_b64_tr_b16 v[136:137], v183 offset:30784
    v_mfma_f32_16x16x32_bf16 v[108:111], v[152:155], v[140:143], v[108:111]
    ds_read_b64_tr_b16 v[138:139], v183 offset:32064
    v_mfma_f32_16x16x32_bf16 v[112:115], v[156:159], v[140:143], v[112:115]
    s_waitcnt lgkmcnt(9)
    v_mfma_f32_16x16x32_bf16 v[116:119], v[148:151], v[144:147], v[116:119]
    ds_read_b64_tr_b16 v[140:141], v184 offset:30816
    v_mfma_f32_16x16x32_bf16 v[120:123], v[152:155], v[144:147], v[120:123]
    s_add_u32 m0, s47, 63488
    ds_read_b64_tr_b16 v[142:143], v184 offset:32096
    v_mfma_f32_16x16x32_bf16 v[124:127], v[156:159], v[144:147], v[124:127]
    s_waitcnt lgkmcnt(4)
    buffer_load_dwordx4 v174, s[12:15], s44 offen lds
    v_mfma_f32_16x16x32_bf16 v[8:11], v[160:163], v[128:131], v[8:11]
    ds_read_b64_tr_b16 v[144:145], v183 offset:30848
    v_mfma_f32_16x16x32_bf16 v[12:15], v[164:167], v[128:131], v[12:15]
    s_add_u32 m0, s46, 9216
    ds_read_b64_tr_b16 v[146:147], v183 offset:32128
    v_mfma_f32_16x16x32_bf16 v[16:19], v[168:171], v[128:131], v[16:19]
    buffer_load_dwordx4 v180, s[8:11], s43 offen lds
    v_mfma_f32_16x16x32_bf16 v[20:23], v[160:163], v[132:135], v[20:23]
    ds_read_b64_tr_b16 v[128:129], v184 offset:30880
    v_mfma_f32_16x16x32_bf16 v[24:27], v[164:167], v[132:135], v[24:27]
    ds_read_b64_tr_b16 v[130:131], v184 offset:32160
    v_mfma_f32_16x16x32_bf16 v[28:31], v[168:171], v[132:135], v[28:31]
    s_waitcnt lgkmcnt(6)
    v_mfma_f32_16x16x32_bf16 v[32:35], v[160:163], v[136:139], v[32:35]
    ds_read_b64_tr_b16 v[132:133], v183 offset:30912
    v_mfma_f32_16x16x32_bf16 v[36:39], v[164:167], v[136:139], v[36:39]
    s_add_u32 m0, s47, 64512
    ds_read_b64_tr_b16 v[134:135], v183 offset:32192
    v_mfma_f32_16x16x32_bf16 v[40:43], v[168:171], v[136:139], v[40:43]
    s_waitcnt lgkmcnt(6)
    buffer_load_dwordx4 v175, s[12:15], s44 offen lds
    v_mfma_f32_16x16x32_bf16 v[44:47], v[160:163], v[140:143], v[44:47]
    ds_read_b64_tr_b16 v[136:137], v184 offset:30944
    v_mfma_f32_16x16x32_bf16 v[48:51], v[164:167], v[140:143], v[48:51]
    ds_read_b64_tr_b16 v[138:139], v184 offset:32224
    v_mfma_f32_16x16x32_bf16 v[52:55], v[168:171], v[140:143], v[52:55]
    s_waitcnt lgkmcnt(6)
    v_mfma_f32_16x16x32_bf16 v[56:59], v[160:163], v[144:147], v[56:59]
    ds_read_b64_tr_b16 v[140:141], v183 offset:30976
    v_mfma_f32_16x16x32_bf16 v[60:63], v[164:167], v[144:147], v[60:63]
    s_add_u32 m0, s46, 10240
    ds_read_b64_tr_b16 v[142:143], v183 offset:32256
    v_mfma_f32_16x16x32_bf16 v[64:67], v[168:171], v[144:147], v[64:67]
    s_waitcnt lgkmcnt(6)
    buffer_load_dwordx4 v181, s[8:11], s43 offen lds
    v_mfma_f32_16x16x32_bf16 v[68:71], v[160:163], v[128:131], v[68:71]
    ds_read_b64_tr_b16 v[144:145], v184 offset:31008
    v_mfma_f32_16x16x32_bf16 v[72:75], v[164:167], v[128:131], v[72:75]
    ds_read_b64_tr_b16 v[146:147], v184 offset:32288
    v_mfma_f32_16x16x32_bf16 v[76:79], v[168:171], v[128:131], v[76:79]
    s_waitcnt vmcnt(9) lgkmcnt(6)
    s_barrier
    v_mfma_f32_16x16x32_bf16 v[80:83], v[160:163], v[132:135], v[80:83]
    ds_read_b64_tr_b16 v[128:129], v185 offset:0
    v_mfma_f32_16x16x32_bf16 v[84:87], v[164:167], v[132:135], v[84:87]
    s_add_u32 m0, s47, 65536
    ds_read_b64_tr_b16 v[130:131], v185 offset:1280
    ds_read_b128 v[148:151], v187 offset:0
    v_mfma_f32_16x16x32_bf16 v[88:91], v[168:171], v[132:135], v[88:91]
    s_waitcnt lgkmcnt(7)
    buffer_load_dwordx4 v176, s[12:15], s44 offen lds
    v_mfma_f32_16x16x32_bf16 v[92:95], v[160:163], v[136:139], v[92:95]
    ds_read_b64_tr_b16 v[132:133], v186 offset:32
    ds_read_b128 v[152:155], v187 offset:2048
    v_mfma_f32_16x16x32_bf16 v[96:99], v[164:167], v[136:139], v[96:99]
    s_add_u32 s44, s44, s45
    ds_read_b64_tr_b16 v[134:135], v186 offset:1312
    v_mfma_f32_16x16x32_bf16 v[100:103], v[168:171], v[136:139], v[100:103]
    s_waitcnt lgkmcnt(8)
    ds_read_b128 v[156:159], v240
    v_mfma_f32_16x16x32_bf16 v[104:107], v[160:163], v[140:143], v[104:107]
    ds_read_b64_tr_b16 v[136:137], v185 offset:64
    v_mfma_f32_16x16x32_bf16 v[108:111], v[164:167], v[140:143], v[108:111]
    s_add_u32 m0, s46, 11264
    ds_read_b64_tr_b16 v[138:139], v185 offset:1344
    v_mfma_f32_16x16x32_bf16 v[112:115], v[168:171], v[140:143], v[112:115]
    s_waitcnt lgkmcnt(9)
    buffer_load_dwordx4 v182, s[8:11], s43 offen lds
    v_mfma_f32_16x16x32_bf16 v[116:119], v[160:163], v[144:147], v[116:119]
    ds_read_b64_tr_b16 v[140:141], v186 offset:96
    v_mfma_f32_16x16x32_bf16 v[120:123], v[164:167], v[144:147], v[120:123]
    s_add_u32 s43, s43, 128
    ds_read_b64_tr_b16 v[142:143], v186 offset:1376
    v_mfma_f32_16x16x32_bf16 v[124:127], v[168:171], v[144:147], v[124:127]
    s_waitcnt lgkmcnt(4)
    v_mfma_f32_16x16x32_bf16 v[8:11], v[148:151], v[128:131], v[8:11]
    ds_read_b64_tr_b16 v[144:145], v185 offset:128
    v_mfma_f32_16x16x32_bf16 v[12:15], v[152:155], v[128:131], v[12:15]
    s_add_u32 m0, s46, 12288
    ds_read_b64_tr_b16 v[146:147], v185 offset:1408
    v_mfma_f32_16x16x32_bf16 v[16:19], v[156:159], v[128:131], v[16:19]
    buffer_load_dwordx4 v177, s[8:11], s43 offen lds
    v_mfma_f32_16x16x32_bf16 v[20:23], v[148:151], v[132:135], v[20:23]
    ds_read_b64_tr_b16 v[128:129], v186 offset:160
    v_mfma_f32_16x16x32_bf16 v[24:27], v[152:155], v[132:135], v[24:27]
    s_add_u32 m0, s47, 0
    ds_read_b64_tr_b16 v[130:131], v186 offset:1440
    v_mfma_f32_16x16x32_bf16 v[28:31], v[156:159], v[132:135], v[28:31]
    s_waitcnt lgkmcnt(6)
    buffer_load_dwordx4 v172, s[12:15], s44 offen lds
    v_mfma_f32_16x16x32_bf16 v[32:35], v[148:151], v[136:139], v[32:35]
    ds_read_b64_tr_b16 v[132:133], v185 offset:192
    v_mfma_f32_16x16x32_bf16 v[36:39], v[152:155], v[136:139], v[36:39]
    ds_read_b64_tr_b16 v[134:135], v185 offset:1472
    v_mfma_f32_16x16x32_bf16 v[40:43], v[156:159], v[136:139], v[40:43]
    s_waitcnt lgkmcnt(6)
    v_mfma_f32_16x16x32_bf16 v[44:47], v[148:151], v[140:143], v[44:47]
    ds_read_b64_tr_b16 v[136:137], v186 offset:224
    v_mfma_f32_16x16x32_bf16 v[48:51], v[152:155], v[140:143], v[48:51]
    s_add_u32 m0, s46, 13312
    ds_read_b64_tr_b16 v[138:139], v186 offset:1504
    v_mfma_f32_16x16x32_bf16 v[52:55], v[156:159], v[140:143], v[52:55]
    s_waitcnt lgkmcnt(6)
    buffer_load_dwordx4 v178, s[8:11], s43 offen lds
    v_mfma_f32_16x16x32_bf16 v[56:59], v[148:151], v[144:147], v[56:59]
    ds_read_b64_tr_b16 v[140:141], v185 offset:256
    v_mfma_f32_16x16x32_bf16 v[60:63], v[152:155], v[144:147], v[60:63]
    ds_read_b64_tr_b16 v[142:143], v185 offset:1536
    v_mfma_f32_16x16x32_bf16 v[64:67], v[156:159], v[144:147], v[64:67]
    s_waitcnt lgkmcnt(6)
    v_mfma_f32_16x16x32_bf16 v[68:71], v[148:151], v[128:131], v[68:71]
    ds_read_b64_tr_b16 v[144:145], v186 offset:288
    v_mfma_f32_16x16x32_bf16 v[72:75], v[152:155], v[128:131], v[72:75]
    s_add_u32 m0, s47, 1024
    ds_read_b64_tr_b16 v[146:147], v186 offset:1568
    v_mfma_f32_16x16x32_bf16 v[76:79], v[156:159], v[128:131], v[76:79]
    s_waitcnt lgkmcnt(6)
    buffer_load_dwordx4 v173, s[12:15], s44 offen lds
    v_mfma_f32_16x16x32_bf16 v[80:83], v[148:151], v[132:135], v[80:83]
    ds_read_b64_tr_b16 v[128:129], v185 offset:10240
    v_mfma_f32_16x16x32_bf16 v[84:87], v[152:155], v[132:135], v[84:87]
    ds_read_b64_tr_b16 v[130:131], v185 offset:11520
    ds_read_b128 v[160:163], v188 offset:0
    v_mfma_f32_16x16x32_bf16 v[88:91], v[156:159], v[132:135], v[88:91]
    s_waitcnt lgkmcnt(7)
    v_mfma_f32_16x16x32_bf16 v[92:95], v[148:151], v[136:139], v[92:95]
    ds_read_b64_tr_b16 v[132:133], v186 offset:10272
    ds_read_b128 v[164:167], v188 offset:2048
    v_mfma_f32_16x16x32_bf16 v[96:99], v[152:155], v[136:139], v[96:99]
    s_add_u32 m0, s46, 14336
    ds_read_b64_tr_b16 v[134:135], v186 offset:11552
    v_mfma_f32_16x16x32_bf16 v[100:103], v[156:159], v[136:139], v[100:103]
    s_waitcnt lgkmcnt(8)
    ds_read_b128 v[168:171], v241
    buffer_load_dwordx4 v179, s[8:11], s43 offen lds
    v_mfma_f32_16x16x32_bf16 v[104:107], v[148:151], v[140:143], v[104:107]
    ds_read_b64_tr_b16 v[136:137], v185 offset:10304
    v_mfma_f32_16x16x32_bf16 v[108:111], v[152:155], v[140:143], v[108:111]
    ds_read_b64_tr_b16 v[138:139], v185 offset:11584
    v_mfma_f32_16x16x32_bf16 v[112:115], v[156:159], v[140:143], v[112:115]
    s_waitcnt lgkmcnt(9)
    v_mfma_f32_16x16x32_bf16 v[116:119], v[148:151], v[144:147], v[116:119]
    ds_read_b64_tr_b16 v[140:141], v186 offset:10336
    v_and_b32 v6, 7, v0
    v_mfma_f32_16x16x32_bf16 v[120:123], v[152:155], v[144:147], v[120:123]
    s_add_u32 m0, s47, 2048
    ds_read_b64_tr_b16 v[142:143], v186 offset:11616
    v_add_u32 v249, 1, v6
    v_mfma_f32_16x16x32_bf16 v[124:127], v[156:159], v[144:147], v[124:127]
    s_waitcnt lgkmcnt(4)
    buffer_load_dwordx4 v174, s[12:15], s44 offen lds
    v_lshrrev_b32 v249, 3, v249
    v_mfma_f32_16x16x32_bf16 v[8:11], v[160:163], v[128:131], v[8:11]
    ds_read_b64_tr_b16 v[144:145], v185 offset:10368
    v_mad_u32_u24 v249, v249, 12, 8
    v_mfma_f32_16x16x32_bf16 v[12:15], v[164:167], v[128:131], v[12:15]
    s_add_u32 m0, s46, 15360
    ds_read_b64_tr_b16 v[146:147], v185 offset:11648
    s_lshl_b32 s71, s36, 10
    v_mfma_f32_16x16x32_bf16 v[16:19], v[168:171], v[128:131], v[16:19]
    buffer_load_dwordx4 v180, s[8:11], s43 offen lds
    s_add_u32 s71, s71, 294912
    v_mfma_f32_16x16x32_bf16 v[20:23], v[160:163], v[132:135], v[20:23]
    ds_read_b64_tr_b16 v[128:129], v186 offset:10400
    v_lshl_add_u32 v6, v6, 7, s71
    v_mfma_f32_16x16x32_bf16 v[24:27], v[164:167], v[132:135], v[24:27]
    ds_read_b64_tr_b16 v[130:131], v186 offset:11680
    v_mfma_f32_16x16x32_bf16 v[28:31], v[168:171], v[132:135], v[28:31]
    s_waitcnt lgkmcnt(6)
    v_mfma_f32_16x16x32_bf16 v[32:35], v[160:163], v[136:139], v[32:35]
    ds_read_b64_tr_b16 v[132:133], v185 offset:10432
    v_mfma_f32_16x16x32_bf16 v[36:39], v[164:167], v[136:139], v[36:39]
    s_add_u32 m0, s47, 3072
    ds_read_b64_tr_b16 v[134:135], v185 offset:11712
    v_mfma_f32_16x16x32_bf16 v[40:43], v[168:171], v[136:139], v[40:43]
    s_waitcnt lgkmcnt(6)
    buffer_load_dwordx4 v175, s[12:15], s44 offen lds
    v_mfma_f32_16x16x32_bf16 v[44:47], v[160:163], v[140:143], v[44:47]
    ds_read_b64_tr_b16 v[136:137], v186 offset:10464
    v_mfma_f32_16x16x32_bf16 v[48:51], v[164:167], v[140:143], v[48:51]
    ds_read_b64_tr_b16 v[138:139], v186 offset:11744
    v_mfma_f32_16x16x32_bf16 v[52:55], v[168:171], v[140:143], v[52:55]
    s_waitcnt lgkmcnt(6)
    v_mfma_f32_16x16x32_bf16 v[56:59], v[160:163], v[144:147], v[56:59]
    ds_read_b64_tr_b16 v[140:141], v185 offset:10496
    v_mfma_f32_16x16x32_bf16 v[60:63], v[164:167], v[144:147], v[60:63]
    s_add_u32 m0, s46, 16384
    ds_read_b64_tr_b16 v[142:143], v185 offset:11776
    v_mfma_f32_16x16x32_bf16 v[64:67], v[168:171], v[144:147], v[64:67]
    s_waitcnt lgkmcnt(6)
    buffer_load_dwordx4 v181, s[8:11], s43 offen lds
    v_mfma_f32_16x16x32_bf16 v[68:71], v[160:163], v[128:131], v[68:71]
    ds_read_b64_tr_b16 v[144:145], v186 offset:10528
    v_mfma_f32_16x16x32_bf16 v[72:75], v[164:167], v[128:131], v[72:75]
    ds_read_b64_tr_b16 v[146:147], v186 offset:11808
    v_mfma_f32_16x16x32_bf16 v[76:79], v[168:171], v[128:131], v[76:79]
    s_waitcnt vmcnt(9) lgkmcnt(6)
    s_barrier
    v_mfma_f32_16x16x32_bf16 v[80:83], v[160:163], v[132:135], v[80:83]
    ds_read_b64_tr_b16 v[128:129], v185 offset:20480
    v_mfma_f32_16x16x32_bf16 v[84:87], v[164:167], v[132:135], v[84:87]
    s_add_u32 m0, s47, 4096
    ds_read_b64_tr_b16 v[130:131], v185 offset:21760
    ds_read_b128 v[148:151], v187 offset:6144
    v_mfma_f32_16x16x32_bf16 v[88:91], v[168:171], v[132:135], v[88:91]
    s_waitcnt lgkmcnt(7)
    buffer_load_dwordx4 v176, s[12:15], s44 offen lds
    v_mfma_f32_16x16x32_bf16 v[92:95], v[160:163], v[136:139], v[92:95]
    ds_read_b64_tr_b16 v[132:133], v186 offset:20512
    ds_read_b128 v[152:155], v187 offset:8192
    buffer_load_dword v5, v6, s[16:19], 0 offen sc1
    v_mfma_f32_16x16x32_bf16 v[96:99], v[164:167], v[136:139], v[96:99]
    s_add_u32 s44, s44, s45
    ds_read_b64_tr_b16 v[134:135], v186 offset:21792
    v_mfma_f32_16x16x32_bf16 v[100:103], v[168:171], v[136:139], v[100:103]
    s_waitcnt lgkmcnt(8)
    ds_read_b128 v[156:159], v242
    v_mfma_f32_16x16x32_bf16 v[104:107], v[160:163], v[140:143], v[104:107]
    ds_read_b64_tr_b16 v[136:137], v185 offset:20544
    v_mfma_f32_16x16x32_bf16 v[108:111], v[164:167], v[140:143], v[108:111]
    s_add_u32 m0, s46, 17408
    ds_read_b64_tr_b16 v[138:139], v185 offset:21824
    v_mfma_f32_16x16x32_bf16 v[112:115], v[168:171], v[140:143], v[112:115]
    s_waitcnt lgkmcnt(9)
    buffer_load_dwordx4 v182, s[8:11], s43 offen lds
    v_mfma_f32_16x16x32_bf16 v[116:119], v[160:163], v[144:147], v[116:119]
    ds_read_b64_tr_b16 v[140:141], v186 offset:20576
    v_mfma_f32_16x16x32_bf16 v[120:123], v[164:167], v[144:147], v[120:123]
    s_add_u32 s43, s43, 128
    ds_read_b64_tr_b16 v[142:143], v186 offset:21856
    v_mfma_f32_16x16x32_bf16 v[124:127], v[168:171], v[144:147], v[124:127]
    s_waitcnt lgkmcnt(4)
    v_mfma_f32_16x16x32_bf16 v[8:11], v[148:151], v[128:131], v[8:11]
    ds_read_b64_tr_b16 v[144:145], v185 offset:20608
    v_mfma_f32_16x16x32_bf16 v[12:15], v[152:155], v[128:131], v[12:15]
    s_add_u32 m0, s46, 0
    ds_read_b64_tr_b16 v[146:147], v185 offset:21888
    v_mfma_f32_16x16x32_bf16 v[16:19], v[156:159], v[128:131], v[16:19]
    buffer_load_dwordx4 v177, s[8:11], s43 offen lds
    v_mfma_f32_16x16x32_bf16 v[20:23], v[148:151], v[132:135], v[20:23]
    ds_read_b64_tr_b16 v[128:129], v186 offset:20640
    v_mfma_f32_16x16x32_bf16 v[24:27], v[152:155], v[132:135], v[24:27]
    s_add_u32 m0, s47, 20480
    ds_read_b64_tr_b16 v[130:131], v186 offset:21920
    v_mfma_f32_16x16x32_bf16 v[28:31], v[156:159], v[132:135], v[28:31]
    s_waitcnt lgkmcnt(6)
    buffer_load_dwordx4 v172, s[12:15], s44 offen lds
    v_mfma_f32_16x16x32_bf16 v[32:35], v[148:151], v[136:139], v[32:35]
    ds_read_b64_tr_b16 v[132:133], v185 offset:20672
    v_mfma_f32_16x16x32_bf16 v[36:39], v[152:155], v[136:139], v[36:39]
    ds_read_b64_tr_b16 v[134:135], v185 offset:21952
    v_mfma_f32_16x16x32_bf16 v[40:43], v[156:159], v[136:139], v[40:43]
    s_waitcnt lgkmcnt(6)
    v_mfma_f32_16x16x32_bf16 v[44:47], v[148:151], v[140:143], v[44:47]
    ds_read_b64_tr_b16 v[136:137], v186 offset:20704
    v_mfma_f32_16x16x32_bf16 v[48:51], v[152:155], v[140:143], v[48:51]
    s_add_u32 m0, s46, 1024
    ds_read_b64_tr_b16 v[138:139], v186 offset:21984
    v_mfma_f32_16x16x32_bf16 v[52:55], v[156:159], v[140:143], v[52:55]
    s_waitcnt lgkmcnt(6)
    buffer_load_dwordx4 v178, s[8:11], s43 offen lds
    v_mfma_f32_16x16x32_bf16 v[56:59], v[148:151], v[144:147], v[56:59]
    ds_read_b64_tr_b16 v[140:141], v185 offset:20736
    v_mfma_f32_16x16x32_bf16 v[60:63], v[152:155], v[144:147], v[60:63]
    ds_read_b64_tr_b16 v[142:143], v185 offset:22016
    v_mfma_f32_16x16x32_bf16 v[64:67], v[156:159], v[144:147], v[64:67]
    s_waitcnt lgkmcnt(6)
    v_mfma_f32_16x16x32_bf16 v[68:71], v[148:151], v[128:131], v[68:71]
    ds_read_b64_tr_b16 v[144:145], v186 offset:20768
    v_mfma_f32_16x16x32_bf16 v[72:75], v[152:155], v[128:131], v[72:75]
    s_add_u32 m0, s47, 21504
    ds_read_b64_tr_b16 v[146:147], v186 offset:22048
    v_mfma_f32_16x16x32_bf16 v[76:79], v[156:159], v[128:131], v[76:79]
    s_waitcnt lgkmcnt(6)
    buffer_load_dwordx4 v173, s[12:15], s44 offen lds
    v_mfma_f32_16x16x32_bf16 v[80:83], v[148:151], v[132:135], v[80:83]
    ds_read_b64_tr_b16 v[128:129], v185 offset:30720
    v_mfma_f32_16x16x32_bf16 v[84:87], v[152:155], v[132:135], v[84:87]
    ds_read_b64_tr_b16 v[130:131], v185 offset:32000
    ds_read_b128 v[160:163], v188 offset:6144
    v_mfma_f32_16x16x32_bf16 v[88:91], v[156:159], v[132:135], v[88:91]
    s_waitcnt lgkmcnt(7)
    v_mfma_f32_16x16x32_bf16 v[92:95], v[148:151], v[136:139], v[92:95]
    ds_read_b64_tr_b16 v[132:133], v186 offset:30752
    ds_read_b128 v[164:167], v188 offset:8192
    v_mfma_f32_16x16x32_bf16 v[96:99], v[152:155], v[136:139], v[96:99]
    s_add_u32 m0, s46, 2048
    ds_read_b64_tr_b16 v[134:135], v186 offset:32032
    v_mfma_f32_16x16x32_bf16 v[100:103], v[156:159], v[136:139], v[100:103]
    s_waitcnt lgkmcnt(8)
    ds_read_b128 v[168:171], v243
    buffer_load_dwordx4 v179, s[8:11], s43 offen lds
    v_mfma_f32_16x16x32_bf16 v[104:107], v[148:151], v[140:143], v[104:107]
    ds_read_b64_tr_b16 v[136:137], v185 offset:30784
    v_mfma_f32_16x16x32_bf16 v[108:111], v[152:155], v[140:143], v[108:111]
    ds_read_b64_tr_b16 v[138:139], v185 offset:32064
    v_mfma_f32_16x16x32_bf16 v[112:115], v[156:159], v[140:143], v[112:115]
    s_waitcnt lgkmcnt(9)
    v_mfma_f32_16x16x32_bf16 v[116:119], v[148:151], v[144:147], v[116:119]
    ds_read_b64_tr_b16 v[140:141], v186 offset:30816
    v_mfma_f32_16x16x32_bf16 v[120:123], v[152:155], v[144:147], v[120:123]
    s_add_u32 m0, s47, 22528
    ds_read_b64_tr_b16 v[142:143], v186 offset:32096
    v_mfma_f32_16x16x32_bf16 v[124:127], v[156:159], v[144:147], v[124:127]
    s_waitcnt lgkmcnt(4)
    buffer_load_dwordx4 v174, s[12:15], s44 offen lds
    v_mfma_f32_16x16x32_bf16 v[8:11], v[160:163], v[128:131], v[8:11]
    ds_read_b64_tr_b16 v[144:145], v185 offset:30848
    v_mfma_f32_16x16x32_bf16 v[12:15], v[164:167], v[128:131], v[12:15]
    s_add_u32 m0, s46, 3072
    ds_read_b64_tr_b16 v[146:147], v185 offset:32128
    v_mfma_f32_16x16x32_bf16 v[16:19], v[168:171], v[128:131], v[16:19]
    buffer_load_dwordx4 v180, s[8:11], s43 offen lds
    v_mfma_f32_16x16x32_bf16 v[20:23], v[160:163], v[132:135], v[20:23]
    ds_read_b64_tr_b16 v[128:129], v186 offset:30880
    v_mfma_f32_16x16x32_bf16 v[24:27], v[164:167], v[132:135], v[24:27]
    ds_read_b64_tr_b16 v[130:131], v186 offset:32160
    v_mfma_f32_16x16x32_bf16 v[28:31], v[168:171], v[132:135], v[28:31]
    s_waitcnt lgkmcnt(6)
    v_mfma_f32_16x16x32_bf16 v[32:35], v[160:163], v[136:139], v[32:35]
    ds_read_b64_tr_b16 v[132:133], v185 offset:30912
    v_mfma_f32_16x16x32_bf16 v[36:39], v[164:167], v[136:139], v[36:39]
    s_add_u32 m0, s47, 23552
    ds_read_b64_tr_b16 v[134:135], v185 offset:32192
    v_mfma_f32_16x16x32_bf16 v[40:43], v[168:171], v[136:139], v[40:43]
    s_waitcnt lgkmcnt(6)
    buffer_load_dwordx4 v175, s[12:15], s44 offen lds
    v_mfma_f32_16x16x32_bf16 v[44:47], v[160:163], v[140:143], v[44:47]
    ds_read_b64_tr_b16 v[136:137], v186 offset:30944
    v_mfma_f32_16x16x32_bf16 v[48:51], v[164:167], v[140:143], v[48:51]
    ds_read_b64_tr_b16 v[138:139], v186 offset:32224
    v_mfma_f32_16x16x32_bf16 v[52:55], v[168:171], v[140:143], v[52:55]
    s_waitcnt lgkmcnt(6)
    v_mfma_f32_16x16x32_bf16 v[56:59], v[160:163], v[144:147], v[56:59]
    ds_read_b64_tr_b16 v[140:141], v185 offset:30976
    v_mfma_f32_16x16x32_bf16 v[60:63], v[164:167], v[144:147], v[60:63]
    s_add_u32 m0, s46, 4096
    ds_read_b64_tr_b16 v[142:143], v185 offset:32256
    v_mfma_f32_16x16x32_bf16 v[64:67], v[168:171], v[144:147], v[64:67]
    s_waitcnt lgkmcnt(6)
    buffer_load_dwordx4 v181, s[8:11], s43 offen lds
    v_mfma_f32_16x16x32_bf16 v[68:71], v[160:163], v[128:131], v[68:71]
    ds_read_b64_tr_b16 v[144:145], v186 offset:31008
    s_waitcnt vmcnt(10)
    v_and_b32 v7, 0xff, v5
    v_cmp_ne_u32 vcc, v249, v7
    s_cbranch_vccz L_chk_kv_ok
    s_mov_b32 s56, 0
L_chk_kv_again:
    s_sleep 8
    buffer_load_dword v5, v6, s[16:19], 0 offen sc1
    s_waitcnt vmcnt(0)
    v_and_b32 v7, 0xff, v5
    v_cmp_ne_u32 vcc, v249, v7
    s_add_u32 s56, s56, 1
    s_cmp_gt_u32 s56, 65536
    s_cbranch_scc1 L_chk_kv_ok
    s_cbranch_vccnz L_chk_kv_again
L_chk_kv_ok:
    v_mfma_f32_16x16x32_bf16 v[72:75], v[164:167], v[128:131], v[72:75]
    ds_read_b64_tr_b16 v[146:147], v186 offset:32288
    v_readlane_b32 s50, v5, 7
    v_mfma_f32_16x16x32_bf16 v[76:79], v[168:171], v[128:131], v[76:79]
    s_waitcnt vmcnt(9) lgkmcnt(6)
    s_barrier
    v_mfma_f32_16x16x32_bf16 v[80:83], v[160:163], v[132:135], v[80:83]
    ds_read_b64_tr_b16 v[128:129], v183 offset:0
    s_getreg_b32 s51, hwreg(HW_REG_XCC_ID, 2, 1)
    v_mfma_f32_16x16x32_bf16 v[84:87], v[164:167], v[132:135], v[84:87]
    s_add_u32 m0, s47, 24576
    ds_read_b64_tr_b16 v[130:131], v183 offset:1280
    ds_read_b128 v[148:151], v187 offset:12288
    v_mfma_f32_16x16x32_bf16 v[88:91], v[168:171], v[132:135], v[88:91]
    s_waitcnt lgkmcnt(7)
    buffer_load_dwordx4 v176, s[12:15], s44 offen lds
    s_bfe_u32 s52, s50, 0x80008
    v_mfma_f32_16x16x32_bf16 v[92:95], v[160:163], v[136:139], v[92:95]
    ds_read_b64_tr_b16 v[132:133], v184 offset:32
    ds_read_b128 v[152:155], v187 offset:14336
    s_cmp_gt_u32 s52, 6
    s_cselect_b32 s64, 0xf0, 0x0f
    v_mfma_f32_16x16x32_bf16 v[96:99], v[164:167], v[136:139], v[96:99]
    s_add_u32 s44, s44, s45
    ds_read_b64_tr_b16 v[134:135], v184 offset:1312
    v_mfma_f32_16x16x32_bf16 v[100:103], v[168:171], v[136:139], v[100:103]
    s_waitcnt lgkmcnt(8)
    ds_read_b128 v[156:159], v244
    v_mfma_f32_16x16x32_bf16 v[104:107], v[160:163], v[140:143], v[104:107]
    ds_read_b64_tr_b16 v[136:137], v183 offset:64
    s_cmp_gt_u32 s50, 458751
    s_cselect_b32 s52, 1, 0
    v_mfma_f32_16x16x32_bf16 v[108:111], v[164:167], v[140:143], v[108:111]
    s_add_u32 m0, s46, 5120
    ds_read_b64_tr_b16 v[138:139], v183 offset:1344
    s_xor_b32 s52, s52, s51
    v_mfma_f32_16x16x32_bf16 v[112:115], v[168:171], v[140:143], v[112:115]
    s_waitcnt lgkmcnt(9)
    buffer_load_dwordx4 v182, s[8:11], s43 offen lds
    s_and_b32 s50, s2, 7
    v_mfma_f32_16x16x32_bf16 v[116:119], v[160:163], v[144:147], v[116:119]
    ds_read_b64_tr_b16 v[140:141], v184 offset:96
    s_lshr_b32 s50, s64, s50
    v_mfma_f32_16x16x32_bf16 v[120:123], v[164:167], v[144:147], v[120:123]
L_st13:
    s_cbranch_execz L_iwback
    s_add_u32 s43, s43, 128
    ds_read_b64_tr_b16 v[142:143], v184 offset:1376
    s_and_b32 s50, s50, 1
    v_mfma_f32_16x16x32_bf16 v[124:127], v[168:171], v[144:147], v[124:127]
    s_waitcnt lgkmcnt(4)
    s_lshl_b32 s61, s50, 13
    s_lshl_b32 s52, s52, 13
    v_mfma_f32_16x16x32_bf16 v[8:11], v[148:151], v[128:131], v[8:11]
    ds_read_b64_tr_b16 v[144:145], v183 offset:128
    s_add_u32 s57, s57, s52
    v_mfma_f32_16x16x32_bf16 v[12:15], v[152:155], v[128:131], v[12:15]
    ds_read_b64_tr_b16 v[146:147], v183 offset:1408
    s_add_u32 s65, s65, s52
    v_mfma_f32_16x16x32_bf16 v[16:19], v[156:159], v[128:131], v[16:19]
    buffer_load_dwordx4 v[192:195], v250, s[20:23], 0 offen sc1
    v_mfma_f32_16x16x32_bf16 v[20:23], v[148:151], v[132:135], v[20:23]
    ds_read_b64_tr_b16 v[128:129], v184 offset:160
    buffer_load_dwordx4 v[196:199], v250, s[20:23], 0 offen offset:64 sc1
    v_mfma_f32_16x16x32_bf16 v[24:27], v[152:155], v[132:135], v[24:27]
    ds_read_b64_tr_b16 v[130:131], v184 offset:1440
    buffer_load_dwordx4 v[200:203], v251, s[20:23], 0 offen sc1
    v_mfma_f32_16x16x32_bf16 v[28:31], v[156:159], v[132:135], v[28:31]
    s_waitcnt lgkmcnt(6)
    buffer_load_dwordx4 v[204:207], v251, s[20:23], 0 offen offset:64 sc1
    v_mfma_f32_16x16x32_bf16 v[32:35], v[148:151], v[136:139], v[32:35]
    ds_read_b64_tr_b16 v[132:133], v183 offset:192
    buffer_load_dwordx4 v[208:211], v252, s[20:23], 0 offen sc1
    v_mfma_f32_16x16x32_bf16 v[36:39], v[152:155], v[136:139], v[36:39]
    ds_read_b64_tr_b16 v[134:135], v183 offset:1472
    buffer_load_dwordx4 v[212:215], v252, s[20:23], 0 offen offset:64 sc1
    v_mfma_f32_16x16x32_bf16 v[40:43], v[156:159], v[136:139], v[40:43]
    s_waitcnt lgkmcnt(6)
    v_lshlrev_b32 v6, 2, v0
    v_add_u32 v6, 156672, v6
    v_mfma_f32_16x16x32_bf16 v[44:47], v[148:151], v[140:143], v[44:47]
    ds_read_b64_tr_b16 v[136:137], v184 offset:224
    s_add_u32 s58, s57, 0
    v_mfma_f32_16x16x32_bf16 v[48:51], v[152:155], v[140:143], v[48:51]
    s_mov_b32 s5, 1
    ds_read_b64_tr_b16 v[138:139], v184 offset:1504
    buffer_load_dwordx4 a[0:3], v3, s[16:19], s58 offen offset:0 sc1
    v_mfma_f32_16x16x32_bf16 v[52:55], v[156:159], v[140:143], v[52:55]
    s_waitcnt lgkmcnt(6)
    v_lshlrev_b32 v7, 2, v1
    v_add_u32 v7, 155648, v7
    v_mfma_f32_16x16x32_bf16 v[56:59], v[148:151], v[144:147], v[56:59]
    ds_read_b64_tr_b16 v[140:141], v183 offset:256
    s_cmp_eq_u32 s36, 3
    s_cselect_b32 vcc_hi, 0xffff0000, 0
    s_mov_b32 vcc_lo, 0
    v_mfma_f32_16x16x32_bf16 v[60:63], v[152:155], v[144:147], v[60:63]
    s_and_b32 s3, s39, 7
    ds_read_b64_tr_b16 v[142:143], v183 offset:1536
    v_cndmask_b32 v6, v6, v7, vcc
    v_mfma_f32_16x16x32_bf16 v[64:67], v[156:159], v[144:147], v[64:67]
    s_waitcnt lgkmcnt(6)
    buffer_load_dwordx4 a[4:7], v3, s[16:19], s58 offen offset:1024 sc1
    v_mov_b32 v5, 0x3f803f80
    v_mfma_f32_16x16x32_bf16 v[68:71], v[148:151], v[128:131], v[68:71]
    s_lshl2_add_u32 s4, s3, s36
    ds_read_b64_tr_b16 v[144:145], v184 offset:288
    v_cmp_gt_u32 vcc, 2048, v189
    v_mfma_f32_16x16x32_bf16 v[72:75], v[152:155], v[128:131], v[72:75]
    s_lshl_b32 s4, s4, 7
    ds_read_b64_tr_b16 v[146:147], v184 offset:1568
    v_cndmask_b32 v250, 0, v5, vcc
    v_mfma_f32_16x16x32_bf16 v[76:79], v[156:159], v[128:131], v[76:79]
    s_waitcnt lgkmcnt(6)
    v_mov_b32 v251, v250
    v_cmp_gt_u32 vcc, 2048, v190
    v_mfma_f32_16x16x32_bf16 v[80:83], v[148:151], v[132:135], v[80:83]
    s_add_u32 s4, s4, 98304
    ds_read_b64_tr_b16 v[128:129], v183 offset:10240
    buffer_load_dwordx4 a[8:11], v3, s[16:19], s58 offen offset:2048 sc1
    v_mfma_f32_16x16x32_bf16 v[84:87], v[152:155], v[132:135], v[84:87]
    s_lshl_b32 s50, s36, 1
    ds_read_b64_tr_b16 v[130:131], v183 offset:11520
    ds_read_b128 v[160:163], v188 offset:12288
    v_mfma_f32_16x16x32_bf16 v[88:91], v[156:159], v[132:135], v[88:91]
    s_waitcnt lgkmcnt(7)
    v_cndmask_b32 v252, 0, v5, vcc
    v_mov_b32 v253, v252
    v_mfma_f32_16x16x32_bf16 v[92:95], v[148:151], v[136:139], v[92:95]
    s_lshr_b32 s3, s64, s50
    ds_read_b64_tr_b16 v[132:133], v184 offset:10272
    ds_read_b128 v[164:167], v188 offset:14336
    v_mfma_f32_16x16x32_bf16 v[96:99], v[152:155], v[136:139], v[96:99]
    s_and_b32 s3, s3, 1
    ds_read_b64_tr_b16 v[134:135], v184 offset:11552
    buffer_load_dwordx4 a[12:15], v3, s[16:19], s58 offen offset:3072 sc1
    v_mfma_f32_16x16x32_bf16 v[100:103], v[156:159], v[136:139], v[100:103]
    s_waitcnt lgkmcnt(8)
    ds_read_b128 v[168:171], v245
    v_cmp_gt_u32 vcc, 2048, v191
    v_mfma_f32_16x16x32_bf16 v[104:107], v[148:151], v[140:143], v[104:107]
    s_lshl_b32 s3, s3, 13
    ds_read_b64_tr_b16 v[136:137], v183 offset:10304
    v_cndmask_b32 v254, 0, v5, vcc
    v_mfma_f32_16x16x32_bf16 v[108:111], v[152:155], v[140:143], v[108:111]
    s_add_u32 s4, s4, s3
    ds_read_b64_tr_b16 v[138:139], v183 offset:11584
    v_mov_b32 v255, v254
    v_mfma_f32_16x16x32_bf16 v[112:115], v[156:159], v[140:143], v[112:115]
    s_waitcnt lgkmcnt(9)
    buffer_load_dwordx4 a[16:19], v4, s[16:19], s58 offen offset:0 sc1
    s_and_b32 s3, s36, 1
    v_mfma_f32_16x16x32_bf16 v[116:119], v[148:151], v[144:147], v[116:119]
    s_lshl_b32 s3, s3, 2
    ds_read_b64_tr_b16 v[140:141], v184 offset:10336
    s_xor_b32 s50, s48, s3
    v_mfma_f32_16x16x32_bf16 v[120:123], v[152:155], v[144:147], v[120:123]
    s_mul_i32 s3, s50, 22336
    ds_read_b64_tr_b16 v[142:143], v184 offset:11616
    s_lshr_b32 s51, s3, 16
    v_mfma_f32_16x16x32_bf16 v[124:127], v[156:159], v[144:147], v[124:127]
    s_waitcnt lgkmcnt(4)
    s_add_u32 s58, s57, 65536
    s_add_u32 s3, s3, 21987
    v_mfma_f32_16x16x32_bf16 v[8:11], v[160:163], v[128:131], v[8:11]
    s_lshr_b32 s3, s3, 16
    ds_read_b64_tr_b16 v[144:145], v183 offset:10368
    buffer_load_dwordx4 a[20:23], v3, s[16:19], s58 offen offset:0 sc1
    v_mfma_f32_16x16x32_bf16 v[12:15], v[164:167], v[128:131], v[12:15]
    s_sub_u32 s51, s3, s51
    ds_read_b64_tr_b16 v[146:147], v183 offset:11648
    s_lshr_b32 s3, s48, 3
    v_mfma_f32_16x16x32_bf16 v[16:19], v[168:171], v[128:131], v[16:19]
    s_lshl2_add_u32 s3, s49, s3
    s_add_u32 s3, s3, 128
    v_mfma_f32_16x16x32_bf16 v[20:23], v[160:163], v[132:135], v[20:23]
    ds_read_b64_tr_b16 v[128:129], v184 offset:10400
    s_cmp_eq_u32 s36, 3
    s_cselect_b32 s50, s3, s50
    s_cselect_b32 s51, 0, s51
    v_mfma_f32_16x16x32_bf16 v[24:27], v[164:167], v[132:135], v[24:27]
    ds_read_b64_tr_b16 v[130:131], v184 offset:11680
    buffer_load_dwordx4 a[24:27], v3, s[16:19], s58 offen offset:1024 sc1
    v_mfma_f32_16x16x32_bf16 v[28:31], v[168:171], v[132:135], v[28:31]
    s_waitcnt lgkmcnt(6)
    s_cmp_eq_u32 s36, 2
    s_cselect_b32 s7, 4, 11
    v_mfma_f32_16x16x32_bf16 v[32:35], v[160:163], v[136:139], v[32:35]
    ds_read_b64_tr_b16 v[132:133], v183 offset:10432
    s_cmp_lt_u32 s36, 2
    s_cselect_b32 s0, -1, 0
    s_cselect_b32 s3, 0, 128
    v_mfma_f32_16x16x32_bf16 v[36:39], v[164:167], v[136:139], v[36:39]
    s_lshl_b32 s7, s7, s51
    ds_read_b64_tr_b16 v[134:135], v183 offset:11712
    s_add_u32 s50, s50, s3
    v_mfma_f32_16x16x32_bf16 v[40:43], v[168:171], v[136:139], v[40:43]
    s_waitcnt lgkmcnt(6)
    buffer_load_dwordx4 a[28:31], v3, s[16:19], s58 offen offset:2048 sc1
    s_lshl_b32 s6, s50, 7
    v_mfma_f32_16x16x32_bf16 v[44:47], v[160:163], v[140:143], v[44:47]
    s_add_u32 s6, s6, s61
    ds_read_b64_tr_b16 v[136:137], v184 offset:10464
    s_add_u32 s6, s6, 65536
    v_mfma_f32_16x16x32_bf16 v[48:51], v[164:167], v[140:143], v[48:51]
    s_mov_b32 s1, s61
    ds_read_b64_tr_b16 v[138:139], v184 offset:11744
    s_lshr_b32 s3, s48, 1
    v_mfma_f32_16x16x32_bf16 v[52:55], v[168:171], v[140:143], v[52:55]
    s_waitcnt lgkmcnt(6)
    s_lshl_b32 s3, s3, 22
    s_add_u32 s61, s61, s3
    v_mfma_f32_16x16x32_bf16 v[56:59], v[160:163], v[144:147], v[56:59]
    s_and_b32 s3, s48, 1
    ds_read_b64_tr_b16 v[140:141], v183 offset:10496
    buffer_load_dwordx4 a[32:35], v3, s[16:19], s58 offen offset:3072 sc1
    v_mfma_f32_16x16x32_bf16 v[60:63], v[164:167], v[144:147], v[60:63]
    s_lshl_b32 s3, s3, 20
    ds_read_b64_tr_b16 v[142:143], v183 offset:11776
    s_add_u32 s61, s61, s3
    v_mfma_f32_16x16x32_bf16 v[64:67], v[168:171], v[144:147], v[64:67]
    s_waitcnt lgkmcnt(6)
    s_and_b32 s3, s48, 15
    s_lshl_b32 s3, s3, 14
    v_mfma_f32_16x16x32_bf16 v[68:71], v[160:163], v[128:131], v[68:71]
    s_add_u32 s61, s61, s3
    ds_read_b64_tr_b16 v[144:145], v184 offset:10528
    s_xor_b32 s20, s61, 0x810000
    v_mfma_f32_16x16x32_bf16 v[72:75], v[164:167], v[128:131], v[72:75]
    s_add_u32 s61, s61, 37748736
    ds_read_b64_tr_b16 v[146:147], v184 offset:11808
    buffer_load_dwordx4 a[36:39], v4, s[16:19], s58 offen offset:0 sc1
    v_mfma_f32_16x16x32_bf16 v[76:79], v[168:171], v[128:131], v[76:79]
    s_waitcnt vmcnt(16) lgkmcnt(6)
    s_barrier
    v_mfma_f32_16x16x32_bf16 v[80:83], v[160:163], v[132:135], v[80:83]
    s_add_u32 s20, s20, 37748736
    ds_read_b64_tr_b16 v[128:129], v183 offset:20480
    s_and_b32 s3, s40, 1
    v_mfma_f32_16x16x32_bf16 v[84:87], v[164:167], v[132:135], v[84:87]
    ds_read_b64_tr_b16 v[130:131], v183 offset:21760
    ds_read_b128 v[148:151], v187 offset:0
    s_add_u32 s58, s57, 131072
    v_mfma_f32_16x16x32_bf16 v[88:91], v[168:171], v[132:135], v[88:91]
    s_waitcnt lgkmcnt(7)
    buffer_load_dwordx4 a[40:43], v3, s[16:19], s58 offen offset:0 sc1
    s_lshl_b32 s3, s3, 12
    v_mfma_f32_16x16x32_bf16 v[92:95], v[160:163], v[136:139], v[92:95]
    s_lshl_b32 s50, s40, 13
    ds_read_b64_tr_b16 v[132:133], v184 offset:20512
    ds_read_b128 v[152:155], v187 offset:2048
    v_mfma_f32_16x16x32_bf16 v[96:99], v[164:167], v[136:139], v[96:99]
    s_sub_u32 s50, s50, s3
    ds_read_b64_tr_b16 v[134:135], v184 offset:21792
    s_add_u32 s20, s20, s50
    v_mfma_f32_16x16x32_bf16 v[100:103], v[168:171], v[136:139], v[100:103]
    s_waitcnt lgkmcnt(8)
    ds_read_b128 v[156:159], v240
    s_add_u32 s21, s61, s50
    v_mfma_f32_16x16x32_bf16 v[104:107], v[160:163], v[140:143], v[104:107]
    s_add_u32 s3, s36, 1
    ds_read_b64_tr_b16 v[136:137], v183 offset:20544
    buffer_load_dwordx4 a[44:47], v3, s[16:19], s58 offen offset:1024 sc1
    v_mfma_f32_16x16x32_bf16 v[108:111], v[164:167], v[140:143], v[108:111]
    s_and_b32 s3, s3, 3
    ds_read_b64_tr_b16 v[138:139], v183 offset:21824
    s_lshl_b32 s12, s3, 10
    v_mfma_f32_16x16x32_bf16 v[112:115], v[168:171], v[140:143], v[112:115]
    s_waitcnt lgkmcnt(9)
    s_add_u32 s3, s36, 2
    s_and_b32 s3, s3, 3
    v_mfma_f32_16x16x32_bf16 v[116:119], v[160:163], v[144:147], v[116:119]
    s_lshl_b32 s13, s3, 10
    ds_read_b64_tr_b16 v[140:141], v184 offset:20576
    s_add_u32 s3, s36, 3
    v_mfma_f32_16x16x32_bf16 v[120:123], v[164:167], v[144:147], v[120:123]
    s_and_b32 s3, s3, 3
    ds_read_b64_tr_b16 v[142:143], v184 offset:21856
    buffer_load_dwordx4 a[48:51], v3, s[16:19], s58 offen offset:2048 sc1
    v_mfma_f32_16x16x32_bf16 v[124:127], v[168:171], v[144:147], v[124:127]
    s_waitcnt lgkmcnt(4)
    s_lshl_b32 s14, s3, 10
    s_add_u32 s3, s36, 4
    v_mfma_f32_16x16x32_bf16 v[8:11], v[148:151], v[128:131], v[8:11]
    s_and_b32 s3, s3, 3
    ds_read_b64_tr_b16 v[144:145], v183 offset:20608
    s_lshl_b32 s15, s3, 10
    v_mfma_f32_16x16x32_bf16 v[12:15], v[152:155], v[128:131], v[12:15]
    ds_read_b64_tr_b16 v[146:147], v183 offset:21888
    v_mfma_f32_16x16x32_bf16 v[16:19], v[156:159], v[128:131], v[16:19]
    buffer_load_dwordx4 a[52:55], v3, s[16:19], s58 offen offset:3072 sc1
    v_mfma_f32_16x16x32_bf16 v[20:23], v[148:151], v[132:135], v[20:23]
    ds_read_b64_tr_b16 v[128:129], v184 offset:20640
    v_mfma_f32_16x16x32_bf16 v[24:27], v[152:155], v[132:135], v[24:27]
    ds_read_b64_tr_b16 v[130:131], v184 offset:21920
    v_mfma_f32_16x16x32_bf16 v[28:31], v[156:159], v[132:135], v[28:31]
    s_waitcnt lgkmcnt(6)
    s_waitcnt vmcnt(14)
    v_mov_b32 v216, v192
    v_mfma_f32_16x16x32_bf16 v[32:35], v[148:151], v[136:139], v[32:35]
    ds_read_b64_tr_b16 v[132:133], v183 offset:20672
    buffer_load_dwordx4 a[56:59], v4, s[16:19], s58 offen offset:0 sc1
    v_mfma_f32_16x16x32_bf16 v[36:39], v[152:155], v[136:139], v[36:39]
    ds_read_b64_tr_b16 v[134:135], v183 offset:21952
    v_mul_f32 v228, 0x3fb8aa3b, v193
    v_mfma_f32_16x16x32_bf16 v[40:43], v[156:159], v[136:139], v[40:43]
    s_waitcnt lgkmcnt(6)
    v_mov_b32 v217, v194
    v_mul_f32 v229, 0x3fb8aa3b, v195
    v_mfma_f32_16x16x32_bf16 v[44:47], v[148:151], v[140:143], v[44:47]
    ds_read_b64_tr_b16 v[136:137], v184 offset:20704
    s_add_u32 s58, s57, 196608
    v_mfma_f32_16x16x32_bf16 v[48:51], v[152:155], v[140:143], v[48:51]
    ds_read_b64_tr_b16 v[138:139], v184 offset:21984
    buffer_load_dwordx4 a[60:63], v3, s[16:19], s58 offen offset:0 sc1
    v_mfma_f32_16x16x32_bf16 v[52:55], v[156:159], v[140:143], v[52:55]
    s_waitcnt lgkmcnt(6)
    v_mov_b32 v218, v196
    v_mul_f32 v230, 0x3fb8aa3b, v197
    v_mfma_f32_16x16x32_bf16 v[56:59], v[148:151], v[144:147], v[56:59]
    ds_read_b64_tr_b16 v[140:141], v183 offset:20736
    v_mov_b32 v219, v198
    v_mfma_f32_16x16x32_bf16 v[60:63], v[152:155], v[144:147], v[60:63]
    ds_read_b64_tr_b16 v[142:143], v183 offset:22016
    v_mul_f32 v231, 0x3fb8aa3b, v199
    v_mfma_f32_16x16x32_bf16 v[64:67], v[156:159], v[144:147], v[64:67]
    s_waitcnt lgkmcnt(6)
    buffer_load_dwordx4 a[64:67], v3, s[16:19], s58 offen offset:1024 sc1
    v_mov_b32 v220, v200
    v_mfma_f32_16x16x32_bf16 v[68:71], v[148:151], v[128:131], v[68:71]
    ds_read_b64_tr_b16 v[144:145], v184 offset:20768
    v_mul_f32 v232, 0x3fb8aa3b, v201
    v_mfma_f32_16x16x32_bf16 v[72:75], v[152:155], v[128:131], v[72:75]
    ds_read_b64_tr_b16 v[146:147], v184 offset:22048
    v_mov_b32 v221, v202
    v_mfma_f32_16x16x32_bf16 v[76:79], v[156:159], v[128:131], v[76:79]
    s_waitcnt lgkmcnt(6)
    v_mul_f32 v233, 0x3fb8aa3b, v203
    v_mov_b32 v222, v204
    v_mfma_f32_16x16x32_bf16 v[80:83], v[148:151], v[132:135], v[80:83]
    ds_read_b64_tr_b16 v[128:129], v183 offset:30720
    buffer_load_dwordx4 a[68:71], v3, s[16:19], s58 offen offset:2048 sc1
    v_mfma_f32_16x16x32_bf16 v[84:87], v[152:155], v[132:135], v[84:87]
    ds_read_b64_tr_b16 v[130:131], v183 offset:32000
    ds_read_b128 v[160:163], v188 offset:0
    v_mfma_f32_16x16x32_bf16 v[88:91], v[156:159], v[132:135], v[88:91]
    s_waitcnt lgkmcnt(7)
    v_mul_f32 v234, 0x3fb8aa3b, v205
    v_mov_b32 v223, v206
    v_mfma_f32_16x16x32_bf16 v[92:95], v[148:151], v[136:139], v[92:95]
    ds_read_b64_tr_b16 v[132:133], v184 offset:30752
    ds_read_b128 v[164:167], v188 offset:2048
    v_mfma_f32_16x16x32_bf16 v[96:99], v[152:155], v[136:139], v[96:99]
    ds_read_b64_tr_b16 v[134:135], v184 offset:32032
    buffer_load_dwordx4 a[72:75], v3, s[16:19], s58 offen offset:3072 sc1
    v_mfma_f32_16x16x32_bf16 v[100:103], v[156:159], v[136:139], v[100:103]
    s_waitcnt lgkmcnt(8)
    ds_read_b128 v[168:171], v241
    v_mul_f32 v235, 0x3fb8aa3b, v207
    v_mfma_f32_16x16x32_bf16 v[104:107], v[148:151], v[140:143], v[104:107]
    ds_read_b64_tr_b16 v[136:137], v183 offset:30784
    v_mov_b32 v224, v208
    v_mfma_f32_16x16x32_bf16 v[108:111], v[152:155], v[140:143], v[108:111]
    ds_read_b64_tr_b16 v[138:139], v183 offset:32064
    v_mul_f32 v236, 0x3fb8aa3b, v209
    v_mfma_f32_16x16x32_bf16 v[112:115], v[156:159], v[140:143], v[112:115]
    s_waitcnt lgkmcnt(9)
    buffer_load_dwordx4 a[76:79], v4, s[16:19], s58 offen offset:0 sc1
    v_mov_b32 v225, v210
    v_mfma_f32_16x16x32_bf16 v[116:119], v[148:151], v[144:147], v[116:119]
    ds_read_b64_tr_b16 v[140:141], v184 offset:30816
    v_mul_f32 v237, 0x3fb8aa3b, v211
    v_mfma_f32_16x16x32_bf16 v[120:123], v[152:155], v[144:147], v[120:123]
    ds_read_b64_tr_b16 v[142:143], v184 offset:32096
    v_mov_b32 v226, v212
    v_mfma_f32_16x16x32_bf16 v[124:127], v[156:159], v[144:147], v[124:127]
    s_waitcnt lgkmcnt(4)
    s_add_u32 s58, s57, 262144
    v_mul_f32 v238, 0x3fb8aa3b, v213
    v_mfma_f32_16x16x32_bf16 v[8:11], v[160:163], v[128:131], v[8:11]
    ds_read_b64_tr_b16 v[144:145], v183 offset:30848
    buffer_load_dwordx4 a[80:83], v3, s[16:19], s58 offen offset:0 sc1
    v_mfma_f32_16x16x32_bf16 v[12:15], v[164:167], v[128:131], v[12:15]
    ds_read_b64_tr_b16 v[146:147], v183 offset:32128
    v_mov_b32 v227, v214
    v_mfma_f32_16x16x32_bf16 v[16:19], v[168:171], v[128:131], v[16:19]
    v_mul_f32 v239, 0x3fb8aa3b, v215
    v_mfma_f32_16x16x32_bf16 v[20:23], v[160:163], v[132:135], v[20:23]
    ds_read_b64_tr_b16 v[128:129], v184 offset:30880
    v_mfma_f32_16x16x32_bf16 v[24:27], v[164:167], v[132:135], v[24:27]
    ds_read_b64_tr_b16 v[130:131], v184 offset:32160
    buffer_load_dwordx4 a[84:87], v3, s[16:19], s58 offen offset:1024 sc1
    v_mfma_f32_16x16x32_bf16 v[28:31], v[168:171], v[132:135], v[28:31]
    s_waitcnt lgkmcnt(6)
    v_mfma_f32_16x16x32_bf16 v[32:35], v[160:163], v[136:139], v[32:35]
    ds_read_b64_tr_b16 v[132:133], v183 offset:30912
    ds_write_b32 v6, v19 offset:0
    v_mfma_f32_16x16x32_bf16 v[36:39], v[164:167], v[136:139], v[36:39]
    ds_read_b64_tr_b16 v[134:135], v183 offset:32192
    v_mfma_f32_16x16x32_bf16 v[40:43], v[168:171], v[136:139], v[40:43]
    s_waitcnt lgkmcnt(7)
    v_mfma_f32_16x16x32_bf16 v[44:47], v[160:163], v[140:143], v[44:47]
    ds_read_b64_tr_b16 v[136:137], v184 offset:30944
    ds_write_b32 v6, v31 offset:64
    v_mfma_f32_16x16x32_bf16 v[48:51], v[164:167], v[140:143], v[48:51]
    ds_read_b64_tr_b16 v[138:139], v184 offset:32224
    v_mfma_f32_16x16x32_bf16 v[52:55], v[168:171], v[140:143], v[52:55]
    s_waitcnt lgkmcnt(8)
    v_mfma_f32_16x16x32_bf16 v[56:59], v[160:163], v[144:147], v[56:59]
    ds_read_b64_tr_b16 v[140:141], v183 offset:30976
    ds_write_b32 v6, v43 offset:128
    v_mfma_f32_16x16x32_bf16 v[60:63], v[164:167], v[144:147], v[60:63]
    ds_read_b64_tr_b16 v[142:143], v183 offset:32256
    v_mfma_f32_16x16x32_bf16 v[64:67], v[168:171], v[144:147], v[64:67]
    s_waitcnt lgkmcnt(9)
    v_mfma_f32_16x16x32_bf16 v[68:71], v[160:163], v[128:131], v[68:71]
    ds_read_b64_tr_b16 v[144:145], v184 offset:31008
    ds_write_b32 v6, v55 offset:192
    v_mfma_f32_16x16x32_bf16 v[72:75], v[164:167], v[128:131], v[72:75]
    ds_read_b64_tr_b16 v[146:147], v184 offset:32288
    v_mfma_f32_16x16x32_bf16 v[76:79], v[168:171], v[128:131], v[76:79]
    s_waitcnt lgkmcnt(9)
    v_mfma_f32_16x16x32_bf16 v[80:83], v[160:163], v[132:135], v[80:83]
    ds_write_b32 v6, v67 offset:256
    v_mfma_f32_16x16x32_bf16 v[84:87], v[164:167], v[132:135], v[84:87]
    v_mfma_f32_16x16x32_bf16 v[88:91], v[168:171], v[132:135], v[88:91]
    s_waitcnt lgkmcnt(7)
    v_mfma_f32_16x16x32_bf16 v[92:95], v[160:163], v[136:139], v[92:95]
    s_nop 0
    ds_write_b32 v6, v79 offset:320
    v_mfma_f32_16x16x32_bf16 v[96:99], v[164:167], v[136:139], v[96:99]
    v_mfma_f32_16x16x32_bf16 v[100:103], v[168:171], v[136:139], v[100:103]
    s_waitcnt lgkmcnt(5)
    s_waitcnt lgkmcnt(3)
    s_barrier
    v_mfma_f32_16x16x32_bf16 v[104:107], v[160:163], v[140:143], v[104:107]
    ds_read_b32 v240, v7 offset:0
    ds_write_b32 v6, v91 offset:384
    v_mfma_f32_16x16x32_bf16 v[108:111], v[164:167], v[140:143], v[108:111]
    ds_read_b32 v241, v7 offset:64
    v_mfma_f32_16x16x32_bf16 v[112:115], v[168:171], v[140:143], v[112:115]
    s_waitcnt lgkmcnt(5)
    ds_read_b32 v242, v7 offset:128
    v_mfma_f32_16x16x32_bf16 v[116:119], v[160:163], v[144:147], v[116:119]
    ds_read_b32 v243, v7 offset:192
    ds_write_b32 v6, v103 offset:448
    v_mfma_f32_16x16x32_bf16 v[120:123], v[164:167], v[144:147], v[120:123]
    v_mfma_f32_16x16x32_bf16 v[124:127], v[168:171], v[144:147], v[124:127]
    s_nop 0
    ds_write_b32 v6, v115 offset:512
    s_nop 5
    ds_write_b32 v6, v127 offset:576
    s_waitcnt lgkmcnt(7)
    v_pk_fma_f32 v[192:193], v[216:217], v[240:241], v[8:9] op_sel:[0,0,0] op_sel_hi:[1,0,1] neg_lo:[1,0,0] neg_hi:[1,0,0]
    v_pk_fma_f32 v[194:195], v[218:219], v[240:241], v[10:11] op_sel:[0,0,0] op_sel_hi:[1,0,1] neg_lo:[1,0,0] neg_hi:[1,0,0]
    v_pk_fma_f32 v[196:197], v[220:221], v[240:241], v[12:13] op_sel:[0,0,0] op_sel_hi:[1,0,1] neg_lo:[1,0,0] neg_hi:[1,0,0]
    v_pk_fma_f32 v[198:199], v[222:223], v[240:241], v[14:15] op_sel:[0,0,0] op_sel_hi:[1,0,1] neg_lo:[1,0,0] neg_hi:[1,0,0]
    v_pk_fma_f32 v[200:201], v[224:225], v[240:241], v[16:17] op_sel:[0,0,0] op_sel_hi:[1,0,1] neg_lo:[1,0,0] neg_hi:[1,0,0]
    v_pk_fma_f32 v[202:203], v[226:227], v[240:241], v[18:19] op_sel:[0,0,0] op_sel_hi:[1,0,1] neg_lo:[1,0,0] neg_hi:[1,0,0]
    v_pk_mul_f32 v[192:193], v[192:193], v[228:229]
    v_pk_mul_f32 v[194:195], v[194:195], v[230:231]
    v_pk_mul_f32 v[196:197], v[196:197], v[232:233]
    v_pk_mul_f32 v[198:199], v[198:199], v[234:235]
    v_pk_mul_f32 v[200:201], v[200:201], v[236:237]
    v_pk_mul_f32 v[202:203], v[202:203], v[238:239]
    s_waitcnt lgkmcnt(0)
    s_barrier
    ds_read_b32 v244, v7 offset:256
    ds_read_b32 v245, v7 offset:320
    ds_read_b32 v246, v7 offset:384
    ds_read_b32 v247, v7 offset:448
    ds_read_b32 v248, v7 offset:512
    ds_read_b32 v249, v7 offset:576
    buffer_load_dwordx4 a[88:91], v3, s[16:19], s58 offen offset:2048 sc1
    v_exp_f32 v204, v192 clamp
    v_exp_f32 v205, v193 clamp
    v_exp_f32 v206, v194 clamp
    v_exp_f32 v207, v195 clamp
    v_exp_f32 v208, v196 clamp
    v_exp_f32 v209, v197 clamp
    v_exp_f32 v210, v198 clamp
    v_exp_f32 v211, v199 clamp
    v_exp_f32 v212, v200 clamp
    v_exp_f32 v213, v201 clamp
    v_exp_f32 v214, v202 clamp
    v_exp_f32 v215, v203 clamp
    buffer_load_dwordx4 a[92:95], v3, s[16:19], s58 offen offset:3072 sc1
    v_pk_fma_f32 v[192:193], v[192:193], s[62:63], 1.0 op_sel_hi:[1,0,0]
    v_pk_fma_f32 v[194:195], v[194:195], s[62:63], 1.0 op_sel_hi:[1,0,0]
    v_pk_fma_f32 v[196:197], v[196:197], s[62:63], 1.0 op_sel_hi:[1,0,0]
    v_pk_fma_f32 v[198:199], v[198:199], s[62:63], 1.0 op_sel_hi:[1,0,0]
    v_pk_fma_f32 v[200:201], v[200:201], s[62:63], 1.0 op_sel_hi:[1,0,0]
    v_pk_fma_f32 v[202:203], v[202:203], s[62:63], 1.0 op_sel_hi:[1,0,0]
    v_max_f32 v192, v192, v204
    v_max_f32 v193, v193, v205
    v_max_f32 v194, v194, v206
    v_max_f32 v195, v195, v207
    v_max_f32 v196, v196, v208
    v_max_f32 v197, v197, v209
    v_max_f32 v198, v198, v210
    v_max_f32 v199, v199, v211
    v_max_f32 v200, v200, v212
    v_max_f32 v201, v201, v213
    v_max_f32 v202, v202, v214
    v_max_f32 v203, v203, v215
    buffer_load_dwordx4 a[96:99], v4, s[16:19], s58 offen offset:0 sc1
    v_pk_add_f32 v[192:193], v[192:193], s[62:63] op_sel:[0,1] op_sel_hi:[1,1]
    v_pk_add_f32 v[194:195], v[194:195], s[62:63] op_sel:[0,1] op_sel_hi:[1,1]
    v_pk_add_f32 v[196:197], v[196:197], s[62:63] op_sel:[0,1] op_sel_hi:[1,1]
    v_pk_add_f32 v[198:199], v[198:199], s[62:63] op_sel:[0,1] op_sel_hi:[1,1]
    v_pk_add_f32 v[200:201], v[200:201], s[62:63] op_sel:[0,1] op_sel_hi:[1,1]
    v_pk_add_f32 v[202:203], v[202:203], s[62:63] op_sel:[0,1] op_sel_hi:[1,1]
    v_cvt_pk_bf16_f32 v128, v192, v193
    v_cvt_pk_bf16_f32 v129, v194, v195
    v_cvt_pk_bf16_f32 v130, v196, v197
    v_cvt_pk_bf16_f32 v131, v198, v199
    v_cvt_pk_bf16_f32 v132, v200, v201
    v_cvt_pk_bf16_f32 v133, v202, v203
    s_add_u32 s52, s42, 28928
    v_mul_u32_u24 v5, 80, v1
    v_lshl_add_u32 v5, v2, 4, v5
    v_add_u32 v8, s52, v5
    v_add_u32 v9, 1280, v8
    v_subrev_u32 v5, 80, v9
    v_cmp_le_u32 vcc, 4, v1
    s_nop 1
    v_cndmask_b32 v9, v9, v5, vcc
    v_add_u32 v10, 2480, v8
    v_subrev_u32 v5, 80, v10
    v_cmp_le_u32 vcc, 8, v1
    s_nop 1
    v_cndmask_b32 v10, v10, v5, vcc
    v_add_u32 v11, 3680, v8
    v_subrev_u32 v5, 80, v11
    v_cmp_le_u32 vcc, 12, v1
    s_nop 1
    v_cndmask_b32 v11, v11, v5, vcc
    v_add_u32 v12, 4880, v8
    v_lshl_add_u32 v13, v1, 2, s52
    s_lshl_b32 s3, s36, 8
    v_lshl_add_u32 v14, v0, 2, s3
    v_add_u32 v15, 28928, v14
    v_add_u32 v16, 100608, v14
    v_or_b32 v17, 0x40000000, v14
    v_cmp_lt_u32 vcc, 572, v14
    s_mul_i32 s50, s39, 7168
    s_add_u32 s50, s50, 163840
    v_cndmask_b32 v17, v14, v17, vcc
    s_add_u32 s51, s50, 4096
    s_waitcnt lgkmcnt(4)
    v_pk_fma_f32 v[192:193], v[216:217], v[244:245], v[68:69] op_sel:[0,1,0] op_sel_hi:[1,1,1] neg_lo:[1,0,0] neg_hi:[1,0,0]
    v_pk_fma_f32 v[194:195], v[218:219], v[244:245], v[70:71] op_sel:[0,1,0] op_sel_hi:[1,1,1] neg_lo:[1,0,0] neg_hi:[1,0,0]
    v_pk_fma_f32 v[196:197], v[220:221], v[244:245], v[72:73] op_sel:[0,1,0] op_sel_hi:[1,1,1] neg_lo:[1,0,0] neg_hi:[1,0,0]
    v_pk_fma_f32 v[198:199], v[222:223], v[244:245], v[74:75] op_sel:[0,1,0] op_sel_hi:[1,1,1] neg_lo:[1,0,0] neg_hi:[1,0,0]
    v_pk_fma_f32 v[200:201], v[224:225], v[244:245], v[76:77] op_sel:[0,1,0] op_sel_hi:[1,1,1] neg_lo:[1,0,0] neg_hi:[1,0,0]
    v_pk_fma_f32 v[202:203], v[226:227], v[244:245], v[78:79] op_sel:[0,1,0] op_sel_hi:[1,1,1] neg_lo:[1,0,0] neg_hi:[1,0,0]
    v_pk_mul_f32 v[192:193], v[192:193], v[228:229]
    v_pk_mul_f32 v[194:195], v[194:195], v[230:231]
    v_pk_mul_f32 v[196:197], v[196:197], v[232:233]
    v_pk_mul_f32 v[198:199], v[198:199], v[234:235]
    v_pk_mul_f32 v[200:201], v[200:201], v[236:237]
    v_pk_mul_f32 v[202:203], v[202:203], v[238:239]
    v_cvt_pk_bf16_f32 v158, v192, v193
    v_cvt_pk_bf16_f32 v159, v194, v195
    v_cvt_pk_bf16_f32 v160, v196, v197
    v_cvt_pk_bf16_f32 v161, v198, v199
    v_cvt_pk_bf16_f32 v162, v200, v201
    v_cvt_pk_bf16_f32 v163, v202, v203
    s_add_u32 s58, s57, 327680
    buffer_load_dwordx4 a[100:103], v3, s[16:19], s58 offen offset:0 sc1
    s_waitcnt lgkmcnt(3)
    v_pk_fma_f32 v[192:193], v[216:217], v[246:247], v[80:81] op_sel:[0,0,0] op_sel_hi:[1,0,1] neg_lo:[1,0,0] neg_hi:[1,0,0]
    v_pk_fma_f32 v[194:195], v[218:219], v[246:247], v[82:83] op_sel:[0,0,0] op_sel_hi:[1,0,1] neg_lo:[1,0,0] neg_hi:[1,0,0]
    v_pk_fma_f32 v[196:197], v[220:221], v[246:247], v[84:85] op_sel:[0,0,0] op_sel_hi:[1,0,1] neg_lo:[1,0,0] neg_hi:[1,0,0]
    v_pk_fma_f32 v[198:199], v[222:223], v[246:247], v[86:87] op_sel:[0,0,0] op_sel_hi:[1,0,1] neg_lo:[1,0,0] neg_hi:[1,0,0]
    v_pk_fma_f32 v[200:201], v[224:225], v[246:247], v[88:89] op_sel:[0,0,0] op_sel_hi:[1,0,1] neg_lo:[1,0,0] neg_hi:[1,0,0]
    v_pk_fma_f32 v[202:203], v[226:227], v[246:247], v[90:91] op_sel:[0,0,0] op_sel_hi:[1,0,1] neg_lo:[1,0,0] neg_hi:[1,0,0]
    v_pk_mul_f32 v[192:193], v[192:193], v[228:229]
    v_pk_mul_f32 v[194:195], v[194:195], v[230:231]
    v_pk_mul_f32 v[196:197], v[196:197], v[232:233]
    v_pk_mul_f32 v[198:199], v[198:199], v[234:235]
    v_pk_mul_f32 v[200:201], v[200:201], v[236:237]
    v_pk_mul_f32 v[202:203], v[202:203], v[238:239]
    v_cvt_pk_bf16_f32 v164, v192, v193
    v_cvt_pk_bf16_f32 v165, v194, v195
    v_cvt_pk_bf16_f32 v166, v196, v197
    v_cvt_pk_bf16_f32 v167, v198, v199
    v_cvt_pk_bf16_f32 v168, v200, v201
    v_cvt_pk_bf16_f32 v169, v202, v203
    buffer_load_dwordx4 a[104:107], v3, s[16:19], s58 offen offset:1024 sc1
    s_waitcnt lgkmcnt(2)
    v_pk_fma_f32 v[192:193], v[216:217], v[246:247], v[92:93] op_sel:[0,1,0] op_sel_hi:[1,1,1] neg_lo:[1,0,0] neg_hi:[1,0,0]
    v_pk_fma_f32 v[194:195], v[218:219], v[246:247], v[94:95] op_sel:[0,1,0] op_sel_hi:[1,1,1] neg_lo:[1,0,0] neg_hi:[1,0,0]
    v_pk_fma_f32 v[196:197], v[220:221], v[246:247], v[96:97] op_sel:[0,1,0] op_sel_hi:[1,1,1] neg_lo:[1,0,0] neg_hi:[1,0,0]
    v_pk_fma_f32 v[198:199], v[222:223], v[246:247], v[98:99] op_sel:[0,1,0] op_sel_hi:[1,1,1] neg_lo:[1,0,0] neg_hi:[1,0,0]
    v_pk_fma_f32 v[200:201], v[224:225], v[246:247], v[100:101] op_sel:[0,1,0] op_sel_hi:[1,1,1] neg_lo:[1,0,0] neg_hi:[1,0,0]
    v_pk_fma_f32 v[202:203], v[226:227], v[246:247], v[102:103] op_sel:[0,1,0] op_sel_hi:[1,1,1] neg_lo:[1,0,0] neg_hi:[1,0,0]
    v_pk_mul_f32 v[192:193], v[192:193], v[228:229]
    v_pk_mul_f32 v[194:195], v[194:195], v[230:231]
    v_pk_mul_f32 v[196:197], v[196:197], v[232:233]
    v_pk_mul_f32 v[198:199], v[198:199], v[234:235]
    v_pk_mul_f32 v[200:201], v[200:201], v[236:237]
    v_pk_mul_f32 v[202:203], v[202:203], v[238:239]
    v_cvt_pk_bf16_f32 v170, v192, v193
    v_cvt_pk_bf16_f32 v171, v194, v195
    v_cvt_pk_bf16_f32 v172, v196, v197
    v_cvt_pk_bf16_f32 v173, v198, v199
    v_cvt_pk_bf16_f32 v174, v200, v201
    v_cvt_pk_bf16_f32 v175, v202, v203
    s_waitcnt lgkmcnt(1)
    v_pk_fma_f32 v[192:193], v[216:217], v[248:249], v[104:105] op_sel:[0,0,0] op_sel_hi:[1,0,1] neg_lo:[1,0,0] neg_hi:[1,0,0]
    v_pk_fma_f32 v[194:195], v[218:219], v[248:249], v[106:107] op_sel:[0,0,0] op_sel_hi:[1,0,1] neg_lo:[1,0,0] neg_hi:[1,0,0]
    v_pk_fma_f32 v[196:197], v[220:221], v[248:249], v[108:109] op_sel:[0,0,0] op_sel_hi:[1,0,1] neg_lo:[1,0,0] neg_hi:[1,0,0]
    v_pk_fma_f32 v[198:199], v[222:223], v[248:249], v[110:111] op_sel:[0,0,0] op_sel_hi:[1,0,1] neg_lo:[1,0,0] neg_hi:[1,0,0]
    v_pk_fma_f32 v[200:201], v[224:225], v[248:249], v[112:113] op_sel:[0,0,0] op_sel_hi:[1,0,1] neg_lo:[1,0,0] neg_hi:[1,0,0]
    v_pk_fma_f32 v[202:203], v[226:227], v[248:249], v[114:115] op_sel:[0,0,0] op_sel_hi:[1,0,1] neg_lo:[1,0,0] neg_hi:[1,0,0]
    v_pk_mul_f32 v[192:193], v[192:193], v[228:229]
    v_pk_mul_f32 v[194:195], v[194:195], v[230:231]
    v_pk_mul_f32 v[196:197], v[196:197], v[232:233]
    v_pk_mul_f32 v[198:199], v[198:199], v[234:235]
    v_pk_mul_f32 v[200:201], v[200:201], v[236:237]
    v_pk_mul_f32 v[202:203], v[202:203], v[238:239]
    v_cvt_pk_bf16_f32 v176, v192, v193
    v_cvt_pk_bf16_f32 v177, v194, v195
    v_cvt_pk_bf16_f32 v178, v196, v197
    v_cvt_pk_bf16_f32 v179, v198, v199
    v_cvt_pk_bf16_f32 v180, v200, v201
    v_cvt_pk_bf16_f32 v181, v202, v203
    buffer_load_dwordx4 a[108:111], v3, s[16:19], s58 offen offset:2048 sc1
    s_waitcnt lgkmcnt(0)
    v_pk_fma_f32 v[192:193], v[216:217], v[248:249], v[116:117] op_sel:[0,1,0] op_sel_hi:[1,1,1] neg_lo:[1,0,0] neg_hi:[1,0,0]
    v_pk_fma_f32 v[194:195], v[218:219], v[248:249], v[118:119] op_sel:[0,1,0] op_sel_hi:[1,1,1] neg_lo:[1,0,0] neg_hi:[1,0,0]
    v_pk_fma_f32 v[196:197], v[220:221], v[248:249], v[120:121] op_sel:[0,1,0] op_sel_hi:[1,1,1] neg_lo:[1,0,0] neg_hi:[1,0,0]
    v_pk_fma_f32 v[198:199], v[222:223], v[248:249], v[122:123] op_sel:[0,1,0] op_sel_hi:[1,1,1] neg_lo:[1,0,0] neg_hi:[1,0,0]
    v_pk_fma_f32 v[200:201], v[224:225], v[248:249], v[124:125] op_sel:[0,1,0] op_sel_hi:[1,1,1] neg_lo:[1,0,0] neg_hi:[1,0,0]
    v_pk_fma_f32 v[202:203], v[226:227], v[248:249], v[126:127] op_sel:[0,1,0] op_sel_hi:[1,1,1] neg_lo:[1,0,0] neg_hi:[1,0,0]
    v_pk_mul_f32 v[192:193], v[192:193], v[228:229]
    v_pk_mul_f32 v[194:195], v[194:195], v[230:231]
    v_pk_mul_f32 v[196:197], v[196:197], v[232:233]
    v_pk_mul_f32 v[198:199], v[198:199], v[234:235]
    v_pk_mul_f32 v[200:201], v[200:201], v[236:237]
    v_pk_mul_f32 v[202:203], v[202:203], v[238:239]
L_st14:
    s_cbranch_execz L_iwback
    v_cvt_pk_bf16_f32 v182, v192, v193
    v_cvt_pk_bf16_f32 v183, v194, v195
    v_cvt_pk_bf16_f32 v184, v196, v197
    v_cvt_pk_bf16_f32 v185, v198, v199
    v_cvt_pk_bf16_f32 v186, v200, v201
    v_cvt_pk_bf16_f32 v187, v202, v203
    buffer_load_dwordx4 a[112:115], v3, s[16:19], s58 offen offset:3072 sc1
    v_pk_fma_f32 v[192:193], v[216:217], v[240:241], v[20:21] op_sel:[0,1,0] op_sel_hi:[1,1,1] neg_lo:[1,0,0] neg_hi:[1,0,0]
    v_pk_fma_f32 v[194:195], v[218:219], v[240:241], v[22:23] op_sel:[0,1,0] op_sel_hi:[1,1,1] neg_lo:[1,0,0] neg_hi:[1,0,0]
    v_pk_fma_f32 v[196:197], v[220:221], v[240:241], v[24:25] op_sel:[0,1,0] op_sel_hi:[1,1,1] neg_lo:[1,0,0] neg_hi:[1,0,0]
    v_pk_fma_f32 v[198:199], v[222:223], v[240:241], v[26:27] op_sel:[0,1,0] op_sel_hi:[1,1,1] neg_lo:[1,0,0] neg_hi:[1,0,0]
    v_pk_fma_f32 v[200:201], v[224:225], v[240:241], v[28:29] op_sel:[0,1,0] op_sel_hi:[1,1,1] neg_lo:[1,0,0] neg_hi:[1,0,0]
    v_pk_fma_f32 v[202:203], v[226:227], v[240:241], v[30:31] op_sel:[0,1,0] op_sel_hi:[1,1,1] neg_lo:[1,0,0] neg_hi:[1,0,0]
    v_pk_mul_f32 v[192:193], v[192:193], v[228:229]
    v_pk_mul_f32 v[194:195], v[194:195], v[230:231]
    v_pk_mul_f32 v[196:197], v[196:197], v[232:233]
    v_pk_mul_f32 v[198:199], v[198:199], v[234:235]
    v_pk_mul_f32 v[200:201], v[200:201], v[236:237]
    v_pk_mul_f32 v[202:203], v[202:203], v[238:239]
    buffer_load_dwordx4 a[116:119], v4, s[16:19], s58 offen offset:0 sc1
    v_mfma_f32_16x16x16_bf16 v[68:71], v[132:133], v[162:163], 0
    v_exp_f32 v204, v192 clamp
    v_mfma_f32_16x16x16_bf16 v[72:75], v[132:133], v[168:169], 0
    v_exp_f32 v205, v193 clamp
    v_mfma_f32_16x16x16_bf16 v[76:79], v[254:255], v[132:133], 0
    v_exp_f32 v206, v194 clamp
    v_mfma_f32_16x16x32_bf16 v[68:71], v[128:131], v[158:161], v[68:71]
    v_exp_f32 v207, v195 clamp
    v_mfma_f32_16x16x32_bf16 v[72:75], v[128:131], v[164:167], v[72:75]
    v_exp_f32 v208, v196 clamp
    v_mfma_f32_16x16x32_bf16 v[76:79], v[250:253], v[128:131], v[76:79]
    v_exp_f32 v209, v197 clamp
    v_exp_f32 v210, v198 clamp
    v_exp_f32 v211, v199 clamp
    v_exp_f32 v212, v200 clamp
    v_exp_f32 v213, v201 clamp
    v_exp_f32 v214, v202 clamp
    v_exp_f32 v215, v203 clamp
    v_pk_fma_f32 v[192:193], v[192:193], s[62:63], 1.0 op_sel_hi:[1,0,0]
    v_pk_fma_f32 v[194:195], v[194:195], s[62:63], 1.0 op_sel_hi:[1,0,0]
    v_pk_fma_f32 v[196:197], v[196:197], s[62:63], 1.0 op_sel_hi:[1,0,0]
    v_pk_fma_f32 v[198:199], v[198:199], s[62:63], 1.0 op_sel_hi:[1,0,0]
    v_pk_fma_f32 v[200:201], v[200:201], s[62:63], 1.0 op_sel_hi:[1,0,0]
    v_pk_fma_f32 v[202:203], v[202:203], s[62:63], 1.0 op_sel_hi:[1,0,0]
    s_mov_b32 exec_lo, 0xffffffff
    s_mov_b32 exec_hi, 0xffffffff
    ds_write_b128 v8, v[68:71] offset:0
    s_mov_b64 exec, -1
    v_max_f32 v192, v192, v204
    v_max_f32 v193, v193, v205
    v_max_f32 v194, v194, v206
    v_max_f32 v195, v195, v207
    v_max_f32 v196, v196, v208
    v_max_f32 v197, v197, v209
    v_max_f32 v198, v198, v210
    v_max_f32 v199, v199, v211
    v_max_f32 v200, v200, v212
    v_max_f32 v201, v201, v213
    v_max_f32 v202, v202, v214
    v_max_f32 v203, v203, v215
    s_mov_b32 exec_lo, 0xf000f
    s_mov_b32 exec_hi, 0xf000f
    ds_write_b128 v9, v[72:75] offset:0
    s_mov_b64 exec, -1
    s_add_u32 s58, s57, 393216
    v_or_b32 v188, s72, v3
    buffer_load_dwordx4 a[120:123], v188, s[16:19], s58 offen offset:0 sc1
    v_pk_add_f32 v[192:193], v[192:193], s[62:63] op_sel:[0,1] op_sel_hi:[1,1]
    v_pk_add_f32 v[194:195], v[194:195], s[62:63] op_sel:[0,1] op_sel_hi:[1,1]
    v_pk_add_f32 v[196:197], v[196:197], s[62:63] op_sel:[0,1] op_sel_hi:[1,1]
    v_pk_add_f32 v[198:199], v[198:199], s[62:63] op_sel:[0,1] op_sel_hi:[1,1]
    v_pk_add_f32 v[200:201], v[200:201], s[62:63] op_sel:[0,1] op_sel_hi:[1,1]
    v_pk_add_f32 v[202:203], v[202:203], s[62:63] op_sel:[0,1] op_sel_hi:[1,1]
    ds_write_b32 v13, v76 offset:6400
    v_cvt_pk_bf16_f32 v134, v192, v193
    v_cvt_pk_bf16_f32 v135, v194, v195
    v_cvt_pk_bf16_f32 v136, v196, v197
    v_cvt_pk_bf16_f32 v137, v198, v199
    v_cvt_pk_bf16_f32 v138, v200, v201
    v_cvt_pk_bf16_f32 v139, v202, v203
    buffer_load_dwordx4 a[124:127], v188, s[16:19], s58 offen offset:1024 sc1
    v_pk_fma_f32 v[192:193], v[216:217], v[242:243], v[32:33] op_sel:[0,0,0] op_sel_hi:[1,0,1] neg_lo:[1,0,0] neg_hi:[1,0,0]
    v_pk_fma_f32 v[194:195], v[218:219], v[242:243], v[34:35] op_sel:[0,0,0] op_sel_hi:[1,0,1] neg_lo:[1,0,0] neg_hi:[1,0,0]
    v_pk_fma_f32 v[196:197], v[220:221], v[242:243], v[36:37] op_sel:[0,0,0] op_sel_hi:[1,0,1] neg_lo:[1,0,0] neg_hi:[1,0,0]
    v_pk_fma_f32 v[198:199], v[222:223], v[242:243], v[38:39] op_sel:[0,0,0] op_sel_hi:[1,0,1] neg_lo:[1,0,0] neg_hi:[1,0,0]
    v_pk_fma_f32 v[200:201], v[224:225], v[242:243], v[40:41] op_sel:[0,0,0] op_sel_hi:[1,0,1] neg_lo:[1,0,0] neg_hi:[1,0,0]
    v_pk_fma_f32 v[202:203], v[226:227], v[242:243], v[42:43] op_sel:[0,0,0] op_sel_hi:[1,0,1] neg_lo:[1,0,0] neg_hi:[1,0,0]
    v_pk_mul_f32 v[192:193], v[192:193], v[228:229]
    v_pk_mul_f32 v[194:195], v[194:195], v[230:231]
    v_pk_mul_f32 v[196:197], v[196:197], v[232:233]
    v_pk_mul_f32 v[198:199], v[198:199], v[234:235]
    v_pk_mul_f32 v[200:201], v[200:201], v[236:237]
    v_pk_mul_f32 v[202:203], v[202:203], v[238:239]
    buffer_load_dwordx4 a[128:131], v188, s[16:19], s58 offen offset:2048 sc1
    v_mfma_f32_16x16x16_bf16 v[84:87], v[138:139], v[162:163], 0
    v_exp_f32 v204, v192 clamp
    v_mfma_f32_16x16x16_bf16 v[88:91], v[138:139], v[168:169], 0
    v_exp_f32 v205, v193 clamp
    v_mfma_f32_16x16x16_bf16 v[92:95], v[138:139], v[174:175], 0
    v_exp_f32 v206, v194 clamp
    v_mfma_f32_16x16x16_bf16 v[96:99], v[254:255], v[138:139], 0
    v_exp_f32 v207, v195 clamp
    v_mfma_f32_16x16x32_bf16 v[84:87], v[134:137], v[158:161], v[84:87]
    v_exp_f32 v208, v196 clamp
    v_mfma_f32_16x16x32_bf16 v[88:91], v[134:137], v[164:167], v[88:91]
    v_exp_f32 v209, v197 clamp
    v_mfma_f32_16x16x32_bf16 v[92:95], v[134:137], v[170:173], v[92:95]
    v_exp_f32 v210, v198 clamp
    v_mfma_f32_16x16x32_bf16 v[96:99], v[250:253], v[134:137], v[96:99]
    v_exp_f32 v211, v199 clamp
    v_exp_f32 v212, v200 clamp
    v_exp_f32 v213, v201 clamp
    v_exp_f32 v214, v202 clamp
    v_exp_f32 v215, v203 clamp
    buffer_load_dwordx4 a[132:135], v188, s[16:19], s58 offen offset:3072 sc1
    v_pk_fma_f32 v[192:193], v[192:193], s[62:63], 1.0 op_sel_hi:[1,0,0]
    v_pk_fma_f32 v[194:195], v[194:195], s[62:63], 1.0 op_sel_hi:[1,0,0]
    v_pk_fma_f32 v[196:197], v[196:197], s[62:63], 1.0 op_sel_hi:[1,0,0]
    v_pk_fma_f32 v[198:199], v[198:199], s[62:63], 1.0 op_sel_hi:[1,0,0]
    v_pk_fma_f32 v[200:201], v[200:201], s[62:63], 1.0 op_sel_hi:[1,0,0]
    v_pk_fma_f32 v[202:203], v[202:203], s[62:63], 1.0 op_sel_hi:[1,0,0]
    s_mov_b32 exec_lo, 0xffff
    s_mov_b32 exec_hi, 0x0
    ds_write_b128 v8, v[84:87] offset:64
    s_mov_b64 exec, -1
    v_max_f32 v192, v192, v204
    v_max_f32 v193, v193, v205
    v_max_f32 v194, v194, v206
    v_max_f32 v195, v195, v207
    v_max_f32 v196, v196, v208
    v_max_f32 v197, v197, v209
    v_max_f32 v198, v198, v210
    v_max_f32 v199, v199, v211
    v_max_f32 v200, v200, v212
    v_max_f32 v201, v201, v213
    v_max_f32 v202, v202, v214
    v_max_f32 v203, v203, v215
    s_mov_b32 exec_lo, 0xfff0000f
    s_mov_b32 exec_hi, 0xfff0fff0
    ds_write_b128 v9, v[88:91] offset:64
    s_mov_b64 exec, -1
    v_or_b32 v188, s72, v4
    buffer_load_dwordx4 a[136:139], v188, s[16:19], s58 offen offset:0 sc1
    v_pk_add_f32 v[192:193], v[192:193], s[62:63] op_sel:[0,1] op_sel_hi:[1,1]
    v_pk_add_f32 v[194:195], v[194:195], s[62:63] op_sel:[0,1] op_sel_hi:[1,1]
    v_pk_add_f32 v[196:197], v[196:197], s[62:63] op_sel:[0,1] op_sel_hi:[1,1]
    v_pk_add_f32 v[198:199], v[198:199], s[62:63] op_sel:[0,1] op_sel_hi:[1,1]
    v_pk_add_f32 v[200:201], v[200:201], s[62:63] op_sel:[0,1] op_sel_hi:[1,1]
    v_pk_add_f32 v[202:203], v[202:203], s[62:63] op_sel:[0,1] op_sel_hi:[1,1]
    ds_write_b32 v13, v96 offset:6464
    v_cvt_pk_bf16_f32 v140, v192, v193
    v_cvt_pk_bf16_f32 v141, v194, v195
    v_cvt_pk_bf16_f32 v142, v196, v197
    v_cvt_pk_bf16_f32 v143, v198, v199
    v_cvt_pk_bf16_f32 v144, v200, v201
    v_cvt_pk_bf16_f32 v145, v202, v203
    s_mov_b32 exec_lo, 0xff0000
    s_mov_b32 exec_hi, 0xff00ff
    ds_write_b128 v10, v[92:95] offset:64
    s_mov_b64 exec, -1
    s_add_u32 s58, s36, 2
    s_and_b32 s58, s58, 2
    s_mul_i32 s58, s58, 1536
    s_add_u32 s58, s58, s65
    s_add_u32 s65, s65, 16384
    buffer_load_dwordx4 a[140:143], v3, s[16:19], s58 offen offset:0 sc1
    v_pk_fma_f32 v[192:193], v[216:217], v[242:243], v[44:45] op_sel:[0,1,0] op_sel_hi:[1,1,1] neg_lo:[1,0,0] neg_hi:[1,0,0]
    v_pk_fma_f32 v[194:195], v[218:219], v[242:243], v[46:47] op_sel:[0,1,0] op_sel_hi:[1,1,1] neg_lo:[1,0,0] neg_hi:[1,0,0]
    v_pk_fma_f32 v[196:197], v[220:221], v[242:243], v[48:49] op_sel:[0,1,0] op_sel_hi:[1,1,1] neg_lo:[1,0,0] neg_hi:[1,0,0]
    v_pk_fma_f32 v[198:199], v[222:223], v[242:243], v[50:51] op_sel:[0,1,0] op_sel_hi:[1,1,1] neg_lo:[1,0,0] neg_hi:[1,0,0]
    v_pk_fma_f32 v[200:201], v[224:225], v[242:243], v[52:53] op_sel:[0,1,0] op_sel_hi:[1,1,1] neg_lo:[1,0,0] neg_hi:[1,0,0]
    v_pk_fma_f32 v[202:203], v[226:227], v[242:243], v[54:55] op_sel:[0,1,0] op_sel_hi:[1,1,1] neg_lo:[1,0,0] neg_hi:[1,0,0]
    v_pk_mul_f32 v[192:193], v[192:193], v[228:229]
    v_pk_mul_f32 v[194:195], v[194:195], v[230:231]
    v_pk_mul_f32 v[196:197], v[196:197], v[232:233]
    v_pk_mul_f32 v[198:199], v[198:199], v[234:235]
    v_pk_mul_f32 v[200:201], v[200:201], v[236:237]
    v_pk_mul_f32 v[202:203], v[202:203], v[238:239]
    v_mfma_f32_16x16x16_bf16 v[100:103], v[144:145], v[168:169], 0
    v_exp_f32 v204, v192 clamp
    v_mfma_f32_16x16x16_bf16 v[104:107], v[144:145], v[174:175], 0
    v_exp_f32 v205, v193 clamp
    v_mfma_f32_16x16x16_bf16 v[108:111], v[144:145], v[180:181], 0
    v_exp_f32 v206, v194 clamp
    v_mfma_f32_16x16x16_bf16 v[112:115], v[254:255], v[144:145], 0
    v_exp_f32 v207, v195 clamp
    v_mfma_f32_16x16x32_bf16 v[100:103], v[140:143], v[164:167], v[100:103]
    v_exp_f32 v208, v196 clamp
    v_mfma_f32_16x16x32_bf16 v[104:107], v[140:143], v[170:173], v[104:107]
    v_exp_f32 v209, v197 clamp
    v_mfma_f32_16x16x32_bf16 v[108:111], v[140:143], v[176:179], v[108:111]
    v_exp_f32 v210, v198 clamp
    v_mfma_f32_16x16x32_bf16 v[112:115], v[250:253], v[140:143], v[112:115]
    v_exp_f32 v211, v199 clamp
    v_exp_f32 v212, v200 clamp
    v_exp_f32 v213, v201 clamp
    v_exp_f32 v214, v202 clamp
    v_exp_f32 v215, v203 clamp
    buffer_load_dwordx4 a[144:147], v3, s[16:19], s58 offen offset:1024 sc1
    v_pk_fma_f32 v[192:193], v[192:193], s[62:63], 1.0 op_sel_hi:[1,0,0]
    v_pk_fma_f32 v[194:195], v[194:195], s[62:63], 1.0 op_sel_hi:[1,0,0]
    v_pk_fma_f32 v[196:197], v[196:197], s[62:63], 1.0 op_sel_hi:[1,0,0]
    v_pk_fma_f32 v[198:199], v[198:199], s[62:63], 1.0 op_sel_hi:[1,0,0]
    v_pk_fma_f32 v[200:201], v[200:201], s[62:63], 1.0 op_sel_hi:[1,0,0]
    v_pk_fma_f32 v[202:203], v[202:203], s[62:63], 1.0 op_sel_hi:[1,0,0]
    s_mov_b32 exec_lo, 0xfff0fff0
    s_mov_b32 exec_hi, 0x0
    ds_write_b128 v9, v[100:103] offset:128
    s_mov_b64 exec, -1
    v_max_f32 v192, v192, v204
    v_max_f32 v193, v193, v205
    v_max_f32 v194, v194, v206
    v_max_f32 v195, v195, v207
    v_max_f32 v196, v196, v208
    v_max_f32 v197, v197, v209
    v_max_f32 v198, v198, v210
    v_max_f32 v199, v199, v211
    v_max_f32 v200, v200, v212
    v_max_f32 v201, v201, v213
    v_max_f32 v202, v202, v214
    v_max_f32 v203, v203, v215
    s_mov_b32 exec_lo, 0xff00ff
    s_mov_b32 exec_hi, 0xff00ff00
    ds_write_b128 v10, v[104:107] offset:128
    s_mov_b64 exec, -1
    buffer_load_dwordx4 a[148:151], v3, s[16:19], s58 offen offset:2048 sc1
    v_pk_add_f32 v[192:193], v[192:193], s[62:63] op_sel:[0,1] op_sel_hi:[1,1]
    v_pk_add_f32 v[194:195], v[194:195], s[62:63] op_sel:[0,1] op_sel_hi:[1,1]
    v_pk_add_f32 v[196:197], v[196:197], s[62:63] op_sel:[0,1] op_sel_hi:[1,1]
    v_pk_add_f32 v[198:199], v[198:199], s[62:63] op_sel:[0,1] op_sel_hi:[1,1]
    v_pk_add_f32 v[200:201], v[200:201], s[62:63] op_sel:[0,1] op_sel_hi:[1,1]
    v_pk_add_f32 v[202:203], v[202:203], s[62:63] op_sel:[0,1] op_sel_hi:[1,1]
    ds_write_b32 v13, v112 offset:6528
    v_cvt_pk_bf16_f32 v146, v192, v193
    v_cvt_pk_bf16_f32 v147, v194, v195
    v_cvt_pk_bf16_f32 v148, v196, v197
    v_cvt_pk_bf16_f32 v149, v198, v199
    v_cvt_pk_bf16_f32 v150, v200, v201
    v_cvt_pk_bf16_f32 v151, v202, v203
    s_mov_b32 exec_lo, 0x0
    s_mov_b32 exec_hi, 0xfff0fff
    ds_write_b128 v11, v[108:111] offset:128
    s_mov_b64 exec, -1
    buffer_load_dwordx4 a[152:155], v3, s[16:19], s58 offen offset:3072 sc1
    v_pk_fma_f32 v[192:193], v[216:217], v[244:245], v[56:57] op_sel:[0,0,0] op_sel_hi:[1,0,1] neg_lo:[1,0,0] neg_hi:[1,0,0]
    v_pk_fma_f32 v[194:195], v[218:219], v[244:245], v[58:59] op_sel:[0,0,0] op_sel_hi:[1,0,1] neg_lo:[1,0,0] neg_hi:[1,0,0]
    v_pk_fma_f32 v[196:197], v[220:221], v[244:245], v[60:61] op_sel:[0,0,0] op_sel_hi:[1,0,1] neg_lo:[1,0,0] neg_hi:[1,0,0]
    v_pk_fma_f32 v[198:199], v[222:223], v[244:245], v[62:63] op_sel:[0,0,0] op_sel_hi:[1,0,1] neg_lo:[1,0,0] neg_hi:[1,0,0]
    v_pk_fma_f32 v[200:201], v[224:225], v[244:245], v[64:65] op_sel:[0,0,0] op_sel_hi:[1,0,1] neg_lo:[1,0,0] neg_hi:[1,0,0]
    v_pk_fma_f32 v[202:203], v[226:227], v[244:245], v[66:67] op_sel:[0,0,0] op_sel_hi:[1,0,1] neg_lo:[1,0,0] neg_hi:[1,0,0]
    v_pk_mul_f32 v[192:193], v[192:193], v[228:229]
    v_pk_mul_f32 v[194:195], v[194:195], v[230:231]
    v_pk_mul_f32 v[196:197], v[196:197], v[232:233]
    v_pk_mul_f32 v[198:199], v[198:199], v[234:235]
    v_pk_mul_f32 v[200:201], v[200:201], v[236:237]
    v_pk_mul_f32 v[202:203], v[202:203], v[238:239]
    buffer_load_dwordx4 a[156:159], v4, s[16:19], s58 offen offset:0 sc1
    v_mfma_f32_16x16x16_bf16 v[68:71], v[150:151], v[174:175], 0
    v_exp_f32 v204, v192 clamp
    v_mfma_f32_16x16x16_bf16 v[72:75], v[150:151], v[180:181], 0
    v_exp_f32 v205, v193 clamp
    v_mfma_f32_16x16x16_bf16 v[76:79], v[150:151], v[186:187], 0
    v_exp_f32 v206, v194 clamp
    v_mfma_f32_16x16x16_bf16 v[80:83], v[254:255], v[150:151], 0
    v_exp_f32 v207, v195 clamp
    v_mfma_f32_16x16x32_bf16 v[68:71], v[146:149], v[170:173], v[68:71]
    v_exp_f32 v208, v196 clamp
    v_mfma_f32_16x16x32_bf16 v[72:75], v[146:149], v[176:179], v[72:75]
    v_exp_f32 v209, v197 clamp
    v_mfma_f32_16x16x32_bf16 v[76:79], v[146:149], v[182:185], v[76:79]
    v_exp_f32 v210, v198 clamp
    v_mfma_f32_16x16x32_bf16 v[80:83], v[250:253], v[146:149], v[80:83]
    v_exp_f32 v211, v199 clamp
    v_exp_f32 v212, v200 clamp
    v_exp_f32 v213, v201 clamp
    v_exp_f32 v214, v202 clamp
    v_exp_f32 v215, v203 clamp
    s_add_u32 s58, s36, 3
    s_and_b32 s58, s58, 2
    s_mul_i32 s58, s58, 1536
    s_add_u32 s58, s58, s65
    s_add_u32 s65, s65, 16384
    buffer_load_dwordx4 a[160:163], v3, s[16:19], s58 offen offset:0 sc1
    v_pk_fma_f32 v[192:193], v[192:193], s[62:63], 1.0 op_sel_hi:[1,0,0]
    v_pk_fma_f32 v[194:195], v[194:195], s[62:63], 1.0 op_sel_hi:[1,0,0]
    v_pk_fma_f32 v[196:197], v[196:197], s[62:63], 1.0 op_sel_hi:[1,0,0]
    v_pk_fma_f32 v[198:199], v[198:199], s[62:63], 1.0 op_sel_hi:[1,0,0]
    v_pk_fma_f32 v[200:201], v[200:201], s[62:63], 1.0 op_sel_hi:[1,0,0]
    v_pk_fma_f32 v[202:203], v[202:203], s[62:63], 1.0 op_sel_hi:[1,0,0]
    s_mov_b32 exec_lo, 0xff00ff00
    s_mov_b32 exec_hi, 0xff00
    ds_write_b128 v10, v[68:71] offset:192
    s_mov_b64 exec, -1
    v_max_f32 v192, v192, v204
    v_max_f32 v193, v193, v205
    v_max_f32 v194, v194, v206
    v_max_f32 v195, v195, v207
    v_max_f32 v196, v196, v208
    v_max_f32 v197, v197, v209
    v_max_f32 v198, v198, v210
    v_max_f32 v199, v199, v211
    v_max_f32 v200, v200, v212
    v_max_f32 v201, v201, v213
    v_max_f32 v202, v202, v214
    v_max_f32 v203, v203, v215
    s_mov_b32 exec_lo, 0xfff0fff
    s_mov_b32 exec_hi, 0xf0000fff
    ds_write_b128 v11, v[72:75] offset:192
    s_mov_b64 exec, -1
    buffer_load_dwordx4 a[164:167], v3, s[16:19], s58 offen offset:1024 sc1
    v_pk_add_f32 v[192:193], v[192:193], s[62:63] op_sel:[0,1] op_sel_hi:[1,1]
    v_pk_add_f32 v[194:195], v[194:195], s[62:63] op_sel:[0,1] op_sel_hi:[1,1]
    v_pk_add_f32 v[196:197], v[196:197], s[62:63] op_sel:[0,1] op_sel_hi:[1,1]
    v_pk_add_f32 v[198:199], v[198:199], s[62:63] op_sel:[0,1] op_sel_hi:[1,1]
    v_pk_add_f32 v[200:201], v[200:201], s[62:63] op_sel:[0,1] op_sel_hi:[1,1]
    v_pk_add_f32 v[202:203], v[202:203], s[62:63] op_sel:[0,1] op_sel_hi:[1,1]
    ds_write_b32 v13, v80 offset:6592
    v_cvt_pk_bf16_f32 v152, v192, v193
    v_cvt_pk_bf16_f32 v153, v194, v195
    v_cvt_pk_bf16_f32 v154, v196, v197
    v_cvt_pk_bf16_f32 v155, v198, v199
    v_cvt_pk_bf16_f32 v156, v200, v201
    v_cvt_pk_bf16_f32 v157, v202, v203
    s_mov_b32 exec_lo, 0x0
    s_mov_b32 exec_hi, 0xffff0000
    ds_write_b128 v12, v[76:79] offset:192
    s_mov_b64 exec, -1
    v_mfma_f32_16x16x16_bf16 v[84:87], v[156:157], v[180:181], 0
    v_mfma_f32_16x16x16_bf16 v[88:91], v[156:157], v[186:187], 0
    v_mfma_f32_16x16x16_bf16 v[92:95], v[254:255], v[156:157], 0
    s_nop 3
    v_mfma_f32_16x16x32_bf16 v[84:87], v[152:155], v[176:179], v[84:87]
    v_mfma_f32_16x16x32_bf16 v[88:91], v[152:155], v[182:185], v[88:91]
    v_mfma_f32_16x16x32_bf16 v[92:95], v[250:253], v[152:155], v[92:95]
    s_mov_b32 exec_lo, 0xf000f000
    s_mov_b32 exec_hi, 0xf000f000
    s_nop 3
    ds_write_b128 v11, v[84:87] offset:256
    s_mov_b64 exec, -1
    s_mov_b32 exec_lo, 0xffffffff
    s_mov_b32 exec_hi, 0xffffffff
    ds_write_b128 v12, v[88:91] offset:256
    s_mov_b64 exec, -1
    ds_write_b32 v13, v92 offset:6656
    s_waitcnt lgkmcnt(0)
    s_barrier
    ds_read2st64_b32 v[32:33], v15 offset0:0 offset1:140
    ds_read2st64_b32 v[34:35], v16 offset0:0 offset1:140
    ds_read2st64_b32 v[36:37], v15 offset0:4 offset1:144
    ds_read2st64_b32 v[38:39], v16 offset0:4 offset1:144
    ds_read2st64_b32 v[40:41], v15 offset0:8 offset1:148
    ds_read2st64_b32 v[42:43], v16 offset0:8 offset1:148
    ds_read2st64_b32 v[44:45], v15 offset0:12 offset1:152
    ds_read2st64_b32 v[46:47], v16 offset0:12 offset1:152
    ds_read2st64_b32 v[48:49], v15 offset0:16 offset1:156
    ds_read2st64_b32 v[50:51], v16 offset0:16 offset1:156
    ds_read2st64_b32 v[52:53], v15 offset0:20 offset1:160
    ds_read2st64_b32 v[54:55], v16 offset0:20 offset1:160
    ds_read2st64_b32 v[56:57], v15 offset0:24 offset1:164
    ds_read2st64_b32 v[58:59], v16 offset0:24 offset1:164
    s_waitcnt lgkmcnt(12)
    v_pk_add_f32 v[32:33], v[32:33], v[34:35]
    v_add_f32 v32, v32, v33
    buffer_atomic_add_f32 v32, v14, s[16:19], s50 offen offset:0
    s_waitcnt lgkmcnt(10)
    v_pk_add_f32 v[36:37], v[36:37], v[38:39]
    v_add_f32 v36, v36, v37
    buffer_atomic_add_f32 v36, v14, s[16:19], s50 offen offset:1024
    s_waitcnt lgkmcnt(8)
    v_pk_add_f32 v[40:41], v[40:41], v[42:43]
    v_add_f32 v40, v40, v41
    buffer_atomic_add_f32 v40, v14, s[16:19], s50 offen offset:2048
    s_waitcnt lgkmcnt(6)
    v_pk_add_f32 v[44:45], v[44:45], v[46:47]
    v_add_f32 v44, v44, v45
    buffer_atomic_add_f32 v44, v14, s[16:19], s50 offen offset:3072
    s_waitcnt lgkmcnt(4)
    v_pk_add_f32 v[48:49], v[48:49], v[50:51]
    v_add_f32 v48, v48, v49
    buffer_atomic_add_f32 v48, v14, s[16:19], s51 offen offset:0
    s_waitcnt lgkmcnt(2)
    v_pk_add_f32 v[52:53], v[52:53], v[54:55]
    v_add_f32 v52, v52, v53
    buffer_atomic_add_f32 v52, v14, s[16:19], s51 offen offset:1024
    s_waitcnt lgkmcnt(0)
    v_pk_add_f32 v[56:57], v[56:57], v[58:59]
    v_add_f32 v56, v56, v57
    buffer_atomic_add_f32 v56, v17, s[16:19], s51 offen offset:2048
    s_branch L_join
L_idle:
    s_bfe_u32 s53, s2, 0x20003
    s_lshl_b32 s53, s53, 8
    s_and_b32 s54, s36, 1
    s_lshl_b32 s54, s54, 12
    s_add_u32 s53, s53, s54
    s_lshr_b32 s54, s36, 1
    s_lshl_b32 s54, s54, 14
    s_add_u32 s53, s53, s54
    s_add_u32 s53, s53, 327680
    s_add_u32 s4, s16, s53
    s_addc_u32 s5, s17, 0
    s_mov_b32 s53, 1
    s_mov_b32 s54, 1
    s_atomic_or s53, s[4:5], 0x0 glc
    s_atomic_or s54, s[4:5], 0x2000 glc
    s_waitcnt lgkmcnt(0)
    s_mul_i32 s50, s75, 192
    s_add_u32 s50, s50, 65536
    s_lshl_b32 s51, s75, 6
    v_mov_b32 v248, 0
    v_mov_b32 v249, 0
    v_mov_b32 v250, 0
    v_mov_b32 v251, 0
    s_mov_b64 exec, 0xfff
    buffer_store_dwordx4 v[248:251], v3, s[16:19], s50 offen sc1
    s_mov_b64 exec, -1
    s_waitcnt vmcnt(7)
    v_lshlrev_b32 v204, 16, v192
    v_and_b32 v205, 0xffff0000, v192
    v_lshlrev_b32 v206, 16, v193
    v_and_b32 v207, 0xffff0000, v193
    v_lshlrev_b32 v208, 16, v194
    v_and_b32 v209, 0xffff0000, v194
    v_lshlrev_b32 v210, 16, v195
    v_and_b32 v211, 0xffff0000, v195
    v_lshlrev_b32 v212, 16, v196
    v_and_b32 v213, 0xffff0000, v196
    v_lshlrev_b32 v214, 16, v197
    v_and_b32 v215, 0xffff0000, v197
    v_lshlrev_b32 v216, 16, v198
    v_and_b32 v217, 0xffff0000, v198
    v_lshlrev_b32 v218, 16, v199
    v_and_b32 v219, 0xffff0000, v199
    v_lshlrev_b32 v220, 16, v200
    v_and_b32 v221, 0xffff0000, v200
    v_lshlrev_b32 v222, 16, v201
    v_and_b32 v223, 0xffff0000, v201
    v_add_f32 v192, v204, v205
    v_add_f32 v193, v206, v207
    v_add_f32 v192, v192, v208
    v_add_f32 v193, v193, v209
    v_add_f32 v192, v192, v210
    v_add_f32 v193, v193, v211
    v_add_f32 v192, v192, v212
    v_add_f32 v193, v193, v213
    v_add_f32 v192, v192, v214
    v_add_f32 v193, v193, v215
    v_add_f32 v192, v192, v216
    v_add_f32 v193, v193, v217
    v_add_f32 v192, v192, v218
    v_add_f32 v193, v193, v219
    v_add_f32 v192, v192, v220
    v_add_f32 v193, v193, v221
    v_add_f32 v192, v192, v222
    v_add_f32 v193, v193, v223
    v_add_f32 v192, v192, v193
    s_nop 1
    v_add_f32_dpp v192, v192, v192 quad_perm:[1,0,3,2] row_mask:0xf bank_mask:0xf
    s_nop 1
    v_add_f32_dpp v192, v192, v192 quad_perm:[2,3,0,1] row_mask:0xf bank_mask:0xf
    s_nop 1
    v_add_f32_dpp v192, v192, v192 row_half_mirror row_mask:0xf bank_mask:0xf
    s_nop 1
    v_add_f32_dpp v192, v192, v192 row_mirror row_mask:0xf bank_mask:0xf
    v_mov_b32 v193, v192
    s_nop 1
    v_permlane16_swap_b32 v192, v193
    v_add_f32 v192, v192, v193
    v_mul_f32 v192, 0x3acccccd, v192
    v_sub_f32 v204, v204, v192
    v_sub_f32 v205, v205, v192
    v_sub_f32 v206, v206, v192
    v_sub_f32 v207, v207, v192
    v_sub_f32 v208, v208, v192
    v_sub_f32 v209, v209, v192
    v_sub_f32 v210, v210, v192
    v_sub_f32 v211, v211, v192
    v_sub_f32 v212, v212, v192
    v_sub_f32 v213, v213, v192
    v_sub_f32 v214, v214, v192
    v_sub_f32 v215, v215, v192
    v_sub_f32 v216, v216, v192
    v_sub_f32 v217, v217, v192
    v_sub_f32 v218, v218, v192
    v_sub_f32 v219, v219, v192
    v_sub_f32 v220, v220, v192
    v_sub_f32 v221, v221, v192
    v_sub_f32 v222, v222, v192
    v_sub_f32 v223, v223, v192
    v_mul_f32 v193, v204, v204
    v_mul_f32 v194, v205, v205
    v_fmac_f32 v193, v206, v206
    v_fmac_f32 v194, v207, v207
    v_fmac_f32 v193, v208, v208
    v_fmac_f32 v194, v209, v209
    v_fmac_f32 v193, v210, v210
    v_fmac_f32 v194, v211, v211
    v_fmac_f32 v193, v212, v212
    v_fmac_f32 v194, v213, v213
    v_fmac_f32 v193, v214, v214
    v_fmac_f32 v194, v215, v215
    v_fmac_f32 v193, v216, v216
    v_fmac_f32 v194, v217, v217
    v_fmac_f32 v193, v218, v218
    v_fmac_f32 v194, v219, v219
    v_fmac_f32 v193, v220, v220
    v_fmac_f32 v194, v221, v221
    v_fmac_f32 v193, v222, v222
    v_fmac_f32 v194, v223, v223
    v_add_f32 v193, v193, v194
    s_nop 1
    v_add_f32_dpp v193, v193, v193 quad_perm:[1,0,3,2] row_mask:0xf bank_mask:0xf
    s_nop 1
    v_add_f32_dpp v193, v193, v193 quad_perm:[2,3,0,1] row_mask:0xf bank_mask:0xf
    s_nop 1
    v_add_f32_dpp v193, v193, v193 row_half_mirror row_mask:0xf bank_mask:0xf
    s_nop 1
    v_add_f32_dpp v193, v193, v193 row_mirror row_mask:0xf bank_mask:0xf
    v_mov_b32 v194, v193
    s_nop 1
    v_permlane16_swap_b32 v193, v194
    v_add_f32 v193, v193, v194
    v_mov_b32 v194, 0x3727c5ac
    v_fmac_f32 v194, 0x3acccccd, v193
    v_rsq_f32 v193, v194
    v_mov_b32 v194, v192
    v_mov_b32 v195, v193
    s_nop 0
    v_permlane32_swap_b32 v192, v194
    v_permlane32_swap_b32 v193, v195
    s_mov_b64 exec, 15
    buffer_store_dwordx4 v[192:195], v3, s[20:23], s51 offen sc1
    s_mov_b64 exec, -1
    s_waitcnt vmcnt(2)
    ds_read_b64_tr_b16 v[224:225], v252 offset:61440
    ds_read_b64_tr_b16 v[226:227], v252 offset:63488
    ds_read_b64_tr_b16 v[228:229], v246 offset:61440
    ds_read_b64_tr_b16 v[230:231], v246 offset:63488
    ds_read_b64_tr_b16 v[232:233], v247 offset:61440
    ds_read_b64_tr_b16 v[234:235], v247 offset:63488
    ds_read_b64_tr_b16 v[236:237], v148 offset:61440
    ds_read_b64_tr_b16 v[238:239], v148 offset:63488
    s_waitcnt lgkmcnt(0)
    buffer_store_dwordx4 v[224:227], v203, s[16:19], s66 offen sc1
    buffer_store_dwordx4 v[224:227], v202, s[16:19], s66 offen sc1
    buffer_store_dwordx4 v[228:231], v203, s[16:19], s67 offen sc1
    buffer_store_dwordx4 v[228:231], v202, s[16:19], s67 offen sc1
    buffer_store_dwordx4 v[232:235], v203, s[16:19], s68 offen sc1
    buffer_store_dwordx4 v[232:235], v202, s[16:19], s68 offen sc1
    buffer_store_dwordx4 v[236:239], v203, s[16:19], s69 offen sc1
    buffer_store_dwordx4 v[236:239], v202, s[16:19], s69 offen sc1
    s_mov_b32 s50, 0
    s_mov_b32 s51, 0
    s_waitcnt lgkmcnt(0)
    s_barrier
    s_mov_b32 s52, 0
    s_atomic_or s52, s[4:5], 0x0 glc
L_pr0:
    s_add_u32 s50, s50, 1
    s_lshr_b32 s53, s50, 12
    s_or_b32 s53, s53, s52
    s_cbranch_scc0 L_pr0
    s_waitcnt lgkmcnt(0)
    s_barrier
    s_mov_b32 s52, 0
    s_atomic_or s52, s[4:5], 0x2000 glc
L_pr1:
    s_add_u32 s51, s51, 1
    s_lshr_b32 s53, s51, 12
    s_or_b32 s53, s53, s52
    s_cbranch_scc0 L_pr1
    s_waitcnt lgkmcnt(0)
    s_barrier
    s_mov_b32 s52, 0
    s_atomic_or s52, s[4:5], 0x0 glc
L_pr2:
    s_add_u32 s50, s50, 1
    s_lshr_b32 s53, s50, 12
    s_or_b32 s53, s53, s52
    s_cbranch_scc0 L_pr2
    s_waitcnt lgkmcnt(0)
    s_barrier
    s_mov_b32 s52, 0
    s_atomic_or s52, s[4:5], 0x2000 glc
L_pr3:
    s_add_u32 s51, s51, 1
    s_lshr_b32 s53, s51, 12
    s_or_b32 s53, s53, s52
    s_cbranch_scc0 L_pr3
    s_waitcnt lgkmcnt(0)
    s_barrier
    s_mov_b32 s52, 0
    s_atomic_or s52, s[4:5], 0x0 glc
L_pr4:
    s_add_u32 s50, s50, 1
    s_lshr_b32 s53, s50, 12
    s_or_b32 s53, s53, s52
    s_cbranch_scc0 L_pr4
    s_waitcnt lgkmcnt(0)
    s_barrier
    s_mov_b32 s52, 0
    s_atomic_or s52, s[4:5], 0x2000 glc
L_pr5:
    s_add_u32 s51, s51, 1
    s_lshr_b32 s53, s51, 12
    s_or_b32 s53, s53, s52
    s_cbranch_scc0 L_pr5
    s_waitcnt lgkmcnt(0)
    s_getreg_b32 s3, hwreg(HW_REG_XCC_ID, 2, 1)
    s_cmp_lt_u32 s51, s50
    s_cselect_b32 s52, 1, 0
    s_xor_b32 s53, s52, s3
    s_lshl_b32 s52, s52, 8
    s_lshl_b32 s53, s53, 16
    s_add_u32 s52, s52, s53
    s_add_u32 s52, s52, 1
    s_mov_b32 s56, 0
L_idle_clr:
    s_mov_b32 s53, 0
    s_atomic_add s53, s[24:25], 0x0 glc
    s_add_u32 s56, s56, 1
    s_lshr_b32 s3, s56, 14
    s_waitcnt lgkmcnt(0)
    s_or_b32 s3, s3, s53
    s_cmp_lt_u32 s3, 4
    s_cbranch_scc1 L_idle_clr
    s_add_u32 s4, s16, 294912
    s_addc_u32 s5, s17, 0
    s_atomic_add s52, s[4:5], 0x380
    s_atomic_add s52, s[4:5], 0x780
    s_atomic_add s52, s[4:5], 0xb80
    s_atomic_add s52, s[4:5], 0xf80
    s_waitcnt vmcnt(0)
    s_barrier
    s_cmp_lg_u32 s36, 0
    s_cbranch_scc1 L_idle_arr
    s_lshr_b32 s3, s2, 3
    s_lshl_b32 s3, s3, 7
    s_mov_b32 s54, 1
    s_atomic_add s54, s[4:5], s3
L_idle_arr:
    v_and_b32 v6, 7, v0
    v_add_u32 v249, 1, v6
    v_lshrrev_b32 v249, 3, v249
    v_mad_u32_u24 v249, v249, 12, 8
    s_lshl_b32 s71, s36, 10
    s_add_u32 s71, s71, 294912
    v_lshl_add_u32 v6, v6, 7, s71
    s_mul_i32 s42, s36, 35840
    s_lshl_b32 s65, s49, 22
    s_add_u32 s65, s65, 4194304
    s_and_b32 s40, s2, 1
    s_mul_i32 s40, s40, 27
    s_add_u32 s40, s40, s36
    s_lshl_b32 s57, s40, 14
    s_add_u32 s57, s57, s65
    s_and_b32 s50, s40, 2
    s_mul_i32 s50, s50, 1536
    s_add_u32 s57, s57, s50
    s_mul_i32 s50, s36, 81920
    s_add_u32 s65, s65, s50
    s_add_u32 s65, s65, 884736
    s_add_u32 s72, s36, 1
    s_lshr_b32 s72, s72, 2
    s_lshl_b32 s72, s72, 30
    s_mov_b32 s62, 0x3f317218
    s_mov_b32 s63, 0x358637bd
    s_mov_b64 exec, 0xff
    s_mov_b64 vcc, -1
    s_cbranch_vccz L_chk_idle_ok
    s_mov_b32 s56, 0
L_chk_idle_again:
    s_sleep 8
    v_mov_b32 v5, 0
    buffer_atomic_add v5, v6, s[16:19], 0 offen sc0 sc1
    s_waitcnt vmcnt(0)
    v_and_b32 v7, 0xff, v5
    v_cmp_ne_u32 vcc, v249, v7
    s_add_u32 s56, s56, 1
    s_cmp_gt_u32 s56, 65536
    s_cbranch_scc1 L_chk_idle_ok
    s_cbranch_vccnz L_chk_idle_again
L_chk_idle_ok:
    s_mov_b64 exec, -1
    s_barrier
    v_readlane_b32 s50, v5, 7
    s_getreg_b32 s51, hwreg(HW_REG_XCC_ID, 2, 1)
    s_bfe_u32 s52, s50, 0x80008
    s_cmp_gt_u32 s52, 6
    s_cselect_b32 s64, 0xf0, 0x0f
    s_cmp_gt_u32 s50, 458751
    s_cselect_b32 s52, 1, 0
    s_xor_b32 s52, s52, s51
    s_and_b32 s50, s2, 7
    s_lshr_b32 s50, s64, s50
    s_and_b32 s50, s50, 1
    s_lshl_b32 s61, s50, 13
    s_lshl_b32 s52, s52, 13
    s_add_u32 s57, s57, s52
    s_add_u32 s65, s65, s52
    s_mov_b32 s5, 0
    s_and_b32 s3, s39, 7
    s_lshl2_add_u32 s4, s3, s36
    s_lshl_b32 s4, s4, 7
    s_add_u32 s4, s4, 98304
    s_lshl_b32 s50, s36, 1
    s_lshr_b32 s3, s64, s50
    s_and_b32 s3, s3, 1
    s_lshl_b32 s3, s3, 13
    s_add_u32 s4, s4, s3
    s_and_b32 s3, s36, 1
    s_lshl_b32 s3, s3, 2
    s_xor_b32 s50, s48, s3
    s_mul_i32 s3, s50, 22336
    s_lshr_b32 s51, s3, 16
    s_add_u32 s3, s3, 21987
    s_lshr_b32 s3, s3, 16
    s_sub_u32 s51, s3, s51
    s_lshr_b32 s3, s48, 3
    s_lshl2_add_u32 s3, s49, s3
    s_add_u32 s3, s3, 128
    s_cmp_eq_u32 s36, 3
    s_cselect_b32 s50, s3, s50
    s_cselect_b32 s51, 0, s51
    s_cmp_eq_u32 s36, 2
    s_cselect_b32 s7, 4, 11
    s_cmp_lt_u32 s36, 2
    s_cselect_b32 s0, -1, 0
    s_cselect_b32 s3, 0, 128
    s_lshl_b32 s7, s7, s51
    s_add_u32 s50, s50, s3
    s_lshl_b32 s6, s50, 7
    s_add_u32 s6, s6, s61
    s_add_u32 s6, s6, 65536
    s_mov_b32 s1, s61
    s_lshr_b32 s3, s48, 1
    s_lshl_b32 s3, s3, 22
    s_add_u32 s61, s61, s3
    s_and_b32 s3, s48, 1
    s_lshl_b32 s3, s3, 20
    s_add_u32 s61, s61, s3
    s_and_b32 s3, s48, 15
    s_lshl_b32 s3, s3, 14
    s_add_u32 s61, s61, s3
    s_xor_b32 s20, s61, 0x810000
    s_add_u32 s61, s61, 37748736
    s_add_u32 s20, s20, 37748736
    s_and_b32 s3, s40, 1
    s_lshl_b32 s3, s3, 12
    s_lshl_b32 s50, s40, 13
    s_sub_u32 s50, s50, s3
    s_add_u32 s20, s20, s50
    s_add_u32 s21, s61, s50
    s_add_u32 s3, s36, 1
    s_and_b32 s3, s3, 3
    s_lshl_b32 s12, s3, 10
    s_add_u32 s3, s36, 2
    s_and_b32 s3, s3, 3
    s_lshl_b32 s13, s3, 10
    s_add_u32 s3, s36, 3
    s_and_b32 s3, s3, 3
    s_lshl_b32 s14, s3, 10
    s_add_u32 s3, s36, 4
    s_and_b32 s3, s3, 3
    s_lshl_b32 s15, s3, 10
    s_add_u32 s58, s57, 0
    buffer_load_dwordx4 a[0:3], v3, s[16:19], s58 offen offset:0 sc1
    buffer_load_dwordx4 a[4:7], v3, s[16:19], s58 offen offset:1024 sc1
    buffer_load_dwordx4 a[8:11], v3, s[16:19], s58 offen offset:2048 sc1
    buffer_load_dwordx4 a[12:15], v3, s[16:19], s58 offen offset:3072 sc1
    buffer_load_dwordx4 a[16:19], v4, s[16:19], s58 offen offset:0 sc1
    s_add_u32 s58, s57, 65536
    buffer_load_dwordx4 a[20:23], v3, s[16:19], s58 offen offset:0 sc1
    buffer_load_dwordx4 a[24:27], v3, s[16:19], s58 offen offset:1024 sc1
    buffer_load_dwordx4 a[28:31], v3, s[16:19], s58 offen offset:2048 sc1
    buffer_load_dwordx4 a[32:35], v3, s[16:19], s58 offen offset:3072 sc1
    buffer_load_dwordx4 a[36:39], v4, s[16:19], s58 offen offset:0 sc1
    s_add_u32 s58, s57, 131072
    buffer_load_dwordx4 a[40:43], v3, s[16:19], s58 offen offset:0 sc1
    buffer_load_dwordx4 a[44:47], v3, s[16:19], s58 offen offset:1024 sc1
    buffer_load_dwordx4 a[48:51], v3, s[16:19], s58 offen offset:2048 sc1
    buffer_load_dwordx4 a[52:55], v3, s[16:19], s58 offen offset:3072 sc1
    buffer_load_dwordx4 a[56:59], v4, s[16:19], s58 offen offset:0 sc1
    s_add_u32 s58, s57, 196608
    buffer_load_dwordx4 a[60:63], v3, s[16:19], s58 offen offset:0 sc1
    buffer_load_dwordx4 a[64:67], v3, s[16:19], s58 offen offset:1024 sc1
    buffer_load_dwordx4 a[68:71], v3, s[16:19], s58 offen offset:2048 sc1
    buffer_load_dwordx4 a[72:75], v3, s[16:19], s58 offen offset:3072 sc1
    buffer_load_dwordx4 a[76:79], v4, s[16:19], s58 offen offset:0 sc1
    s_add_u32 s58, s57, 262144
    buffer_load_dwordx4 a[80:83], v3, s[16:19], s58 offen offset:0 sc1
    buffer_load_dwordx4 a[84:87], v3, s[16:19], s58 offen offset:1024 sc1
    buffer_load_dwordx4 a[88:91], v3, s[16:19], s58 offen offset:2048 sc1
    buffer_load_dwordx4 a[92:95], v3, s[16:19], s58 offen offset:3072 sc1
    buffer_load_dwordx4 a[96:99], v4, s[16:19], s58 offen offset:0 sc1
    s_add_u32 s58, s57, 327680
    buffer_load_dwordx4 a[100:103], v3, s[16:19], s58 offen offset:0 sc1
    buffer_load_dwordx4 a[104:107], v3, s[16:19], s58 offen offset:1024 sc1
    buffer_load_dwordx4 a[108:111], v3, s[16:19], s58 offen offset:2048 sc1
    buffer_load_dwordx4 a[112:115], v3, s[16:19], s58 offen offset:3072 sc1
    buffer_load_dwordx4 a[116:119], v4, s[16:19], s58 offen offset:0 sc1
    s_add_u32 s58, s57, 393216
    v_or_b32 v188, s72, v3
    buffer_load_dwordx4 a[120:123], v188, s[16:19], s58 offen offset:0 sc1
    buffer_load_dwordx4 a[124:127], v188, s[16:19], s58 offen offset:1024 sc1
    buffer_load_dwordx4 a[128:131], v188, s[16:19], s58 offen offset:2048 sc1
    buffer_load_dwordx4 a[132:135], v188, s[16:19], s58 offen offset:3072 sc1
    v_or_b32 v188, s72, v4
    buffer_load_dwordx4 a[136:139], v188, s[16:19], s58 offen offset:0 sc1
    s_add_u32 s58, s36, 2
    s_and_b32 s58, s58, 2
    s_mul_i32 s58, s58, 1536
    s_add_u32 s58, s58, s65
    s_add_u32 s65, s65, 16384
    buffer_load_dwordx4 a[140:143], v3, s[16:19], s58 offen offset:0 sc1
    buffer_load_dwordx4 a[144:147], v3, s[16:19], s58 offen offset:1024 sc1
    buffer_load_dwordx4 a[148:151], v3, s[16:19], s58 offen offset:2048 sc1
    buffer_load_dwordx4 a[152:155], v3, s[16:19], s58 offen offset:3072 sc1
    buffer_load_dwordx4 a[156:159], v4, s[16:19], s58 offen offset:0 sc1
    s_add_u32 s58, s36, 3
    s_and_b32 s58, s58, 2
    s_mul_i32 s58, s58, 1536
    s_add_u32 s58, s58, s65
    s_add_u32 s65, s65, 16384
    buffer_load_dwordx4 a[160:163], v3, s[16:19], s58 offen offset:0 sc1
    buffer_load_dwordx4 a[164:167], v3, s[16:19], s58 offen offset:1024 sc1
    s_mov_b32 s38, 3
    s_branch L_join
L_code_end:
    s_endpgm
.fill 64, 4, 0xbf810000
.section .rodata,"a"
.p2align 6
.amdhsa_kernel parallel_sum__linear_attn_block__dense_activation_silu__prompt_kernel
  .amdhsa_next_free_vgpr 512
  .amdhsa_next_free_sgpr 102
  .amdhsa_accum_offset 256
  .amdhsa_group_segment_fixed_size 0
  .amdhsa_kernarg_size 72
  .amdhsa_user_sgpr_count 2
  .amdhsa_user_sgpr_kernarg_segment_ptr 1
  .amdhsa_system_sgpr_workgroup_id_x 1
.end_amdhsa_kernel
```
